```python
import torch

def _softmax(x, axis=-1):
    return torch.softmax(x, dim=axis)
def _gelu(x):
    return torch.nn.functional.gelu(x, approximate="tanh")
def _silu(x):
    return torch.nn.functional.silu(x)
def _sigmoid(x):
    return torch.sigmoid(x)
def _layernorm(x, axis=-1, eps=1e-5):
    m = x.mean(dim=axis, keepdim=True)
    v = x.var(dim=axis, keepdim=True, unbiased=False)
    return (x - m) / torch.sqrt(v + eps)
def _scatter_add(tgt, idx, src, axis=0):
    return tgt.clone().index_add_(axis, idx, src)
def _segment_sum(src, seg, n):
    out = torch.zeros((n,) + src.shape[1:], dtype=src.dtype)
    return out.index_add_(0, seg, src)
def _pad(x, pw):
    flat = tuple(v for pair in reversed(pw) for v in pair)
    return torch.nn.functional.pad(x, flat)

kernel_name = 'gated_mix__spectral_gfnet__swiglu_ffn__prompt'

def setup_inputs():

    _w = (lambda a: (lambda t: t.to(torch.bfloat16) if t.is_floating_point() else t)(torch.as_tensor(a)))
    def _A_setup():
        B, S, D = 1, 2048, 576
        Df = D // 2 + 1
        return {
            "x": _w((lambda *s: torch.randn(*s, dtype=torch.bfloat16) * 0.05)(B, S, D)),
            "w_r": _w((lambda *s: torch.randn(*s, dtype=torch.bfloat16) * 1.6)(S, Df) * 0.02),
            "w_i": _w((lambda *s: torch.randn(*s, dtype=torch.bfloat16) * 1.6)(S, Df) * 0.02),
        }
    _A_in = _A_setup()

    def _B_setup():
        B, S, D, F = 1, 2048, 576, 4608
        return {
            "x": _w((lambda *s: torch.randn(*s, dtype=torch.bfloat16) * 0.05)(B, S, D)),
            "w_gate": _w((lambda *s: torch.randn(*s, dtype=torch.bfloat16) * 0.05)(D, F)),
            "w_up": _w((lambda *s: torch.randn(*s, dtype=torch.bfloat16) * 0.05)(D, F)),
            "w_down": _w((lambda *s: torch.randn(*s, dtype=torch.bfloat16) * 0.05)(F, D)),
        }
    _B_in = _B_setup()

    return {
        "A_x": _A_in["x"],
        "A_w_r": _A_in["w_r"],
        "A_w_i": _A_in["w_i"],
        "B_x": _B_in["x"],
        "B_w_gate": _B_in["w_gate"],
        "B_w_up": _B_in["w_up"],
        "B_w_down": _B_in["w_down"],
        "gate_w": _w((lambda *s: torch.randn(*s, dtype=torch.bfloat16) * 0.05)(576) * 16.0),
    }

def reference(A_x, A_w_r, A_w_i, B_x, B_w_gate, B_w_up, B_w_down, gate_w):
    def _A_ref(x, w_r, w_i):
        B, S, D = x.shape
        X = (lambda x, axes=(-2,-1): torch.fft.rfft2(x.float(), dim=axes))(x, axes=(-2, -1))
        W = w_r + 1j * w_i
        X = X * W
        y = (lambda x, s, axes=(-2,-1): torch.fft.irfft2(x, s=s, dim=axes).to(torch.bfloat16))(X, (S, D), axes=(-2, -1))
        return y

    def _B_ref(x, w_gate, w_up, w_down):
        g = _silu(x @ w_gate)
        u = x @ w_up
        return (g * u) @ w_down

    x = A_x
    g = _sigmoid((x * gate_w).sum(-1, keepdims=True))
    a = _A_ref(x, A_w_r, A_w_i)
    b = _B_ref(x, B_w_gate, B_w_up, B_w_down)
    return g * a + (1 - g) * b
```

```asm
; @launch grid=(256,1,1) block=(256,1,1) lds=163840
.amdgcn_target "amdgcn-amd-amdhsa--gfx950"
.text
.globl gated_mix__spectral_gfnet__swiglu_ffn__prompt_kernel
.p2align 8
.type gated_mix__spectral_gfnet__swiglu_ffn__prompt_kernel,@function
gated_mix__spectral_gfnet__swiglu_ffn__prompt_kernel:
  s_cmp_ge_u32 s2, 256
  s_cbranch_scc1 L_end_gated_mix__spectral_gfnet__swiglu_ffn__prompt_kernel
  s_load_dwordx16 s[52:67], s[0:1], 0
  s_load_dwordx4 s[68:71], s[0:1], 64
  s_load_dwordx2 s[72:73], s[0:1], 80
  s_getpc_b64 s[6:7]
L_pc_gated_mix__spectral_gfnet__swiglu_ffn__prompt_kernel:
  v_lshlrev_b32 v34, 5, v0
  v_mov_b32 v35, s7
  v_add_co_u32 v34, vcc, s6, v34
  s_nop 1
  v_addc_co_u32 v35, vcc, 0, v35, vcc
  global_load_dword v23, v[34:35], off
  v_lshrrev_b32 v1, 6, v0
  v_and_b32 v0, 63, v0
  v_readfirstlane_b32 s81, v1
  v_and_b32 v1, 15, v0
  v_lshrrev_b32 v2, 4, v0
  s_and_b32 s80, s2, 3
  s_lshl_b32 s80, s80, 2
  s_bfe_u32 s84, s2, 0x20003
  s_add_u32 s80, s80, s84
  s_lshr_b32 s3, s2, 5
  s_lshl_b32 s79, s3, 1
  s_bfe_u32 s85, s2, 0x10002
  s_add_u32 s79, s79, s85
  s_lshl_b32 s84, s84, 1
  s_add_u32 s3, s3, s84
  s_cmp_ge_u32 s3, 9
  s_cselect_b32 s84, 9, 0
  s_sub_u32 s3, s3, s84
  s_lshr_b32 s87, s81, 1
  s_and_b32 s88, s81, 1
  s_lshl_b32 s82, s81, 10
  v_lshrrev_b32 v6, 3, v0
  s_lshl_b32 s84, s81, 3
  v_add_u32 v6, s84, v6
  v_mul_u32_u24 v3, 36864, v6
  s_lshl_b32 s84, s88, 2
  v_add_u32 v32, s84, v2
  v_xor_b32 v32, v0, v32
  v_and_b32 v32, 7, v32
  v_lshl_add_u32 v3, v32, 4, v3
  s_mul_i32 s84, s79, 2304
  s_lshl_b32 s85, s3, 7
  s_add_u32 s84, s84, s85
  v_add_u32 v3, s84, v3
  v_mul_u32_u24 v4, 9216, v6
  v_bfe_u32 v32, v0, 1, 2
  v_and_b32 v33, 1, v2
  s_lshl_b32 s84, s88, 1
  v_or_b32 v33, s84, v33
  v_xor_b32 v33, v33, v32
  v_lshl_add_u32 v4, v33, 5, v4
  v_and_b32 v33, 1, v0
  v_lshl_add_u32 v4, v33, 4, v4
  s_mul_i32 s92, s80, 576
  s_and_b32 s93, s80, 1
  s_lshl_b32 s86, s93, 6
  s_add_u32 s86, s86, s92
  v_add_u32 v4, s86, v4
  s_mov_b32 s75, 0
  s_mov_b32 s76, 1179648
  s_mov_b32 s77, 1152
  s_mov_b32 s78, 1180800
  s_mul_i32 s48, s3, 589824
  s_add_u32 s49, s48, 294912
  s_add_u32 s50, s48, 589824
  s_cmp_eq_u32 s3, 8
  s_cselect_b32 s50, 0, s50
  s_add_u32 s51, s50, 294912
  s_mov_b32 s10, 0x240000
  s_mov_b32 s11, 0x20000
  s_mov_b32 s14, 0x510000
  s_mov_b32 s15, 0x20000
  s_mov_b32 s18, 0x510000
  s_mov_b32 s19, 0x20000
  s_waitcnt lgkmcnt(0)
  s_mov_b32 s8, s52
  s_and_b32 s9, s53, 0xffff
  s_add_u32 m0, s82, 16384
  s_nop 0
  buffer_load_dwordx4 v3, s[8:11], s75 offen lds
  s_add_u32 m0, s82, 20480
  s_nop 0
  buffer_load_dwordx4 v3, s[8:11], s76 offen lds
  s_add_u32 m0, s82, 24576
  s_nop 0
  buffer_load_dwordx4 v3, s[8:11], s77 offen lds
  s_add_u32 m0, s82, 28672
  s_nop 0
  buffer_load_dwordx4 v3, s[8:11], s78 offen lds
  s_mov_b32 s12, s60
  s_and_b32 s13, s61, 0xffff
  s_mov_b32 s16, s62
  s_and_b32 s17, s63, 0xffff
  s_add_u32 m0, s82, 0
  s_nop 0
  buffer_load_dwordx4 v4, s[12:15], s48 offen lds
  s_add_u32 m0, s82, 4096
  s_nop 0
  buffer_load_dwordx4 v4, s[12:15], s49 offen lds
  s_add_u32 m0, s82, 8192
  s_nop 0
  buffer_load_dwordx4 v4, s[16:19], s48 offen lds
  s_add_u32 m0, s82, 12288
  s_nop 0
  buffer_load_dwordx4 v4, s[16:19], s49 offen lds
  s_cmp_eq_u32 s87, 0
  s_cselect_b32 s54, s54, s56
  s_cselect_b32 s55, s55, s57
  s_mov_b32 s32, s54
  s_and_b32 s33, s55, 0xffff
  s_mov_b32 s34, 0x121000
  s_mov_b32 s35, 0x20000
  s_mov_b32 s20, s64
  s_and_b32 s21, s65, 0xffff
  s_mov_b32 s22, 0x510000
  s_mov_b32 s23, 0x20000
  s_mov_b32 s40, s66
  s_and_b32 s41, s67, 0xffff
  s_mov_b32 s42, 0x480
  s_mov_b32 s43, 0x20000
  s_mov_b32 s28, s70
  s_and_b32 s29, s71, 0xffff
  s_mov_b32 s30, 0x100
  s_mov_b32 s31, 0x20000
  s_mov_b32 s24, s72
  s_and_b32 s25, s73, 0xffff
  s_mov_b32 s26, 0x10000000
  s_mov_b32 s27, 0x20000
  s_lshr_b32 s84, s2, 3
  s_lshl_b32 s84, s84, 2
  s_add_u32 s84, s84, s81
  s_lshl_b32 s84, s84, 9
  s_add_u32 s84, s84, 8192
  v_lshlrev_b32 v34, 3, v0
  v_add_u32 v34, s84, v34
  v_min_u32 v34, L_last_gated_mix__spectral_gfnet__swiglu_ffn__prompt_kernel-L_pc_gated_mix__spectral_gfnet__swiglu_ffn__prompt_kernel, v34
  v_mov_b32 v35, s7
  v_add_co_u32 v34, vcc, s6, v34
  s_nop 1
  v_addc_co_u32 v35, vcc, 0, v35, vcc
  global_load_dword v23, v[34:35], off
  v_lshrrev_b32 v171, 5, v0
  s_lshl_b32 s84, s80, 3
  s_lshl_b32 s85, s81, 1
  s_add_u32 s84, s84, s85
  v_add_u32 v171, s84, v171
  v_and_b32 v180, 63, v171
  v_lshlrev_b32 v180, 5, v180
  v_lshrrev_b32 v181, 6, v171
  v_add_u32 v180, v180, v181
  s_lshl_b32 s84, s79, 1
  v_add_u32 v180, s84, v180
  v_mul_u32_u24 v180, 1152, v180
  v_and_b32 v181, 31, v0
  v_mul_u32_u24 v181, 36, v181
  v_add_u32 v180, v180, v181
  buffer_load_dwordx4 v[112:115], v180, s[8:11], 0 offen
  buffer_load_dwordx4 v[116:119], v180, s[8:11], 0 offen offset:16
  buffer_load_dword v168, v180, s[8:11], 0 offen offset:32
  buffer_load_dwordx4 v[120:123], v181, s[40:43], 0 offen
  buffer_load_dwordx4 v[124:127], v181, s[40:43], 0 offen offset:16
  buffer_load_dword v169, v181, s[40:43], 0 offen offset:32
  s_mov_b32 s40, s68
  s_and_b32 s41, s69, 0xffff
  s_mov_b32 s42, 0x240000
  s_mov_b32 s43, 0x20000
  s_cmp_lg_u32 s80, 0
  s_cbranch_scc1 L_nw_gated_mix__spectral_gfnet__swiglu_ffn__prompt_kernel
  s_lshl_b32 s84, s79, 7
  s_lshl_b32 s85, s88, 6
  s_add_u32 s84, s84, s85
  v_add_u32 v220, s84, v0
  v_mul_u32_u24 v220, 578, v220
  buffer_load_ushort v220, v220, s[32:35], 0 offen offset:576
L_nw_gated_mix__spectral_gfnet__swiglu_ffn__prompt_kernel:
  s_cmp_lg_u32 s2, 0
  s_cbranch_scc1 L_z_gated_mix__spectral_gfnet__swiglu_ffn__prompt_kernel
  v_mov_b32 v36, 0
  v_mov_b32 v37, 0
  v_mov_b32 v38, 0
  v_mov_b32 v39, 0
  v_lshlrev_b32 v40, 4, v0
  s_lshl_b32 s84, s81, 12
  s_add_u32 s84, s84, 6422528
  buffer_store_dwordx4 v[36:39], v40, s[24:27], s84 offen offset:0 sc1
  buffer_store_dwordx4 v[36:39], v40, s[24:27], s84 offen offset:1024 sc1
  buffer_store_dwordx4 v[36:39], v40, s[24:27], s84 offen offset:2048 sc1
  buffer_store_dwordx4 v[36:39], v40, s[24:27], s84 offen offset:3072 sc1
L_z_gated_mix__spectral_gfnet__swiglu_ffn__prompt_kernel:
  s_add_u32 s52, s50, 589824
  s_cmp_eq_u32 s3, 7
  s_cselect_b32 s52, 0, s52
  s_add_u32 s53, s52, 294912
  s_add_u32 s54, s52, 589824
  s_cmp_eq_u32 s3, 6
  s_cselect_b32 s54, 0, s54
  s_add_u32 s55, s54, 294912
  s_add_u32 s56, s54, 589824
  s_cmp_eq_u32 s3, 5
  s_cselect_b32 s56, 0, s56
  s_add_u32 s57, s56, 294912
  s_add_u32 s58, s56, 589824
  s_cmp_eq_u32 s3, 4
  s_cselect_b32 s58, 0, s58
  s_add_u32 s59, s58, 294912
  s_add_u32 s60, s58, 589824
  s_cmp_eq_u32 s3, 3
  s_cselect_b32 s60, 0, s60
  s_add_u32 s61, s60, 294912
  s_add_u32 s62, s60, 589824
  s_cmp_eq_u32 s3, 2
  s_cselect_b32 s62, 0, s62
  s_add_u32 s63, s62, 294912
  s_add_u32 s64, s62, 589824
  s_cmp_eq_u32 s3, 1
  s_cselect_b32 s64, 0, s64
  s_add_u32 s65, s64, 294912
  s_lshl_b32 s89, s79, 1
  s_add_u32 s89, s89, s87
  v_lshrrev_b32 v7, 2, v1
  v_lshlrev_b32 v7, 7, v7
  v_lshl_add_u32 v7, v2, 10, v7
  v_and_b32 v32, 3, v1
  v_lshl_add_u32 v7, v32, 3, v7
  v_bfe_u32 v32, v1, 3, 1
  v_and_b32 v33, 1, v2
  v_lshl_add_u32 v32, v33, 1, v32
  s_lshl_b32 s84, s88, 1
  v_xor_b32 v32, s84, v32
  v_lshl_add_u32 v7, v32, 5, v7
  v_xor_b32 v10, 32, v7
  v_lshrrev_b32 v32, 1, v1
  v_xor_b32 v32, v32, v2
  v_lshlrev_b32 v32, 4, v32
  v_lshl_add_u32 v13, v1, 7, v32
  s_lshl_b32 s84, s87, 13
  v_add_u32 v13, s84, v13
  v_xor_b32 v16, 64, v13
  v_add_u32 v8, 0x10000, v7
  v_add_u32 v9, 0x20000, v7
  v_add_u32 v11, 0x10000, v10
  v_add_u32 v12, 0x20000, v10
  v_add_u32 v14, 0x10000, v13
  v_add_u32 v15, 0x20000, v13
  v_add_u32 v17, 0x10000, v16
  v_add_u32 v18, 0x20000, v16
  v_or_b32 v222, s81, v0
  v_min_u32 v222, 1, v222
  v_lshlrev_b32 v222, 31, v222
  v_mul_u32_u24 v6, 1152, v6
  v_bfe_u32 v32, v0, 1, 2
  v_xor_b32 v32, v32, v2
  v_lshl_add_u32 v6, v32, 5, v6
  v_and_b32 v33, 1, v0
  v_lshl_add_u32 v6, v33, 4, v6
  v_lshrrev_b32 v5, 2, v0
  s_lshl_b32 s84, s81, 4
  v_add_u32 v5, s84, v5
  v_mul_u32_u24 v5, 9216, v5
  v_lshl_add_u32 v5, v33, 4, v5
  v_bfe_u32 v32, v0, 1, 1
  v_lshrrev_b32 v33, 5, v0
  v_xor_b32 v32, v32, v33
  v_lshl_add_u32 v5, v32, 5, v5
  s_cmp_eq_u32 s93, 0
  s_cselect_b32 s84, 512, 0
  s_add_u32 s84, s84, s92
  v_add_u32 v5, s84, v5
  v_lshlrev_b32 v21, 4, v0
  v_add_u32 v22, 0x10000, v21
  s_lshl_b32 s84, s88, 13
  s_lshl_b32 s85, s87, 12
  s_add_u32 s84, s84, s85
  v_add_u32 v19, s84, v21
  s_lshl_b32 s46, s79, 4
  s_add_u32 s46, s46, s80
  s_mul_i32 s46, s46, 73728
  s_add_u32 s46, s46, 54525952
  s_mov_b32 s94, 0x3e800000
  s_mov_b32 s96, 0xbfb8aa3b
  s_add_u32 s97, s80, 2
  s_add_u32 s95, s80, 4
  s_cmp_lt_u32 s95, 18
  s_cselect_b32 s95, s95, 0
  s_sub_u32 s98, 11, s80
  s_lshl_b32 s98, s98, 4
  s_add_u32 s98, s98, s79
  s_cmp_lt_u32 s80, 12
  s_cselect_b32 s98, s98, 0x1000
  s_add_u32 s99, s98, 192
  s_mul_i32 s84, s80, 331776
  s_mul_i32 s86, s93, 36864
  s_add_u32 s66, s84, s86
  s_cmp_eq_u32 s93, 0
  s_cselect_b32 s86, 294912, 0
  s_add_u32 s74, s84, s86
  s_lshr_b32 s85, s79, 1
  s_mul_i32 s85, s85, 41472
  s_add_u32 s84, s84, s85
  s_mul_i32 s85, s81, 10368
  s_add_u32 s84, s84, s85
  v_lshlrev_b32 v20, 7, v0
  v_add_u32 v20, s84, v20
  v_cmp_gt_u32 vcc, 27, v0
  v_bfrev_b32 v32, 2
  s_lshl_b32 s44, s79, 18
  s_lshl_b32 s85, s81, 16
  v_cndmask_b32 v20, v32, v20, vcc
  s_add_u32 s44, s44, s85
  s_lshl_b32 s85, s80, 10
  s_add_u32 s44, s44, s85
  s_add_u32 s67, s66, 36864
  s_add_u32 s68, s66, 73728
  s_add_u32 s69, s66, 110592
  s_add_u32 s70, s66, 147456
  s_add_u32 s71, s66, 184320
  s_add_u32 s72, s66, 221184
  s_add_u32 s73, s66, 258048
  s_and_b32 s85, s98, 31
  s_lshl_b32 s100, s85, 7
  s_lshl_b32 s85, s85, 1
  s_add_u32 s85, s85, s88
  s_mul_i32 s85, s85, 578
  s_lshr_b32 s84, s98, 5
  s_lshl_b32 s36, s84, 6
  s_add_u32 s36, s36, s85
  s_lshl_b32 s84, s84, 18
  s_add_u32 s100, s100, s84
  s_lshl_b32 s85, s81, 15
  s_add_u32 s100, s100, s85
  s_and_b32 s85, s99, 31
  s_lshl_b32 s101, s85, 7
  s_lshl_b32 s85, s85, 1
  s_add_u32 s85, s85, s88
  s_mul_i32 s85, s85, 578
  s_lshr_b32 s84, s99, 5
  s_lshl_b32 s37, s84, 6
  s_add_u32 s37, s37, s85
  s_lshl_b32 s84, s84, 18
  s_add_u32 s101, s101, s84
  s_lshl_b32 s85, s81, 15
  s_add_u32 s101, s101, s85
  v_lshrrev_b32 v24, 2, v1
  v_lshlrev_b32 v24, 1, v24
  v_and_b32 v30, 1, v1
  v_add_u32 v24, v24, v30
  v_lshlrev_b32 v29, 31, v30
  v_or_b32 v29, 1.0, v29
  s_lshl_b32 s84, s80, 4
  s_lshl_b32 s85, s88, 3
  s_add_u32 s84, s84, s85
  v_add_u32 v24, s84, v24
  v_bfe_u32 v25, v1, 1, 1
  v_cvt_f32_u32 v25, v25
  v_mul_f32 v25, 0x3e800000, v25
  v_add_u32 v30, s84, v1
  v_cmp_eq_u32 vcc, 2, v30
  v_mov_b32 v30, 0x120
  v_lshlrev_b32 v27, 3, v2
  v_cndmask_b32 v24, v24, v30, vcc
  v_cndmask_b32 v25, v25, 0, vcc
  v_mul_u32_u24 v30, s3, v24
  v_mul_u32_u24 v26, 7282, v30
  v_lshrrev_b32 v26, 16, v26
  v_mul_u32_u24 v26, 9, v26
  v_sub_u32 v30, v30, v26
  v_cvt_f32_u32 v30, v30
  v_fmac_f32 v25, 0x3de38e39, v30
  v_cvt_f32_u32 v24, v24
  v_mul_f32 v26, 0x3d638e39, v24
  v_mul_f32 v24, 0x3ae38e39, v24
  v_cos_f32 v26, v26
  v_add_u32 v30, s84, v2
  v_cmp_eq_u32 vcc, 0, v30
  v_cvt_f32_u32 v27, v27
  v_add_f32 v26, v26, v26
  v_cndmask_b32 v28, 1.0, 0, vcc
  v_add_f32 v64, 0x00000000, v27
  v_add_f32 v65, 0x3f800000, v27
  v_add_f32 v66, 0x40000000, v27
  v_add_f32 v67, 0x40400000, v27
  v_add_f32 v68, 0x40800000, v27
  v_add_f32 v69, 0x40a00000, v27
  v_add_f32 v70, 0x40c00000, v27
  v_add_f32 v71, 0x40e00000, v27
  v_fma_f32 v64, v64, v24, v25
  v_fma_f32 v65, v65, v24, v25
  v_fma_f32 v66, v66, v24, v25
  v_fma_f32 v67, v67, v24, v25
  v_fma_f32 v68, v68, v24, v25
  v_fma_f32 v69, v69, v24, v25
  v_fma_f32 v70, v70, v24, v25
  v_fma_f32 v71, v71, v24, v25
  v_cos_f32 v64, v64
  v_cos_f32 v65, v65
  v_cos_f32 v66, v66
  v_cos_f32 v67, v67
  v_cos_f32 v68, v68
  v_cos_f32 v69, v69
  v_cos_f32 v70, v70
  v_cos_f32 v71, v71
  v_cvt_pk_bf16_f32 v128, v64, v65
  v_cvt_pk_bf16_f32 v129, v66, v67
  v_cvt_pk_bf16_f32 v130, v68, v69
  v_cvt_pk_bf16_f32 v131, v70, v71
  s_add_u32 m0, s82, 32768
  s_nop 0
  buffer_load_dwordx4 v4, s[12:15], s50 offen lds
  v_add_f32 v72, 0x42000000, v27
  v_add_f32 v73, 0x42040000, v27
  v_add_f32 v74, 0x42080000, v27
  v_add_f32 v75, 0x420c0000, v27
  v_add_f32 v76, 0x42100000, v27
  v_add_f32 v77, 0x42140000, v27
  v_add_f32 v78, 0x42180000, v27
  v_add_f32 v79, 0x421c0000, v27
  v_fma_f32 v72, v72, v24, v25
  v_fma_f32 v73, v73, v24, v25
  v_fma_f32 v74, v74, v24, v25
  v_fma_f32 v75, v75, v24, v25
  v_fma_f32 v76, v76, v24, v25
  v_fma_f32 v77, v77, v24, v25
  v_fma_f32 v78, v78, v24, v25
  v_fma_f32 v79, v79, v24, v25
  v_cos_f32 v72, v72
  v_cos_f32 v73, v73
  v_cos_f32 v74, v74
  v_cos_f32 v75, v75
  v_cos_f32 v76, v76
  v_cos_f32 v77, v77
  v_cos_f32 v78, v78
  v_cos_f32 v79, v79
  v_cvt_pk_bf16_f32 v132, v72, v73
  v_cvt_pk_bf16_f32 v133, v74, v75
  v_cvt_pk_bf16_f32 v134, v76, v77
  v_cvt_pk_bf16_f32 v135, v78, v79
  s_add_u32 m0, s82, 36864
  s_nop 0
  buffer_load_dwordx4 v4, s[12:15], s51 offen lds
  v_fma_f32 v64, v26, v72, -v64
  v_fma_f32 v65, v26, v73, -v65
  v_fma_f32 v66, v26, v74, -v66
  v_fma_f32 v67, v26, v75, -v67
  v_fma_f32 v68, v26, v76, -v68
  v_fma_f32 v69, v26, v77, -v69
  v_fma_f32 v70, v26, v78, -v70
  v_fma_f32 v71, v26, v79, -v71
  v_cvt_pk_bf16_f32 v136, v64, v65
  v_cvt_pk_bf16_f32 v137, v66, v67
  v_cvt_pk_bf16_f32 v138, v68, v69
  v_cvt_pk_bf16_f32 v139, v70, v71
  s_cmp_eq_u32 s3, 8
  s_cselect_b32 s91, -8, 1
  v_lshl_add_u32 v3, s91, 7, v3
  s_add_u32 m0, s82, 49152
  s_nop 0
  buffer_load_dwordx4 v3, s[8:11], s75 offen lds
  v_fma_f32 v72, v26, v64, -v72
  v_fma_f32 v73, v26, v65, -v73
  v_fma_f32 v74, v26, v66, -v74
  v_fma_f32 v75, v26, v67, -v75
  v_fma_f32 v76, v26, v68, -v76
  v_fma_f32 v77, v26, v69, -v77
  v_fma_f32 v78, v26, v70, -v78
  v_fma_f32 v79, v26, v71, -v79
  v_cvt_pk_bf16_f32 v140, v72, v73
  v_cvt_pk_bf16_f32 v141, v74, v75
  v_cvt_pk_bf16_f32 v142, v76, v77
  v_cvt_pk_bf16_f32 v143, v78, v79
  s_add_u32 m0, s82, 53248
  s_nop 0
  buffer_load_dwordx4 v3, s[8:11], s76 offen lds
  v_fma_f32 v64, v26, v72, -v64
  v_fma_f32 v65, v26, v73, -v65
  v_fma_f32 v66, v26, v74, -v66
  v_fma_f32 v67, v26, v75, -v67
  v_fma_f32 v68, v26, v76, -v68
  v_fma_f32 v69, v26, v77, -v69
  v_fma_f32 v70, v26, v78, -v70
  v_fma_f32 v71, v26, v79, -v71
  v_cvt_pk_bf16_f32 v144, v64, v65
  v_cvt_pk_bf16_f32 v145, v66, v67
  v_cvt_pk_bf16_f32 v146, v68, v69
  v_cvt_pk_bf16_f32 v147, v70, v71
  s_add_u32 m0, s82, 57344
  s_nop 0
  buffer_load_dwordx4 v3, s[8:11], s77 offen lds
  v_fma_f32 v72, v26, v64, -v72
  v_fma_f32 v73, v26, v65, -v73
  v_fma_f32 v74, v26, v66, -v74
  v_fma_f32 v75, v26, v67, -v75
  v_fma_f32 v76, v26, v68, -v76
  v_fma_f32 v77, v26, v69, -v77
  v_fma_f32 v78, v26, v70, -v78
  v_fma_f32 v79, v26, v71, -v79
  v_cvt_pk_bf16_f32 v148, v72, v73
  v_cvt_pk_bf16_f32 v149, v74, v75
  v_cvt_pk_bf16_f32 v150, v76, v77
  v_cvt_pk_bf16_f32 v151, v78, v79
  s_add_u32 m0, s82, 61440
  s_nop 0
  buffer_load_dwordx4 v3, s[8:11], s78 offen lds
  v_fma_f32 v64, v26, v72, -v64
  v_fma_f32 v65, v26, v73, -v65
  v_fma_f32 v66, v26, v74, -v66
  v_fma_f32 v67, v26, v75, -v67
  v_fma_f32 v68, v26, v76, -v68
  v_fma_f32 v69, v26, v77, -v69
  v_fma_f32 v70, v26, v78, -v70
  v_fma_f32 v71, v26, v79, -v71
  v_cvt_pk_bf16_f32 v152, v64, v65
  v_cvt_pk_bf16_f32 v153, v66, v67
  v_cvt_pk_bf16_f32 v154, v68, v69
  v_cvt_pk_bf16_f32 v155, v70, v71
  s_add_u32 m0, s82, 40960
  s_nop 0
  buffer_load_dwordx4 v4, s[16:19], s50 offen lds
  v_fma_f32 v72, v26, v64, -v72
  v_fma_f32 v73, v26, v65, -v73
  v_fma_f32 v74, v26, v66, -v74
  v_fma_f32 v75, v26, v67, -v75
  v_fma_f32 v76, v26, v68, -v76
  v_fma_f32 v77, v26, v69, -v77
  v_fma_f32 v78, v26, v70, -v78
  v_fma_f32 v79, v26, v71, -v79
  v_cvt_pk_bf16_f32 v156, v72, v73
  v_cvt_pk_bf16_f32 v157, v74, v75
  v_cvt_pk_bf16_f32 v158, v76, v77
  v_cvt_pk_bf16_f32 v159, v78, v79
  s_add_u32 m0, s82, 45056
  s_nop 0
  buffer_load_dwordx4 v4, s[16:19], s51 offen lds
  v_fma_f32 v64, v26, v72, -v64
  v_fma_f32 v65, v26, v73, -v65
  v_fma_f32 v66, v26, v74, -v66
  v_fma_f32 v67, v26, v75, -v67
  v_fma_f32 v68, v26, v76, -v68
  v_fma_f32 v69, v26, v77, -v69
  v_fma_f32 v70, v26, v78, -v70
  v_fma_f32 v71, v26, v79, -v71
  v_cvt_pk_bf16_f32 v192, v64, v65
  v_cvt_pk_bf16_f32 v193, v66, v67
  v_cvt_pk_bf16_f32 v194, v68, v69
  v_cvt_pk_bf16_f32 v195, v70, v71
  v_lshlrev_b32 v32, 7, v2
  v_add_u32 v32, s89, v32
  v_cvt_f32_u32 v32, v32
  v_add_f32 v33, 0x42000000, v32
  v_add_f32 v34, 0x42800000, v32
  v_add_f32 v35, 0x42c00000, v32
  v_lshl_add_u32 v36, v1, 2, 0
  v_cvt_f32_u32 v36, v36
  v_mul_f32 v36, 0x3a000000, v36
  v_mul_f32 v37, v32, v36
  v_mul_f32 v38, v33, v36
  v_cos_f32 v39, v37
  v_cos_f32 v40, v38
  v_sin_f32 v37, v37
  v_sin_f32 v38, v38
  v_cvt_pk_bf16_f32 v196, v39, v40
  v_cvt_pk_bf16_f32 v200, v37, v38
  v_cvt_pk_bf16_f32 v198, v39, v40
  v_cvt_pk_bf16_f32 v202, v37, v38
  v_mul_f32 v37, v34, v36
  v_mul_f32 v38, v35, v36
  v_cos_f32 v39, v37
  v_cos_f32 v40, v38
  v_sin_f32 v37, v37
  v_sin_f32 v38, v38
  v_cvt_pk_bf16_f32 v197, v39, v40
  v_cvt_pk_bf16_f32 v201, v37, v38
  v_cvt_pk_bf16_f32 v199, v39, v40
  v_cvt_pk_bf16_f32 v203, v37, v38
  v_lshl_add_u32 v36, v1, 2, 1
  v_cvt_f32_u32 v36, v36
  v_mul_f32 v36, 0x3a000000, v36
  v_mul_f32 v37, v32, v36
  v_mul_f32 v38, v33, v36
  v_cos_f32 v39, v37
  v_cos_f32 v40, v38
  v_sin_f32 v37, v37
  v_sin_f32 v38, v38
  v_cvt_pk_bf16_f32 v204, v39, v40
  v_cvt_pk_bf16_f32 v208, v37, v38
  v_cvt_pk_bf16_f32 v206, -v37, -v38
  v_cvt_pk_bf16_f32 v210, v39, v40
  v_mul_f32 v37, v34, v36
  v_mul_f32 v38, v35, v36
  v_cos_f32 v39, v37
  v_cos_f32 v40, v38
  v_sin_f32 v37, v37
  v_sin_f32 v38, v38
  v_cvt_pk_bf16_f32 v205, v39, v40
  v_cvt_pk_bf16_f32 v209, v37, v38
  v_cvt_pk_bf16_f32 v207, -v37, -v38
  v_cvt_pk_bf16_f32 v211, v39, v40
  v_lshl_add_u32 v36, v1, 2, 2
  v_cvt_f32_u32 v36, v36
  v_mul_f32 v36, 0x3a000000, v36
  v_mul_f32 v37, v32, v36
  v_mul_f32 v38, v33, v36
  v_cos_f32 v39, v37
  v_cos_f32 v40, v38
  v_sin_f32 v37, v37
  v_sin_f32 v38, v38
  v_cvt_pk_bf16_f32 v212, v39, v40
  v_cvt_pk_bf16_f32 v216, v37, v38
  v_cvt_pk_bf16_f32 v214, -v39, -v40
  v_cvt_pk_bf16_f32 v218, -v37, -v38
  v_mul_f32 v37, v34, v36
  v_mul_f32 v38, v35, v36
  v_cos_f32 v39, v37
  v_cos_f32 v40, v38
  v_sin_f32 v37, v37
  v_sin_f32 v38, v38
  v_cvt_pk_bf16_f32 v213, v39, v40
  v_cvt_pk_bf16_f32 v217, v37, v38
  v_cvt_pk_bf16_f32 v215, -v39, -v40
  v_cvt_pk_bf16_f32 v219, -v37, -v38
  s_waitcnt vmcnt(17)
  s_barrier
  ds_read_b128 a[0:3], v13 offset:16384
  ds_read_b128 a[4:7], v13 offset:18432
  ds_read_b128 a[16:19], v16 offset:16384
  ds_read_b128 a[20:23], v16 offset:18432
  ds_read_b64_tr_b16 v[160:161], v7 offset:0
  ds_read_b64_tr_b16 v[162:163], v7 offset:512
  ds_read_b64_tr_b16 v[164:165], v7 offset:4096
  ds_read_b64_tr_b16 v[166:167], v7 offset:4608
  ds_read_b128 a[8:11], v13 offset:20480
  ds_read_b128 a[12:15], v13 offset:22528
  ds_read_b128 a[24:27], v16 offset:20480
  ds_read_b128 a[28:31], v16 offset:22528
  ds_read_b64_tr_b16 v[172:173], v10 offset:0
  ds_read_b64_tr_b16 v[174:175], v10 offset:512
  ds_read_b64_tr_b16 v[176:177], v10 offset:4096
  ds_read_b64_tr_b16 v[178:179], v10 offset:4608
  s_waitcnt lgkmcnt(10)
  v_mfma_f32_16x16x32_bf16 v[32:35], v[160:163], a[0:3], 0
  s_waitcnt vmcnt(15) lgkmcnt(4)
  s_barrier
  v_mfma_f32_16x16x32_bf16 v[32:35], v[164:167], a[16:19], v[32:35]
  ds_read_b64_tr_b16 v[184:185], v7 offset:8192
  ds_read_b64_tr_b16 v[186:187], v7 offset:8704
  v_mfma_f32_16x16x32_bf16 v[36:39], v[164:167], a[20:23], 0
  s_add_u32 m0, s82, 65536
  v_mfma_f32_16x16x32_bf16 v[36:39], v[160:163], a[4:7], v[36:39]
  buffer_load_dwordx4 v4, s[12:15], s52 offen lds
  v_mfma_f32_16x16x32_bf16 v[40:43], v[160:163], a[8:11], 0
  s_add_u32 m0, s82, 69632
  ds_read_b64_tr_b16 v[188:189], v7 offset:12288
  ds_read_b64_tr_b16 v[190:191], v7 offset:12800
  v_mfma_f32_16x16x32_bf16 v[40:43], v[164:167], a[24:27], v[40:43]
  buffer_load_dwordx4 v4, s[12:15], s53 offen lds
  v_mfma_f32_16x16x32_bf16 v[44:47], v[164:167], a[28:31], 0
  v_mfma_f32_16x16x32_bf16 v[44:47], v[160:163], a[12:15], v[44:47]
  s_waitcnt lgkmcnt(4)
  v_mfma_f32_16x16x32_bf16 v[48:51], v[172:175], a[0:3], 0
  ds_read_b64_tr_b16 v[160:161], v10 offset:8192
  ds_read_b64_tr_b16 v[162:163], v10 offset:8704
  v_mfma_f32_16x16x32_bf16 v[48:51], v[176:179], a[16:19], v[48:51]
  s_cmp_eq_u32 s3, 7
  s_cselect_b32 s91, -8, 1
  v_lshl_add_u32 v3, s91, 7, v3
  s_add_u32 m0, s82, 81920
  v_mfma_f32_16x16x32_bf16 v[52:55], v[176:179], a[20:23], 0
  buffer_load_dwordx4 v3, s[8:11], s75 offen lds
  v_mfma_f32_16x16x32_bf16 v[52:55], v[172:175], a[4:7], v[52:55]
  v_mfma_f32_16x16x32_bf16 v[56:59], v[172:175], a[8:11], 0
  s_add_u32 m0, s82, 86016
  ds_read_b64_tr_b16 v[164:165], v10 offset:12288
  ds_read_b64_tr_b16 v[166:167], v10 offset:12800
  v_mfma_f32_16x16x32_bf16 v[56:59], v[176:179], a[24:27], v[56:59]
  buffer_load_dwordx4 v3, s[8:11], s76 offen lds
  v_mfma_f32_16x16x32_bf16 v[60:63], v[176:179], a[28:31], 0
  v_mfma_f32_16x16x32_bf16 v[60:63], v[172:175], a[12:15], v[60:63]
  s_waitcnt vmcnt(4) lgkmcnt(4)
  v_mfma_f32_16x16x32_bf16 v[64:67], v[184:187], a[0:3], 0
  s_barrier
  v_mfma_f32_16x16x32_bf16 v[64:67], v[188:191], a[16:19], v[64:67]
  ds_read_b64_tr_b16 v[172:173], v7 offset:32768
  ds_read_b64_tr_b16 v[174:175], v7 offset:33280
  v_mfma_f32_16x16x32_bf16 v[68:71], v[188:191], a[20:23], 0
  s_add_u32 m0, s82, 90112
  ds_read_b128 a[32:35], v13 offset:49152
  v_mfma_f32_16x16x32_bf16 v[68:71], v[184:187], a[4:7], v[68:71]
  buffer_load_dwordx4 v3, s[8:11], s77 offen lds
  v_mfma_f32_16x16x32_bf16 v[72:75], v[184:187], a[8:11], 0
  s_add_u32 m0, s82, 94208
  ds_read_b64_tr_b16 v[176:177], v7 offset:36864
  ds_read_b64_tr_b16 v[178:179], v7 offset:37376
  v_mfma_f32_16x16x32_bf16 v[72:75], v[188:191], a[24:27], v[72:75]
  buffer_load_dwordx4 v3, s[8:11], s78 offen lds
  v_mfma_f32_16x16x32_bf16 v[76:79], v[188:191], a[28:31], 0
  ds_read_b128 a[36:39], v13 offset:51200
  v_mfma_f32_16x16x32_bf16 v[76:79], v[184:187], a[12:15], v[76:79]
  s_waitcnt lgkmcnt(6)
  v_mfma_f32_16x16x32_bf16 v[80:83], v[160:163], a[0:3], 0
  ds_read_b64_tr_b16 v[184:185], v10 offset:32768
  ds_read_b64_tr_b16 v[186:187], v10 offset:33280
  v_mfma_f32_16x16x32_bf16 v[80:83], v[164:167], a[16:19], v[80:83]
  s_add_u32 m0, s82, 73728
  ds_read_b128 a[48:51], v16 offset:49152
  v_mfma_f32_16x16x32_bf16 v[84:87], v[164:167], a[20:23], 0
  buffer_load_dwordx4 v4, s[16:19], s52 offen lds
  v_mfma_f32_16x16x32_bf16 v[84:87], v[160:163], a[4:7], v[84:87]
  ds_read_b128 a[52:55], v16 offset:51200
  v_mfma_f32_16x16x32_bf16 v[88:91], v[160:163], a[8:11], 0
  s_add_u32 m0, s82, 77824
  v_mfma_f32_16x16x32_bf16 v[88:91], v[164:167], a[24:27], v[88:91]
  buffer_load_dwordx4 v4, s[16:19], s53 offen lds
  v_mfma_f32_16x16x32_bf16 v[92:95], v[164:167], a[28:31], 0
  ds_read_b128 a[40:43], v13 offset:53248
  v_lshlrev_b32 v180, 16, v112
  v_mfma_f32_16x16x32_bf16 v[92:95], v[160:163], a[12:15], v[92:95]
  s_add_u32 m0, s82, 98304
  ds_read_b64_tr_b16 v[188:189], v10 offset:36864
  ds_read_b64_tr_b16 v[190:191], v10 offset:37376
  v_mfma_f32_16x16x32_bf16 v[96:99], a[0:3], v[128:131], 0
  buffer_load_dwordx4 v4, s[12:15], s54 offen lds
  v_mfma_f32_16x16x32_bf16 v[96:99], a[16:19], v[132:135], v[96:99]
  s_add_u32 m0, s82, 102400
  ds_read_b128 a[44:47], v13 offset:55296
  v_lshlrev_b32 v181, 16, v120
  v_mfma_f32_16x16x32_bf16 v[100:103], a[4:7], v[128:131], 0
  buffer_load_dwordx4 v4, s[12:15], s55 offen lds
  ds_read_b128 a[56:59], v16 offset:53248
  ds_read_b128 a[60:63], v16 offset:55296
  v_mfma_f32_16x16x32_bf16 v[100:103], a[20:23], v[132:135], v[100:103]
  v_and_b32 v182, 0xffff0000, v112
  v_and_b32 v183, 0xffff0000, v120
  v_mfma_f32_16x16x32_bf16 v[104:107], a[8:11], v[128:131], 0
  v_mul_f32 v180, v180, v181
  v_mul_f32 v182, v182, v183
  s_cmp_eq_u32 s3, 6
  s_cselect_b32 s91, -8, 1
  v_lshl_add_u32 v3, s91, 7, v3
  s_add_u32 m0, s82, 114688
  v_mfma_f32_16x16x32_bf16 v[104:107], a[24:27], v[132:135], v[104:107]
  buffer_load_dwordx4 v3, s[8:11], s75 offen lds
  v_mfma_f32_16x16x32_bf16 v[108:111], a[12:15], v[128:131], 0
  v_cvt_pk_bf16_f32 v180, v180, v182
  v_lshlrev_b32 v181, 16, v180
  v_mfma_f32_16x16x32_bf16 v[108:111], a[28:31], v[132:135], v[108:111]
  s_waitcnt lgkmcnt(0)
  v_and_b32 v180, 0xffff0000, v180
  v_add_f32 v170, v181, v180
  v_mfma_f32_16x16x32_bf16 v[32:35], v[172:175], a[32:35], v[32:35]
  ds_read_b64_tr_b16 v[160:161], v7 offset:40960
  ds_read_b64_tr_b16 v[162:163], v7 offset:41472
  v_mfma_f32_16x16x32_bf16 v[32:35], v[176:179], a[48:51], v[32:35]
  s_add_u32 m0, s82, 118784
  v_lshlrev_b32 v180, 16, v113
  v_lshlrev_b32 v181, 16, v121
  v_mfma_f32_16x16x32_bf16 v[36:39], v[176:179], a[52:55], v[36:39]
  buffer_load_dwordx4 v3, s[8:11], s76 offen lds
  v_mfma_f32_16x16x32_bf16 v[36:39], v[172:175], a[36:39], v[36:39]
  v_and_b32 v182, 0xffff0000, v113
  v_and_b32 v183, 0xffff0000, v121
  v_mfma_f32_16x16x32_bf16 v[40:43], v[172:175], a[40:43], v[40:43]
  s_add_u32 m0, s82, 122880
  ds_read_b64_tr_b16 v[164:165], v7 offset:45056
  ds_read_b64_tr_b16 v[166:167], v7 offset:45568
  v_mfma_f32_16x16x32_bf16 v[40:43], v[176:179], a[56:59], v[40:43]
  buffer_load_dwordx4 v3, s[8:11], s77 offen lds
  v_mfma_f32_16x16x32_bf16 v[44:47], v[176:179], a[60:63], v[44:47]
  v_mul_f32 v180, v180, v181
  v_mul_f32 v182, v182, v183
  v_mfma_f32_16x16x32_bf16 v[44:47], v[172:175], a[44:47], v[44:47]
  v_cvt_pk_bf16_f32 v180, v180, v182
  v_lshlrev_b32 v181, 16, v180
  v_mfma_f32_16x16x32_bf16 v[48:51], v[184:187], a[32:35], v[48:51]
  ds_read_b64_tr_b16 v[172:173], v10 offset:40960
  ds_read_b64_tr_b16 v[174:175], v10 offset:41472
  v_mfma_f32_16x16x32_bf16 v[48:51], v[188:191], a[48:51], v[48:51]
  s_add_u32 m0, s82, 126976
  v_and_b32 v180, 0xffff0000, v180
  v_add_f32 v170, v170, v181
  v_mfma_f32_16x16x32_bf16 v[52:55], v[188:191], a[52:55], v[52:55]
  buffer_load_dwordx4 v3, s[8:11], s78 offen lds
  v_mfma_f32_16x16x32_bf16 v[52:55], v[184:187], a[36:39], v[52:55]
  v_add_f32 v170, v170, v180
  v_lshlrev_b32 v180, 16, v114
  v_mfma_f32_16x16x32_bf16 v[56:59], v[184:187], a[40:43], v[56:59]
  s_add_u32 m0, s82, 106496
  ds_read_b64_tr_b16 v[176:177], v10 offset:45056
  ds_read_b64_tr_b16 v[178:179], v10 offset:45568
  v_mfma_f32_16x16x32_bf16 v[56:59], v[188:191], a[56:59], v[56:59]
  buffer_load_dwordx4 v4, s[16:19], s54 offen lds
  v_mfma_f32_16x16x32_bf16 v[60:63], v[188:191], a[60:63], v[60:63]
  v_lshlrev_b32 v181, 16, v122
  v_and_b32 v182, 0xffff0000, v114
  v_mfma_f32_16x16x32_bf16 v[60:63], v[184:187], a[44:47], v[60:63]
  s_waitcnt vmcnt(7) lgkmcnt(4)
  v_and_b32 v183, 0xffff0000, v122
  v_mul_f32 v180, v180, v181
  v_mfma_f32_16x16x32_bf16 v[64:67], v[160:163], a[32:35], v[64:67]
  s_barrier
  v_mfma_f32_16x16x32_bf16 v[64:67], v[164:167], a[48:51], v[64:67]
  ds_read_b64_tr_b16 v[184:185], v8 offset:0
  ds_read_b64_tr_b16 v[186:187], v8 offset:512
  v_mfma_f32_16x16x32_bf16 v[68:71], v[164:167], a[52:55], v[68:71]
  s_add_u32 m0, s82, 110592
  ds_read_b128 a[64:67], v14 offset:16384
  v_mul_f32 v182, v182, v183
  v_mfma_f32_16x16x32_bf16 v[68:71], v[160:163], a[36:39], v[68:71]
  buffer_load_dwordx4 v4, s[16:19], s55 offen lds
  v_mfma_f32_16x16x32_bf16 v[72:75], v[160:163], a[40:43], v[72:75]
  s_add_u32 m0, s82, 131072
  ds_read_b64_tr_b16 v[188:189], v8 offset:4096
  ds_read_b64_tr_b16 v[190:191], v8 offset:4608
  v_mfma_f32_16x16x32_bf16 v[72:75], v[164:167], a[56:59], v[72:75]
  buffer_load_dwordx4 v4, s[12:15], s56 offen lds
  v_mfma_f32_16x16x32_bf16 v[76:79], v[164:167], a[60:63], v[76:79]
  ds_read_b128 a[68:71], v14 offset:18432
  v_cvt_pk_bf16_f32 v180, v180, v182
  v_mfma_f32_16x16x32_bf16 v[76:79], v[160:163], a[44:47], v[76:79]
  v_lshlrev_b32 v181, 16, v180
  v_and_b32 v180, 0xffff0000, v180
  s_cmp_lg_u32 s2, 0
  s_cbranch_scc0 L_ozf_gated_mix__spectral_gfnet__swiglu_ffn__prompt_kernel
L_zf_gated_mix__spectral_gfnet__swiglu_ffn__prompt_kernel:
  s_waitcnt lgkmcnt(6)
  v_mfma_f32_16x16x32_bf16 v[80:83], v[172:175], a[32:35], v[80:83]
  ds_read_b64_tr_b16 v[160:161], v11 offset:0
  ds_read_b64_tr_b16 v[162:163], v11 offset:512
  v_mfma_f32_16x16x32_bf16 v[80:83], v[176:179], a[48:51], v[80:83]
  s_add_u32 m0, s82, 135168
  ds_read_b128 a[80:83], v17 offset:16384
  v_add_f32 v170, v170, v181
  v_mfma_f32_16x16x32_bf16 v[84:87], v[176:179], a[52:55], v[84:87]
  buffer_load_dwordx4 v4, s[12:15], s57 offen lds
  v_mfma_f32_16x16x32_bf16 v[84:87], v[172:175], a[36:39], v[84:87]
  ds_read_b128 a[84:87], v17 offset:18432
  v_add_f32 v170, v170, v180
  v_mfma_f32_16x16x32_bf16 v[88:91], v[172:175], a[40:43], v[88:91]
  v_lshlrev_b32 v180, 16, v115
  v_lshlrev_b32 v181, 16, v123
  s_cmp_eq_u32 s3, 5
  s_cselect_b32 s91, -8, 1
  v_lshl_add_u32 v3, s91, 7, v3
  s_add_u32 m0, s82, 147456
  v_mfma_f32_16x16x32_bf16 v[88:91], v[176:179], a[56:59], v[88:91]
  buffer_load_dwordx4 v3, s[8:11], s75 offen lds
  v_mfma_f32_16x16x32_bf16 v[92:95], v[176:179], a[60:63], v[92:95]
  ds_read_b128 a[72:75], v14 offset:20480
  v_and_b32 v182, 0xffff0000, v115
  v_mfma_f32_16x16x32_bf16 v[92:95], v[172:175], a[44:47], v[92:95]
  s_add_u32 m0, s82, 151552
  ds_read_b64_tr_b16 v[164:165], v11 offset:4096
  ds_read_b64_tr_b16 v[166:167], v11 offset:4608
  v_mfma_f32_16x16x32_bf16 v[96:99], a[32:35], v[136:139], v[96:99]
  buffer_load_dwordx4 v3, s[8:11], s76 offen lds
  v_mfma_f32_16x16x32_bf16 v[96:99], a[48:51], v[140:143], v[96:99]
  s_add_u32 m0, s82, 155648
  ds_read_b128 a[76:79], v14 offset:22528
  v_and_b32 v183, 0xffff0000, v123
  v_mfma_f32_16x16x32_bf16 v[100:103], a[36:39], v[136:139], v[100:103]
  buffer_load_dwordx4 v3, s[8:11], s77 offen lds
  ds_read_b128 a[88:91], v17 offset:20480
  ds_read_b128 a[92:95], v17 offset:22528
  v_mfma_f32_16x16x32_bf16 v[100:103], a[52:55], v[140:143], v[100:103]
  v_mul_f32 v180, v180, v181
  v_mul_f32 v182, v182, v183
  v_mfma_f32_16x16x32_bf16 v[104:107], a[40:43], v[136:139], v[104:107]
  s_add_u32 m0, s82, 159744
  v_cvt_pk_bf16_f32 v180, v180, v182
  v_lshlrev_b32 v181, 16, v180
  v_mfma_f32_16x16x32_bf16 v[104:107], a[56:59], v[140:143], v[104:107]
  buffer_load_dwordx4 v3, s[8:11], s78 offen lds
  v_mfma_f32_16x16x32_bf16 v[108:111], a[44:47], v[136:139], v[108:111]
  v_and_b32 v180, 0xffff0000, v180
  v_add_f32 v170, v170, v181
  v_mfma_f32_16x16x32_bf16 v[108:111], a[60:63], v[140:143], v[108:111]
  s_waitcnt lgkmcnt(0)
  v_add_f32 v170, v170, v180
  v_lshlrev_b32 v180, 16, v116
  v_mfma_f32_16x16x32_bf16 v[32:35], v[184:187], a[64:67], v[32:35]
  ds_read_b64_tr_b16 v[172:173], v8 offset:8192
  ds_read_b64_tr_b16 v[174:175], v8 offset:8704
  v_mfma_f32_16x16x32_bf16 v[32:35], v[188:191], a[80:83], v[32:35]
  s_add_u32 m0, s82, 139264
  v_lshlrev_b32 v181, 16, v124
  v_and_b32 v182, 0xffff0000, v116
  v_mfma_f32_16x16x32_bf16 v[36:39], v[188:191], a[84:87], v[36:39]
  buffer_load_dwordx4 v4, s[16:19], s56 offen lds
  v_mfma_f32_16x16x32_bf16 v[36:39], v[184:187], a[68:71], v[36:39]
  v_and_b32 v183, 0xffff0000, v124
  v_mul_f32 v180, v180, v181
  v_mfma_f32_16x16x32_bf16 v[40:43], v[184:187], a[72:75], v[40:43]
  s_add_u32 m0, s82, 143360
  ds_read_b64_tr_b16 v[176:177], v8 offset:12288
  ds_read_b64_tr_b16 v[178:179], v8 offset:12800
  v_mfma_f32_16x16x32_bf16 v[40:43], v[188:191], a[88:91], v[40:43]
  buffer_load_dwordx4 v4, s[16:19], s57 offen lds
  v_mfma_f32_16x16x32_bf16 v[44:47], v[188:191], a[92:95], v[44:47]
  v_mul_f32 v182, v182, v183
  v_cvt_pk_bf16_f32 v180, v180, v182
  v_mfma_f32_16x16x32_bf16 v[44:47], v[184:187], a[76:79], v[44:47]
  v_lshlrev_b32 v181, 16, v180
  v_and_b32 v180, 0xffff0000, v180
  v_mfma_f32_16x16x32_bf16 v[48:51], v[160:163], a[64:67], v[48:51]
  ds_read_b64_tr_b16 v[184:185], v11 offset:8192
  ds_read_b64_tr_b16 v[186:187], v11 offset:8704
  v_mfma_f32_16x16x32_bf16 v[48:51], v[164:167], a[80:83], v[48:51]
  s_add_u32 m0, s82, 0
  v_add_f32 v170, v170, v181
  v_add_f32 v170, v170, v180
  v_mfma_f32_16x16x32_bf16 v[52:55], v[164:167], a[84:87], v[52:55]
  buffer_load_dwordx4 v4, s[12:15], s58 offen lds
  v_mfma_f32_16x16x32_bf16 v[52:55], v[160:163], a[68:71], v[52:55]
  v_lshlrev_b32 v180, 16, v117
  v_lshlrev_b32 v181, 16, v125
  v_mfma_f32_16x16x32_bf16 v[56:59], v[160:163], a[72:75], v[56:59]
  s_add_u32 m0, s82, 4096
  ds_read_b64_tr_b16 v[188:189], v11 offset:12288
  ds_read_b64_tr_b16 v[190:191], v11 offset:12800
  v_mfma_f32_16x16x32_bf16 v[56:59], v[164:167], a[88:91], v[56:59]
  buffer_load_dwordx4 v4, s[12:15], s59 offen lds
  v_mfma_f32_16x16x32_bf16 v[60:63], v[164:167], a[92:95], v[60:63]
  v_and_b32 v182, 0xffff0000, v117
  v_and_b32 v183, 0xffff0000, v125
  v_mfma_f32_16x16x32_bf16 v[60:63], v[160:163], a[76:79], v[60:63]
  s_waitcnt vmcnt(10) lgkmcnt(4)
  v_mul_f32 v180, v180, v181
  v_mul_f32 v182, v182, v183
  v_mfma_f32_16x16x32_bf16 v[64:67], v[172:175], a[64:67], v[64:67]
  s_barrier
  v_mfma_f32_16x16x32_bf16 v[64:67], v[176:179], a[80:83], v[64:67]
  ds_read_b64_tr_b16 v[160:161], v8 offset:32768
  ds_read_b64_tr_b16 v[162:163], v8 offset:33280
  v_mfma_f32_16x16x32_bf16 v[68:71], v[176:179], a[84:87], v[68:71]
  ds_read_b128 a[96:99], v14 offset:49152
  v_cvt_pk_bf16_f32 v180, v180, v182
  s_cmp_eq_u32 s3, 4
  s_cselect_b32 s91, -8, 1
  v_lshl_add_u32 v3, s91, 7, v3
  s_add_u32 m0, s82, 16384
  v_mfma_f32_16x16x32_bf16 v[68:71], v[172:175], a[68:71], v[68:71]
  buffer_load_dwordx4 v3, s[8:11], s75 offen lds
  v_mfma_f32_16x16x32_bf16 v[72:75], v[172:175], a[72:75], v[72:75]
  s_add_u32 m0, s82, 20480
  ds_read_b64_tr_b16 v[164:165], v8 offset:36864
  ds_read_b64_tr_b16 v[166:167], v8 offset:37376
  v_mfma_f32_16x16x32_bf16 v[72:75], v[176:179], a[88:91], v[72:75]
  buffer_load_dwordx4 v3, s[8:11], s76 offen lds
  v_mfma_f32_16x16x32_bf16 v[76:79], v[176:179], a[92:95], v[76:79]
  ds_read_b128 a[100:103], v14 offset:51200
  v_lshlrev_b32 v181, 16, v180
  v_mfma_f32_16x16x32_bf16 v[76:79], v[172:175], a[76:79], v[76:79]
  s_waitcnt lgkmcnt(6)
  v_and_b32 v180, 0xffff0000, v180
  v_add_f32 v170, v170, v181
  v_mfma_f32_16x16x32_bf16 v[80:83], v[184:187], a[64:67], v[80:83]
  ds_read_b64_tr_b16 v[172:173], v11 offset:32768
  ds_read_b64_tr_b16 v[174:175], v11 offset:33280
  v_mfma_f32_16x16x32_bf16 v[80:83], v[188:191], a[80:83], v[80:83]
  s_add_u32 m0, s82, 24576
  ds_read_b128 a[112:115], v17 offset:49152
  v_add_f32 v170, v170, v180
  v_mfma_f32_16x16x32_bf16 v[84:87], v[188:191], a[84:87], v[84:87]
  buffer_load_dwordx4 v3, s[8:11], s77 offen lds
  v_mfma_f32_16x16x32_bf16 v[84:87], v[184:187], a[68:71], v[84:87]
  ds_read_b128 a[116:119], v17 offset:51200
  v_lshlrev_b32 v180, 16, v118
  v_mfma_f32_16x16x32_bf16 v[88:91], v[184:187], a[72:75], v[88:91]
  s_add_u32 m0, s82, 28672
  v_lshlrev_b32 v181, 16, v126
  v_and_b32 v182, 0xffff0000, v118
  v_mfma_f32_16x16x32_bf16 v[88:91], v[188:191], a[88:91], v[88:91]
  buffer_load_dwordx4 v3, s[8:11], s78 offen lds
  v_mfma_f32_16x16x32_bf16 v[92:95], v[188:191], a[92:95], v[92:95]
  ds_read_b128 a[104:107], v14 offset:53248
  v_and_b32 v183, 0xffff0000, v126
  v_mfma_f32_16x16x32_bf16 v[92:95], v[184:187], a[76:79], v[92:95]
  s_add_u32 m0, s82, 8192
  ds_read_b64_tr_b16 v[176:177], v11 offset:36864
  ds_read_b64_tr_b16 v[178:179], v11 offset:37376
  v_mfma_f32_16x16x32_bf16 v[96:99], a[64:67], v[144:147], v[96:99]
  buffer_load_dwordx4 v4, s[16:19], s58 offen lds
  v_mfma_f32_16x16x32_bf16 v[96:99], a[80:83], v[148:151], v[96:99]
  s_add_u32 m0, s82, 12288
  ds_read_b128 a[108:111], v14 offset:55296
  v_mul_f32 v180, v180, v181
  v_mfma_f32_16x16x32_bf16 v[100:103], a[68:71], v[144:147], v[100:103]
  buffer_load_dwordx4 v4, s[16:19], s59 offen lds
  ds_read_b128 a[120:123], v17 offset:53248
  ds_read_b128 a[124:127], v17 offset:55296
  v_mfma_f32_16x16x32_bf16 v[100:103], a[84:87], v[148:151], v[100:103]
  v_mul_f32 v182, v182, v183
  v_cvt_pk_bf16_f32 v180, v180, v182
  v_mfma_f32_16x16x32_bf16 v[104:107], a[72:75], v[144:147], v[104:107]
  s_add_u32 m0, s82, 32768
  v_lshlrev_b32 v181, 16, v180
  v_and_b32 v180, 0xffff0000, v180
  v_mfma_f32_16x16x32_bf16 v[104:107], a[88:91], v[148:151], v[104:107]
  buffer_load_dwordx4 v4, s[12:15], s60 offen lds
  v_mfma_f32_16x16x32_bf16 v[108:111], a[76:79], v[144:147], v[108:111]
  v_add_f32 v170, v170, v181
  v_add_f32 v170, v170, v180
  v_mfma_f32_16x16x32_bf16 v[108:111], a[92:95], v[148:151], v[108:111]
  s_waitcnt lgkmcnt(0)
  v_lshlrev_b32 v180, 16, v119
  v_lshlrev_b32 v181, 16, v127
  v_mfma_f32_16x16x32_bf16 v[32:35], v[160:163], a[96:99], v[32:35]
  ds_read_b64_tr_b16 v[184:185], v8 offset:40960
  ds_read_b64_tr_b16 v[186:187], v8 offset:41472
  v_mfma_f32_16x16x32_bf16 v[32:35], v[164:167], a[112:115], v[32:35]
  s_add_u32 m0, s82, 36864
  v_and_b32 v182, 0xffff0000, v119
  v_and_b32 v183, 0xffff0000, v127
  v_mfma_f32_16x16x32_bf16 v[36:39], v[164:167], a[116:119], v[36:39]
  buffer_load_dwordx4 v4, s[12:15], s61 offen lds
  v_mfma_f32_16x16x32_bf16 v[36:39], v[160:163], a[100:103], v[36:39]
  v_mul_f32 v180, v180, v181
  v_mul_f32 v182, v182, v183
  v_mfma_f32_16x16x32_bf16 v[40:43], v[160:163], a[104:107], v[40:43]
  ds_read_b64_tr_b16 v[188:189], v8 offset:45056
  ds_read_b64_tr_b16 v[190:191], v8 offset:45568
  s_cmp_eq_u32 s3, 3
  s_cselect_b32 s91, -8, 1
  v_lshl_add_u32 v3, s91, 7, v3
  s_add_u32 m0, s82, 49152
  v_mfma_f32_16x16x32_bf16 v[40:43], v[164:167], a[120:123], v[40:43]
  buffer_load_dwordx4 v3, s[8:11], s75 offen lds
  v_mfma_f32_16x16x32_bf16 v[44:47], v[164:167], a[124:127], v[44:47]
  v_cvt_pk_bf16_f32 v180, v180, v182
  v_lshlrev_b32 v181, 16, v180
  v_mfma_f32_16x16x32_bf16 v[44:47], v[160:163], a[108:111], v[44:47]
  v_and_b32 v180, 0xffff0000, v180
  v_add_f32 v170, v170, v181
  v_mfma_f32_16x16x32_bf16 v[48:51], v[172:175], a[96:99], v[48:51]
  ds_read_b64_tr_b16 v[160:161], v11 offset:40960
  ds_read_b64_tr_b16 v[162:163], v11 offset:41472
  v_mfma_f32_16x16x32_bf16 v[48:51], v[176:179], a[112:115], v[48:51]
  s_add_u32 m0, s82, 53248
  v_add_f32 v170, v170, v180
  v_lshlrev_b32 v180, 16, v168
  v_mfma_f32_16x16x32_bf16 v[52:55], v[176:179], a[116:119], v[52:55]
  buffer_load_dwordx4 v3, s[8:11], s76 offen lds
  v_mfma_f32_16x16x32_bf16 v[52:55], v[172:175], a[100:103], v[52:55]
  v_lshlrev_b32 v181, 16, v169
  v_and_b32 v182, 0xffff0000, v168
  v_mfma_f32_16x16x32_bf16 v[56:59], v[172:175], a[104:107], v[56:59]
  s_add_u32 m0, s82, 57344
  ds_read_b64_tr_b16 v[164:165], v11 offset:45056
  ds_read_b64_tr_b16 v[166:167], v11 offset:45568
  v_mfma_f32_16x16x32_bf16 v[56:59], v[176:179], a[120:123], v[56:59]
  buffer_load_dwordx4 v3, s[8:11], s77 offen lds
  v_mfma_f32_16x16x32_bf16 v[60:63], v[176:179], a[124:127], v[60:63]
  v_and_b32 v183, 0xffff0000, v169
  v_mul_f32 v180, v180, v181
  v_mfma_f32_16x16x32_bf16 v[60:63], v[172:175], a[108:111], v[60:63]
  s_waitcnt vmcnt(13) lgkmcnt(4)
  v_mul_f32 v182, v182, v183
  v_cvt_pk_bf16_f32 v180, v180, v182
  v_mfma_f32_16x16x32_bf16 v[64:67], v[184:187], a[96:99], v[64:67]
  s_barrier
  v_mfma_f32_16x16x32_bf16 v[64:67], v[188:191], a[112:115], v[64:67]
  ds_read_b64_tr_b16 v[172:173], v9 offset:0
  ds_read_b64_tr_b16 v[174:175], v9 offset:512
  v_mfma_f32_16x16x32_bf16 v[68:71], v[188:191], a[116:119], v[68:71]
  s_add_u32 m0, s82, 61440
  ds_read_b128 a[128:131], v15 offset:16384
  v_lshlrev_b32 v181, 16, v180
  v_mfma_f32_16x16x32_bf16 v[68:71], v[184:187], a[100:103], v[68:71]
  buffer_load_dwordx4 v3, s[8:11], s78 offen lds
  v_mfma_f32_16x16x32_bf16 v[72:75], v[184:187], a[104:107], v[72:75]
  s_add_u32 m0, s82, 40960
  ds_read_b64_tr_b16 v[176:177], v9 offset:4096
  ds_read_b64_tr_b16 v[178:179], v9 offset:4608
  v_mfma_f32_16x16x32_bf16 v[72:75], v[188:191], a[120:123], v[72:75]
  buffer_load_dwordx4 v4, s[16:19], s60 offen lds
  v_mfma_f32_16x16x32_bf16 v[76:79], v[188:191], a[124:127], v[76:79]
  ds_read_b128 a[132:135], v15 offset:18432
  v_and_b32 v180, 0xffff0000, v180
  v_mfma_f32_16x16x32_bf16 v[76:79], v[184:187], a[108:111], v[76:79]
  s_waitcnt lgkmcnt(6)
  v_add_f32 v170, v170, v181
  v_add_f32 v170, v170, v180
  v_mfma_f32_16x16x32_bf16 v[80:83], v[160:163], a[96:99], v[80:83]
  ds_read_b64_tr_b16 v[184:185], v12 offset:0
  ds_read_b64_tr_b16 v[186:187], v12 offset:512
  v_mfma_f32_16x16x32_bf16 v[80:83], v[164:167], a[112:115], v[80:83]
  ds_read_b128 a[144:147], v18 offset:16384
  v_add_f32_dpp v170, v170, v170 row_ror:8 row_mask:0xf bank_mask:0xf
  v_mfma_f32_16x16x32_bf16 v[84:87], v[164:167], a[116:119], v[84:87]
  s_add_u32 m0, s82, 45056
  v_add_f32_dpp v170, v170, v170 row_ror:4 row_mask:0xf bank_mask:0xf
  s_nop 1
  v_add_f32_dpp v170, v170, v170 row_ror:2 row_mask:0xf bank_mask:0xf
  v_mfma_f32_16x16x32_bf16 v[84:87], v[160:163], a[100:103], v[84:87]
  buffer_load_dwordx4 v4, s[16:19], s61 offen lds
  v_mfma_f32_16x16x32_bf16 v[88:91], v[160:163], a[104:107], v[88:91]
  ds_read_b128 a[148:151], v18 offset:18432
  v_add_f32_dpp v170, v170, v170 row_ror:1 row_mask:0xf bank_mask:0xf
  v_mfma_f32_16x16x32_bf16 v[88:91], v[164:167], a[120:123], v[88:91]
  v_mov_b32 v180, v170
  v_and_b32 v181, 31, v0
  v_mfma_f32_16x16x32_bf16 v[92:95], v[164:167], a[124:127], v[92:95]
  ds_read_b128 a[136:139], v15 offset:20480
  v_cmp_eq_u32 vcc, 0, v181
  v_mfma_f32_16x16x32_bf16 v[92:95], v[160:163], a[108:111], v[92:95]
  s_add_u32 m0, s82, 65536
  ds_read_b64_tr_b16 v[188:189], v12 offset:4096
  ds_read_b64_tr_b16 v[190:191], v12 offset:4608
  v_mfma_f32_16x16x32_bf16 v[96:99], a[96:99], v[152:155], v[96:99]
  buffer_load_dwordx4 v4, s[12:15], s62 offen lds
  v_mfma_f32_16x16x32_bf16 v[96:99], a[112:115], v[156:159], v[96:99]
  ds_read_b128 a[140:143], v15 offset:22528
  v_mfma_f32_16x16x32_bf16 v[100:103], a[100:103], v[152:155], v[100:103]
  ds_read_b128 a[152:155], v18 offset:20480
  ds_read_b128 a[156:159], v18 offset:22528
  v_mfma_f32_16x16x32_bf16 v[100:103], a[116:119], v[156:159], v[100:103]
  s_add_u32 m0, s82, 69632
  v_permlane16_swap_b32 v170, v180
  v_mfma_f32_16x16x32_bf16 v[104:107], a[104:107], v[152:155], v[104:107]
  buffer_load_dwordx4 v4, s[12:15], s63 offen lds
  v_mfma_f32_16x16x32_bf16 v[104:107], a[120:123], v[156:159], v[104:107]
  v_add_f32 v170, v170, v180
  v_cvt_pk_bf16_f32 v170, v170, v170
  v_mfma_f32_16x16x32_bf16 v[108:111], a[108:111], v[152:155], v[108:111]
  v_lshlrev_b32 v170, 16, v170
  v_mul_f32 v170, s96, v170
  v_mfma_f32_16x16x32_bf16 v[108:111], a[124:127], v[156:159], v[108:111]
  s_waitcnt lgkmcnt(0)
  v_exp_f32 v170, v170
  v_mfma_f32_16x16x32_bf16 v[32:35], v[172:175], a[128:131], v[32:35]
  ds_read_b64_tr_b16 v[160:161], v9 offset:8192
  ds_read_b64_tr_b16 v[162:163], v9 offset:8704
  v_mfma_f32_16x16x32_bf16 v[32:35], v[176:179], a[144:147], v[32:35]
  v_lshlrev_b32 v171, 2, v171
  v_add_f32 v170, 1.0, v170
  s_cmp_eq_u32 s3, 2
  s_cselect_b32 s91, -8, 1
  v_lshl_add_u32 v3, s91, 7, v3
  s_add_u32 m0, s82, 81920
  v_mfma_f32_16x16x32_bf16 v[36:39], v[176:179], a[148:151], v[36:39]
  buffer_load_dwordx4 v3, s[8:11], s75 offen lds
  v_mfma_f32_16x16x32_bf16 v[36:39], v[172:175], a[132:135], v[36:39]
  v_rcp_f32 v170, v170
  v_mfma_f32_16x16x32_bf16 v[40:43], v[172:175], a[136:139], v[40:43]
  s_add_u32 m0, s82, 86016
  ds_read_b64_tr_b16 v[164:165], v9 offset:12288
  ds_read_b64_tr_b16 v[166:167], v9 offset:12800
  v_mfma_f32_16x16x32_bf16 v[40:43], v[176:179], a[152:155], v[40:43]
  buffer_load_dwordx4 v3, s[8:11], s76 offen lds
  v_mfma_f32_16x16x32_bf16 v[44:47], v[176:179], a[156:159], v[44:47]
  v_bfrev_b32 v181, 1
  v_cvt_pk_bf16_f32 v170, v170, v170
  v_mfma_f32_16x16x32_bf16 v[44:47], v[172:175], a[140:143], v[44:47]
  v_lshlrev_b32 v170, 16, v170
  v_sub_f32 v180, 1.0, v170
  v_mfma_f32_16x16x32_bf16 v[48:51], v[184:187], a[128:131], v[48:51]
  ds_read_b64_tr_b16 v[172:173], v12 offset:8192
  ds_read_b64_tr_b16 v[174:175], v12 offset:8704
  v_mfma_f32_16x16x32_bf16 v[48:51], v[188:191], a[144:147], v[48:51]
  s_add_u32 m0, s82, 90112
  v_cvt_pk_bf16_f32 v180, v180, v180
  v_lshlrev_b32 v180, 16, v180
  v_mfma_f32_16x16x32_bf16 v[52:55], v[188:191], a[148:151], v[52:55]
  buffer_load_dwordx4 v3, s[8:11], s77 offen lds
  v_mfma_f32_16x16x32_bf16 v[52:55], v[184:187], a[132:135], v[52:55]
  v_cndmask_b32 v171, v181, v171, vcc
  v_mfma_f32_16x16x32_bf16 v[56:59], v[184:187], a[136:139], v[56:59]
  s_add_u32 m0, s82, 94208
  ds_read_b64_tr_b16 v[176:177], v12 offset:12288
  ds_read_b64_tr_b16 v[178:179], v12 offset:12800
  v_mfma_f32_16x16x32_bf16 v[56:59], v[188:191], a[152:155], v[56:59]
  buffer_load_dwordx4 v3, s[8:11], s78 offen lds
  v_mfma_f32_16x16x32_bf16 v[60:63], v[188:191], a[156:159], v[60:63]
  s_lshl_b32 s6, s79, 9
  v_mfma_f32_16x16x32_bf16 v[60:63], v[184:187], a[140:143], v[60:63]
  s_waitcnt vmcnt(14) lgkmcnt(4)
  v_mfma_f32_16x16x32_bf16 v[64:67], v[160:163], a[128:131], v[64:67]
  s_barrier
  v_mfma_f32_16x16x32_bf16 v[64:67], v[164:167], a[144:147], v[64:67]
  s_add_u32 s6, s6, 6291456
  ds_read_b64_tr_b16 v[184:185], v7 offset:0
  ds_read_b64_tr_b16 v[186:187], v7 offset:512
  v_mfma_f32_16x16x32_bf16 v[68:71], v[164:167], a[148:151], v[68:71]
  s_add_u32 m0, s82, 73728
  ds_read_b128 a[160:163], v13 offset:16384
  v_mfma_f32_16x16x32_bf16 v[68:71], v[160:163], a[132:135], v[68:71]
  buffer_load_dwordx4 v4, s[16:19], s62 offen lds
  v_mfma_f32_16x16x32_bf16 v[72:75], v[160:163], a[136:139], v[72:75]
  s_add_u32 m0, s82, 77824
  ds_read_b64_tr_b16 v[188:189], v7 offset:4096
  ds_read_b64_tr_b16 v[190:191], v7 offset:4608
  v_mfma_f32_16x16x32_bf16 v[72:75], v[164:167], a[152:155], v[72:75]
  buffer_load_dwordx4 v4, s[16:19], s63 offen lds
  v_mfma_f32_16x16x32_bf16 v[76:79], v[164:167], a[156:159], v[76:79]
  ds_read_b128 a[164:167], v13 offset:18432
  v_mfma_f32_16x16x32_bf16 v[76:79], v[160:163], a[140:143], v[76:79]
  s_waitcnt lgkmcnt(6)
  v_mfma_f32_16x16x32_bf16 v[80:83], v[172:175], a[128:131], v[80:83]
  s_add_u32 s7, s6, 8192
  ds_read_b64_tr_b16 v[160:161], v10 offset:0
  ds_read_b64_tr_b16 v[162:163], v10 offset:512
  v_mfma_f32_16x16x32_bf16 v[80:83], v[176:179], a[144:147], v[80:83]
  ds_read_b128 a[176:179], v16 offset:16384
  v_mfma_f32_16x16x32_bf16 v[84:87], v[176:179], a[148:151], v[84:87]
  buffer_store_dword v170, v171, s[24:27], s6 offen sc1
  v_mfma_f32_16x16x32_bf16 v[84:87], v[172:175], a[132:135], v[84:87]
  s_add_u32 m0, s82, 98304
  ds_read_b128 a[180:183], v16 offset:18432
  v_mfma_f32_16x16x32_bf16 v[88:91], v[172:175], a[136:139], v[88:91]
  buffer_load_dwordx4 v4, s[12:15], s64 offen lds
  v_mfma_f32_16x16x32_bf16 v[88:91], v[176:179], a[152:155], v[88:91]
  ds_read_b128 a[168:171], v13 offset:20480
  v_mfma_f32_16x16x32_bf16 v[92:95], v[176:179], a[156:159], v[92:95]
  buffer_store_dword v180, v171, s[24:27], s7 offen sc1
  v_mfma_f32_16x16x32_bf16 v[92:95], v[172:175], a[140:143], v[92:95]
  ds_read_b128 a[172:175], v13 offset:22528
  v_mfma_f32_16x16x32_bf16 v[96:99], a[128:131], v[192:195], v[96:99]
  ds_read_b64_tr_b16 v[164:165], v10 offset:4096
  ds_read_b64_tr_b16 v[166:167], v10 offset:4608
  v_mfma_f32_16x16x32_bf16 v[112:115], a[144:147], v[128:131], 0
  ds_read_b128 a[184:187], v16 offset:20480
  v_mfma_f32_16x16x32_bf16 v[100:103], a[132:135], v[192:195], v[100:103]
  s_add_u32 m0, s82, 102400
  ds_read_b128 a[188:191], v16 offset:22528
  v_mfma_f32_16x16x32_bf16 v[116:119], a[148:151], v[128:131], 0
  buffer_load_dwordx4 v4, s[12:15], s65 offen lds
  v_mfma_f32_16x16x32_bf16 v[104:107], a[136:139], v[192:195], v[104:107]
  v_mfma_f32_16x16x32_bf16 v[120:123], a[152:155], v[128:131], 0
  v_mfma_f32_16x16x32_bf16 v[108:111], a[140:143], v[192:195], v[108:111]
  v_mfma_f32_16x16x32_bf16 v[124:127], a[156:159], v[128:131], 0
  s_cmp_lg_u32 s80, 0
  s_cbranch_scc0 L_onw2_gated_mix__spectral_gfnet__swiglu_ffn__prompt_kernel
L_nw2_gated_mix__spectral_gfnet__swiglu_ffn__prompt_kernel:
  s_waitcnt lgkmcnt(0)
  v_mfma_f32_16x16x32_bf16 v[32:35], v[184:187], a[160:163], v[32:35]
  ds_read_b64_tr_b16 v[172:173], v7 offset:8192
  ds_read_b64_tr_b16 v[174:175], v7 offset:8704
  v_mfma_f32_16x16x32_bf16 v[32:35], v[188:191], a[176:179], v[32:35]
  s_cmp_eq_u32 s3, 1
  s_cselect_b32 s91, -8, 1
  v_lshl_add_u32 v3, s91, 7, v3
  s_add_u32 m0, s82, 114688
  v_mfma_f32_16x16x32_bf16 v[36:39], v[188:191], a[180:183], v[36:39]
  buffer_load_dwordx4 v3, s[8:11], s75 offen lds
  v_mfma_f32_16x16x32_bf16 v[36:39], v[184:187], a[164:167], v[36:39]
  v_mfma_f32_16x16x32_bf16 v[40:43], v[184:187], a[168:171], v[40:43]
  s_add_u32 m0, s82, 118784
  ds_read_b64_tr_b16 v[176:177], v7 offset:12288
  ds_read_b64_tr_b16 v[178:179], v7 offset:12800
  v_mfma_f32_16x16x32_bf16 v[40:43], v[188:191], a[184:187], v[40:43]
  buffer_load_dwordx4 v3, s[8:11], s76 offen lds
  v_mfma_f32_16x16x32_bf16 v[44:47], v[188:191], a[188:191], v[44:47]
  v_mfma_f32_16x16x32_bf16 v[44:47], v[184:187], a[172:175], v[44:47]
  v_mfma_f32_16x16x32_bf16 v[48:51], v[160:163], a[160:163], v[48:51]
  ds_read_b64_tr_b16 v[184:185], v10 offset:8192
  ds_read_b64_tr_b16 v[186:187], v10 offset:8704
  v_mfma_f32_16x16x32_bf16 v[48:51], v[164:167], a[176:179], v[48:51]
  s_add_u32 m0, s82, 122880
  v_mfma_f32_16x16x32_bf16 v[52:55], v[164:167], a[180:183], v[52:55]
  buffer_load_dwordx4 v3, s[8:11], s77 offen lds
  v_mfma_f32_16x16x32_bf16 v[52:55], v[160:163], a[164:167], v[52:55]
  v_mfma_f32_16x16x32_bf16 v[56:59], v[160:163], a[168:171], v[56:59]
  s_add_u32 m0, s82, 126976
  ds_read_b64_tr_b16 v[188:189], v10 offset:12288
  ds_read_b64_tr_b16 v[190:191], v10 offset:12800
  v_mfma_f32_16x16x32_bf16 v[56:59], v[164:167], a[184:187], v[56:59]
  buffer_load_dwordx4 v3, s[8:11], s78 offen lds
  v_mfma_f32_16x16x32_bf16 v[60:63], v[164:167], a[188:191], v[60:63]
  v_mfma_f32_16x16x32_bf16 v[60:63], v[160:163], a[172:175], v[60:63]
  s_waitcnt vmcnt(16) lgkmcnt(4)
  v_mfma_f32_16x16x32_bf16 v[64:67], v[172:175], a[160:163], v[64:67]
  s_barrier
  v_mfma_f32_16x16x32_bf16 v[64:67], v[176:179], a[176:179], v[64:67]
  ds_read_b64_tr_b16 v[160:161], v7 offset:32768
  ds_read_b64_tr_b16 v[162:163], v7 offset:33280
  v_mfma_f32_16x16x32_bf16 v[68:71], v[176:179], a[180:183], v[68:71]
  s_add_u32 m0, s82, 106496
  ds_read_b128 a[192:195], v13 offset:49152
  v_mfma_f32_16x16x32_bf16 v[68:71], v[172:175], a[164:167], v[68:71]
  buffer_load_dwordx4 v4, s[16:19], s64 offen lds
  v_mfma_f32_16x16x32_bf16 v[72:75], v[172:175], a[168:171], v[72:75]
  s_add_u32 m0, s82, 110592
  ds_read_b64_tr_b16 v[164:165], v7 offset:36864
  ds_read_b64_tr_b16 v[166:167], v7 offset:37376
  v_mfma_f32_16x16x32_bf16 v[72:75], v[176:179], a[184:187], v[72:75]
  buffer_load_dwordx4 v4, s[16:19], s65 offen lds
  v_mfma_f32_16x16x32_bf16 v[76:79], v[176:179], a[188:191], v[76:79]
  ds_read_b128 a[196:199], v13 offset:51200
  v_mfma_f32_16x16x32_bf16 v[76:79], v[172:175], a[172:175], v[76:79]
  s_waitcnt lgkmcnt(6)
  v_mfma_f32_16x16x32_bf16 v[80:83], v[184:187], a[160:163], v[80:83]
  ds_read_b64_tr_b16 v[172:173], v10 offset:32768
  ds_read_b64_tr_b16 v[174:175], v10 offset:33280
  v_mfma_f32_16x16x32_bf16 v[80:83], v[188:191], a[176:179], v[80:83]
  s_add_u32 m0, s82, 159616
  ds_read_b128 a[208:211], v16 offset:49152
  v_mfma_f32_16x16x32_bf16 v[84:87], v[188:191], a[180:183], v[84:87]
  buffer_load_dwordx4 v4, s[12:15], s48 offen offset:128 lds
  v_mfma_f32_16x16x32_bf16 v[84:87], v[184:187], a[164:167], v[84:87]
  ds_read_b128 a[212:215], v16 offset:51200
  v_mfma_f32_16x16x32_bf16 v[88:91], v[184:187], a[168:171], v[88:91]
  s_add_u32 m0, s82, 155520
  v_mfma_f32_16x16x32_bf16 v[88:91], v[188:191], a[184:187], v[88:91]
  buffer_load_dwordx4 v4, s[12:15], s49 offen offset:128 lds
  v_mfma_f32_16x16x32_bf16 v[92:95], v[188:191], a[188:191], v[92:95]
  ds_read_b128 a[200:203], v13 offset:53248
  v_mfma_f32_16x16x32_bf16 v[92:95], v[184:187], a[172:175], v[92:95]
  s_add_u32 m0, s82, 151424
  ds_read_b64_tr_b16 v[176:177], v10 offset:36864
  ds_read_b64_tr_b16 v[178:179], v10 offset:37376
  v_mfma_f32_16x16x32_bf16 v[112:115], a[160:163], v[132:135], v[112:115]
  buffer_load_dwordx4 v4, s[12:15], s50 offen offset:128 lds
  v_mfma_f32_16x16x32_bf16 v[112:115], a[176:179], v[136:139], v[112:115]
  s_add_u32 m0, s82, 147328
  ds_read_b128 a[204:207], v13 offset:55296
  v_mfma_f32_16x16x32_bf16 v[116:119], a[164:167], v[132:135], v[116:119]
  buffer_load_dwordx4 v4, s[12:15], s51 offen offset:128 lds
  ds_read_b128 a[216:219], v16 offset:53248
  ds_read_b128 a[220:223], v16 offset:55296
  v_mfma_f32_16x16x32_bf16 v[116:119], a[180:183], v[136:139], v[116:119]
  v_mfma_f32_16x16x32_bf16 v[120:123], a[168:171], v[132:135], v[120:123]
  s_add_u32 m0, s82, 143232
  v_mfma_f32_16x16x32_bf16 v[120:123], a[184:187], v[136:139], v[120:123]
  buffer_load_dwordx4 v4, s[12:15], s52 offen offset:128 lds
  v_mfma_f32_16x16x32_bf16 v[124:127], a[172:175], v[132:135], v[124:127]
  v_mfma_f32_16x16x32_bf16 v[124:127], a[188:191], v[136:139], v[124:127]
  s_waitcnt lgkmcnt(0)
  v_mfma_f32_16x16x32_bf16 v[32:35], v[160:163], a[192:195], v[32:35]
  ds_read_b64_tr_b16 v[184:185], v7 offset:40960
  ds_read_b64_tr_b16 v[186:187], v7 offset:41472
  v_mfma_f32_16x16x32_bf16 v[32:35], v[164:167], a[208:211], v[32:35]
  s_add_u32 m0, s82, 139136
  v_mfma_f32_16x16x32_bf16 v[36:39], v[164:167], a[212:215], v[36:39]
  buffer_load_dwordx4 v4, s[12:15], s53 offen offset:128 lds
  v_mfma_f32_16x16x32_bf16 v[36:39], v[160:163], a[196:199], v[36:39]
  v_mfma_f32_16x16x32_bf16 v[40:43], v[160:163], a[200:203], v[40:43]
  s_add_u32 m0, s82, 135040
  ds_read_b64_tr_b16 v[188:189], v7 offset:45056
  ds_read_b64_tr_b16 v[190:191], v7 offset:45568
  v_mfma_f32_16x16x32_bf16 v[40:43], v[164:167], a[216:219], v[40:43]
  buffer_load_dwordx4 v4, s[12:15], s54 offen offset:128 lds
  v_mfma_f32_16x16x32_bf16 v[44:47], v[164:167], a[220:223], v[44:47]
  v_mfma_f32_16x16x32_bf16 v[44:47], v[160:163], a[204:207], v[44:47]
  v_mfma_f32_16x16x32_bf16 v[48:51], v[172:175], a[192:195], v[48:51]
  ds_read_b64_tr_b16 v[160:161], v10 offset:40960
  ds_read_b64_tr_b16 v[162:163], v10 offset:41472
  v_mfma_f32_16x16x32_bf16 v[48:51], v[176:179], a[208:211], v[48:51]
  s_add_u32 m0, s82, 130944
  v_mfma_f32_16x16x32_bf16 v[52:55], v[176:179], a[212:215], v[52:55]
  buffer_load_dwordx4 v4, s[12:15], s55 offen offset:128 lds
  v_mfma_f32_16x16x32_bf16 v[52:55], v[172:175], a[196:199], v[52:55]
  v_mfma_f32_16x16x32_bf16 v[56:59], v[172:175], a[200:203], v[56:59]
  s_add_u32 m0, s82, 28544
  ds_read_b64_tr_b16 v[164:165], v10 offset:45056
  ds_read_b64_tr_b16 v[166:167], v10 offset:45568
  v_mfma_f32_16x16x32_bf16 v[56:59], v[176:179], a[216:219], v[56:59]
  buffer_load_dwordx4 v4, s[12:15], s56 offen offset:128 lds
  v_mfma_f32_16x16x32_bf16 v[60:63], v[176:179], a[220:223], v[60:63]
  v_mfma_f32_16x16x32_bf16 v[60:63], v[172:175], a[204:207], v[60:63]
  s_waitcnt vmcnt(19) lgkmcnt(4)
  v_mfma_f32_16x16x32_bf16 v[64:67], v[184:187], a[192:195], v[64:67]
  s_barrier
  v_mfma_f32_16x16x32_bf16 v[64:67], v[188:191], a[208:211], v[64:67]
  ds_read_b64_tr_b16 v[172:173], v8 offset:0
  ds_read_b64_tr_b16 v[174:175], v8 offset:512
  v_mfma_f32_16x16x32_bf16 v[68:71], v[188:191], a[212:215], v[68:71]
  s_add_u32 m0, s82, 61312
  ds_read_b128 a[224:227], v14 offset:16384
  v_mfma_f32_16x16x32_bf16 v[68:71], v[184:187], a[196:199], v[68:71]
  buffer_load_dwordx4 v4, s[12:15], s57 offen offset:128 lds
  v_mfma_f32_16x16x32_bf16 v[72:75], v[184:187], a[200:203], v[72:75]
  s_add_u32 m0, s82, 57216
  ds_read_b64_tr_b16 v[176:177], v8 offset:4096
  ds_read_b64_tr_b16 v[178:179], v8 offset:4608
  v_mfma_f32_16x16x32_bf16 v[72:75], v[188:191], a[216:219], v[72:75]
  buffer_load_dwordx4 v4, s[12:15], s58 offen offset:128 lds
  v_mfma_f32_16x16x32_bf16 v[76:79], v[188:191], a[220:223], v[76:79]
  ds_read_b128 a[228:231], v14 offset:18432
  v_mfma_f32_16x16x32_bf16 v[76:79], v[184:187], a[204:207], v[76:79]
  s_waitcnt lgkmcnt(6)
  v_mfma_f32_16x16x32_bf16 v[80:83], v[160:163], a[192:195], v[80:83]
  ds_read_b64_tr_b16 v[184:185], v11 offset:0
  ds_read_b64_tr_b16 v[186:187], v11 offset:512
  v_mfma_f32_16x16x32_bf16 v[80:83], v[164:167], a[208:211], v[80:83]
  s_add_u32 m0, s82, 53120
  ds_read_b128 a[240:243], v17 offset:16384
  v_mfma_f32_16x16x32_bf16 v[84:87], v[164:167], a[212:215], v[84:87]
  buffer_load_dwordx4 v4, s[12:15], s59 offen offset:128 lds
  v_mfma_f32_16x16x32_bf16 v[84:87], v[160:163], a[196:199], v[84:87]
  ds_read_b128 a[244:247], v17 offset:18432
  v_mfma_f32_16x16x32_bf16 v[88:91], v[160:163], a[200:203], v[88:91]
  s_add_u32 m0, s82, 49024
  v_mfma_f32_16x16x32_bf16 v[88:91], v[164:167], a[216:219], v[88:91]
  buffer_load_dwordx4 v4, s[12:15], s60 offen offset:128 lds
  v_mfma_f32_16x16x32_bf16 v[92:95], v[164:167], a[220:223], v[92:95]
  ds_read_b128 a[232:235], v14 offset:20480
  v_mfma_f32_16x16x32_bf16 v[92:95], v[160:163], a[204:207], v[92:95]
  s_add_u32 m0, s82, 36736
  ds_read_b64_tr_b16 v[188:189], v11 offset:4096
  ds_read_b64_tr_b16 v[190:191], v11 offset:4608
  v_mfma_f32_16x16x32_bf16 v[112:115], a[192:195], v[140:143], v[112:115]
  buffer_load_dwordx4 v4, s[12:15], s61 offen offset:128 lds
  v_mfma_f32_16x16x32_bf16 v[112:115], a[208:211], v[144:147], v[112:115]
  s_add_u32 m0, s82, 32640
  ds_read_b128 a[236:239], v14 offset:22528
  v_mfma_f32_16x16x32_bf16 v[116:119], a[196:199], v[140:143], v[116:119]
  buffer_load_dwordx4 v4, s[12:15], s62 offen offset:128 lds
  ds_read_b128 a[248:251], v17 offset:20480
  ds_read_b128 a[252:255], v17 offset:22528
  v_mfma_f32_16x16x32_bf16 v[116:119], a[212:215], v[144:147], v[116:119]
  v_mfma_f32_16x16x32_bf16 v[120:123], a[200:203], v[140:143], v[120:123]
  s_add_u32 m0, s82, 24448
  v_mfma_f32_16x16x32_bf16 v[120:123], a[216:219], v[144:147], v[120:123]
  buffer_load_dwordx4 v4, s[12:15], s63 offen offset:128 lds
  v_mfma_f32_16x16x32_bf16 v[124:127], a[204:207], v[140:143], v[124:127]
  v_mfma_f32_16x16x32_bf16 v[124:127], a[220:223], v[144:147], v[124:127]
  s_waitcnt lgkmcnt(0)
  v_mfma_f32_16x16x32_bf16 v[32:35], v[172:175], a[224:227], v[32:35]
  ds_read_b64_tr_b16 v[160:161], v8 offset:8192
  ds_read_b64_tr_b16 v[162:163], v8 offset:8704
  v_mfma_f32_16x16x32_bf16 v[32:35], v[176:179], a[240:243], v[32:35]
  v_lshlrev_b32 v136, 7, v2
  v_add_u32 v136, s89, v136
  v_mfma_f32_16x16x32_bf16 v[36:39], v[176:179], a[244:247], v[36:39]
  v_cvt_f32_u32 v136, v136
  v_add_f32 v137, 0x42000000, v136
  v_mfma_f32_16x16x32_bf16 v[36:39], v[172:175], a[228:231], v[36:39]
  s_add_u32 m0, s82, 20352
  ds_read_b64_tr_b16 v[164:165], v8 offset:12288
  ds_read_b64_tr_b16 v[166:167], v8 offset:12800
  v_mfma_f32_16x16x32_bf16 v[40:43], v[172:175], a[232:235], v[40:43]
  buffer_load_dwordx4 v4, s[12:15], s64 offen offset:128 lds
  v_mfma_f32_16x16x32_bf16 v[40:43], v[176:179], a[248:251], v[40:43]
  v_add_f32 v138, 0x42800000, v136
  v_add_f32 v139, 0x42c00000, v136
  v_mfma_f32_16x16x32_bf16 v[44:47], v[176:179], a[252:255], v[44:47]
  v_lshl_add_u32 v140, v1, 2, 3
  v_cvt_f32_u32 v140, v140
  v_mfma_f32_16x16x32_bf16 v[44:47], v[172:175], a[236:239], v[44:47]
  v_mul_f32 v140, 0x3a000000, v140
  v_mul_f32 v141, v136, v140
  v_mfma_f32_16x16x32_bf16 v[48:51], v[184:187], a[224:227], v[48:51]
  ds_read_b64_tr_b16 v[172:173], v11 offset:8192
  ds_read_b64_tr_b16 v[174:175], v11 offset:8704
  v_mfma_f32_16x16x32_bf16 v[48:51], v[188:191], a[240:243], v[48:51]
  v_mul_f32 v142, v137, v140
  v_mfma_f32_16x16x32_bf16 v[52:55], v[188:191], a[244:247], v[52:55]
  v_cos_f32 v143, v141
  v_mfma_f32_16x16x32_bf16 v[52:55], v[184:187], a[228:231], v[52:55]
  v_cos_f32 v144, v142
  v_mfma_f32_16x16x32_bf16 v[56:59], v[184:187], a[232:235], v[56:59]
  ds_read_b64_tr_b16 v[176:177], v11 offset:12288
  ds_read_b64_tr_b16 v[178:179], v11 offset:12800
  v_mfma_f32_16x16x32_bf16 v[56:59], v[188:191], a[248:251], v[56:59]
  v_sin_f32 v141, v141
  v_mfma_f32_16x16x32_bf16 v[60:63], v[188:191], a[252:255], v[60:63]
  v_sin_f32 v142, v142
  v_mfma_f32_16x16x32_bf16 v[60:63], v[184:187], a[236:239], v[60:63]
  s_waitcnt vmcnt(17) lgkmcnt(4)
  v_cvt_pk_bf16_f32 v128, v143, v144
  v_cvt_pk_bf16_f32 v132, v141, v142
  v_mfma_f32_16x16x32_bf16 v[64:67], v[160:163], a[224:227], v[64:67]
  s_barrier
  v_mfma_f32_16x16x32_bf16 v[64:67], v[164:167], a[240:243], v[64:67]
  ds_read_b64_tr_b16 v[184:185], v8 offset:32768
  ds_read_b64_tr_b16 v[186:187], v8 offset:33280
  v_mfma_f32_16x16x32_bf16 v[68:71], v[164:167], a[244:247], v[68:71]
  s_add_u32 m0, s82, 94080
  ds_read_b128 v[224:227], v14 offset:49152
  v_cvt_pk_bf16_f32 v130, v141, v142
  v_mfma_f32_16x16x32_bf16 v[68:71], v[160:163], a[228:231], v[68:71]
  buffer_load_dwordx4 v4, s[12:15], s65 offen offset:128 lds
  v_mfma_f32_16x16x32_bf16 v[72:75], v[160:163], a[232:235], v[72:75]
  s_add_u32 m0, s82, 89984
  ds_read_b64_tr_b16 v[188:189], v8 offset:36864
  ds_read_b64_tr_b16 v[190:191], v8 offset:37376
  v_mfma_f32_16x16x32_bf16 v[72:75], v[164:167], a[248:251], v[72:75]
  buffer_load_dwordx4 v4, s[16:19], s48 offen offset:128 lds
  v_mfma_f32_16x16x32_bf16 v[76:79], v[164:167], a[252:255], v[76:79]
  ds_read_b128 v[228:231], v14 offset:51200
  v_cvt_pk_bf16_f32 v134, -v143, -v144
  v_mfma_f32_16x16x32_bf16 v[76:79], v[160:163], a[236:239], v[76:79]
  s_waitcnt lgkmcnt(6)
  v_mul_f32 v141, v138, v140
  v_mul_f32 v142, v139, v140
  v_mfma_f32_16x16x32_bf16 v[80:83], v[172:175], a[224:227], v[80:83]
  ds_read_b64_tr_b16 v[160:161], v11 offset:32768
  ds_read_b64_tr_b16 v[162:163], v11 offset:33280
  v_mfma_f32_16x16x32_bf16 v[80:83], v[176:179], a[240:243], v[80:83]
  s_add_u32 m0, s82, 85888
  ds_read_b128 v[240:243], v17 offset:49152
  v_mfma_f32_16x16x32_bf16 v[84:87], v[176:179], a[244:247], v[84:87]
  buffer_load_dwordx4 v4, s[16:19], s49 offen offset:128 lds
  v_mfma_f32_16x16x32_bf16 v[84:87], v[172:175], a[228:231], v[84:87]
  ds_read_b128 v[244:247], v17 offset:51200
  v_mfma_f32_16x16x32_bf16 v[88:91], v[172:175], a[232:235], v[88:91]
  s_add_u32 m0, s82, 81792
  v_cos_f32 v143, v141
  v_mfma_f32_16x16x32_bf16 v[88:91], v[176:179], a[248:251], v[88:91]
  buffer_load_dwordx4 v4, s[16:19], s50 offen offset:128 lds
  v_mfma_f32_16x16x32_bf16 v[92:95], v[176:179], a[252:255], v[92:95]
  ds_read_b128 v[232:235], v14 offset:53248
  v_mfma_f32_16x16x32_bf16 v[92:95], v[172:175], a[236:239], v[92:95]
  s_add_u32 m0, s82, 69504
  ds_read_b64_tr_b16 v[164:165], v11 offset:36864
  ds_read_b64_tr_b16 v[166:167], v11 offset:37376
  v_mfma_f32_16x16x32_bf16 v[112:115], a[224:227], v[148:151], v[112:115]
  buffer_load_dwordx4 v4, s[16:19], s51 offen offset:128 lds
  v_mfma_f32_16x16x32_bf16 v[112:115], a[240:243], v[152:155], v[112:115]
  s_add_u32 m0, s82, 65408
  ds_read_b128 v[236:239], v14 offset:55296
  v_mfma_f32_16x16x32_bf16 v[116:119], a[228:231], v[148:151], v[116:119]
  buffer_load_dwordx4 v4, s[16:19], s52 offen offset:128 lds
  ds_read_b128 v[248:251], v17 offset:53248
  ds_read_b128 v[252:255], v17 offset:55296
  v_mfma_f32_16x16x32_bf16 v[116:119], a[244:247], v[152:155], v[116:119]
  v_cos_f32 v144, v142
  v_mfma_f32_16x16x32_bf16 v[120:123], a[232:235], v[148:151], v[120:123]
  s_add_u32 m0, s82, 44928
  v_sin_f32 v141, v141
  v_mfma_f32_16x16x32_bf16 v[120:123], a[248:251], v[152:155], v[120:123]
  buffer_load_dwordx4 v4, s[16:19], s53 offen offset:128 lds
  v_mfma_f32_16x16x32_bf16 v[124:127], a[236:239], v[148:151], v[124:127]
  v_sin_f32 v142, v142
  v_mfma_f32_16x16x32_bf16 v[124:127], a[252:255], v[152:155], v[124:127]
  s_waitcnt lgkmcnt(0)
  v_cvt_pk_bf16_f32 v129, v143, v144
  v_cvt_pk_bf16_f32 v133, v141, v142
  v_mfma_f32_16x16x32_bf16 v[112:115], v[224:227], v[156:159], v[112:115]
  ds_read_b64_tr_b16 v[172:173], v8 offset:40960
  ds_read_b64_tr_b16 v[174:175], v8 offset:41472
  v_mfma_f32_16x16x32_bf16 v[112:115], v[240:243], v[192:195], v[112:115]
  v_cvt_pk_bf16_f32 v131, v141, v142
  v_cvt_pk_bf16_f32 v135, -v143, -v144
  v_mfma_f32_16x16x32_bf16 v[116:119], v[228:231], v[156:159], v[116:119]
  v_mfma_f32_16x16x32_bf16 v[116:119], v[244:247], v[192:195], v[116:119]
  v_mfma_f32_16x16x32_bf16 v[120:123], v[232:235], v[156:159], v[120:123]
  v_mfma_f32_16x16x32_bf16 v[120:123], v[248:251], v[192:195], v[120:123]
  v_mfma_f32_16x16x32_bf16 v[124:127], v[236:239], v[156:159], v[124:127]
  v_mfma_f32_16x16x32_bf16 v[124:127], v[252:255], v[192:195], v[124:127]
  s_add_u32 m0, s82, 40832
  ds_read_b64_tr_b16 v[176:177], v8 offset:45056
  ds_read_b64_tr_b16 v[178:179], v8 offset:45568
  v_mfma_f32_16x16x32_bf16 v[32:35], v[184:187], v[224:227], v[32:35]
  buffer_load_dwordx4 v4, s[16:19], s54 offen offset:128 lds
  v_mfma_f32_16x16x32_bf16 v[32:35], v[188:191], v[240:243], v[32:35]
  v_mfma_f32_16x16x32_bf16 v[36:39], v[188:191], v[244:247], v[36:39]
  v_fma_f32 v96, v29, v112, v96
  v_fma_f32 v97, v29, v113, v97
  v_fma_f32 v98, v29, v114, v98
  v_mfma_f32_16x16x32_bf16 v[36:39], v[184:187], v[228:231], v[36:39]
  v_fma_f32 v99, v29, v115, v99
  v_fma_f32 v100, v29, v116, v100
  v_mfma_f32_16x16x32_bf16 v[40:43], v[184:187], v[232:235], v[40:43]
  v_fma_f32 v101, v29, v117, v101
  v_fma_f32 v102, v29, v118, v102
  v_fma_f32 v103, v29, v119, v103
  v_mfma_f32_16x16x32_bf16 v[40:43], v[188:191], v[248:251], v[40:43]
  v_fma_f32 v104, v29, v120, v104
  v_fma_f32 v105, v29, v121, v105
  v_mfma_f32_16x16x32_bf16 v[44:47], v[188:191], v[252:255], v[44:47]
  v_fma_f32 v106, v29, v122, v106
  v_fma_f32 v107, v29, v123, v107
  v_mfma_f32_16x16x32_bf16 v[44:47], v[184:187], v[236:239], v[44:47]
  v_fma_f32 v108, v29, v124, v108
  v_fma_f32 v109, v29, v125, v109
  v_fma_f32 v110, v29, v126, v110
  v_mfma_f32_16x16x32_bf16 v[48:51], v[160:163], v[224:227], v[48:51]
  ds_read_b64_tr_b16 v[184:185], v11 offset:40960
  ds_read_b64_tr_b16 v[186:187], v11 offset:41472
  v_mfma_f32_16x16x32_bf16 v[48:51], v[164:167], v[240:243], v[48:51]
  v_fma_f32 v111, v29, v127, v111
  v_add_f32 v112, v96, v104
  v_mfma_f32_16x16x32_bf16 v[52:55], v[164:167], v[244:247], v[52:55]
  v_sub_f32 v120, v96, v104
  v_add_f32 v113, v97, v105
  v_sub_f32 v121, v97, v105
  v_mfma_f32_16x16x32_bf16 v[52:55], v[160:163], v[228:231], v[52:55]
  v_add_f32 v114, v98, v106
  v_sub_f32 v122, v98, v106
  v_mfma_f32_16x16x32_bf16 v[56:59], v[160:163], v[232:235], v[56:59]
  ds_read_b64_tr_b16 v[188:189], v11 offset:45056
  ds_read_b64_tr_b16 v[190:191], v11 offset:45568
  v_add_f32 v115, v99, v107
  v_mfma_f32_16x16x32_bf16 v[56:59], v[164:167], v[248:251], v[56:59]
  v_sub_f32 v123, v99, v107
  v_add_f32 v116, v100, v108
  v_mfma_f32_16x16x32_bf16 v[60:63], v[164:167], v[252:255], v[60:63]
  v_sub_f32 v124, v100, v108
  v_add_f32 v117, v101, v109
  v_mfma_f32_16x16x32_bf16 v[60:63], v[160:163], v[236:239], v[60:63]
  s_waitcnt vmcnt(19) lgkmcnt(4)
  v_sub_f32 v125, v101, v109
  v_add_f32 v118, v102, v110
  v_sub_f32 v126, v102, v110
  v_mfma_f32_16x16x32_bf16 v[64:67], v[172:175], v[224:227], v[64:67]
  s_barrier
  v_mfma_f32_16x16x32_bf16 v[64:67], v[176:179], v[240:243], v[64:67]
  ds_read_b64_tr_b16 v[160:161], v9 offset:28672
  ds_read_b64_tr_b16 v[162:163], v9 offset:29184
  v_mfma_f32_16x16x32_bf16 v[68:71], v[176:179], v[244:247], v[68:71]
  v_add_f32 v119, v103, v111
  v_sub_f32 v127, v103, v111
  v_cvt_pk_bf16_f32 v136, v112, v113
  v_mfma_f32_16x16x32_bf16 v[68:71], v[172:175], v[228:231], v[68:71]
  s_add_u32 m0, s82, 126848
  ds_read_b64_tr_b16 v[164:165], v9 offset:24576
  ds_read_b64_tr_b16 v[166:167], v9 offset:25088
  v_mfma_f32_16x16x32_bf16 v[72:75], v[172:175], v[232:235], v[72:75]
  buffer_load_dwordx4 v4, s[16:19], s55 offen offset:128 lds
  v_mfma_f32_16x16x32_bf16 v[72:75], v[176:179], v[248:251], v[72:75]
  v_cvt_pk_bf16_f32 v137, v114, v115
  v_cvt_pk_bf16_f32 v138, v116, v117
  v_cvt_pk_bf16_f32 v139, v118, v119
  v_mfma_f32_16x16x32_bf16 v[76:79], v[176:179], v[252:255], v[76:79]
  ds_read_b64_tr_b16 v[168:169], v9 offset:20480
  ds_read_b64_tr_b16 v[170:171], v9 offset:20992
  v_mfma_f32_16x16x32_bf16 v[76:79], v[172:175], v[236:239], v[76:79]
  s_waitcnt lgkmcnt(6)
  v_cvt_pk_bf16_f32 v140, v120, v121
  v_cvt_pk_bf16_f32 v141, v122, v123
  v_mfma_f32_16x16x32_bf16 v[80:83], v[184:187], v[224:227], v[80:83]
  ds_read_b64_tr_b16 v[172:173], v12 offset:28672
  ds_read_b64_tr_b16 v[174:175], v12 offset:29184
  v_cvt_pk_bf16_f32 v142, v124, v125
  v_mfma_f32_16x16x32_bf16 v[80:83], v[188:191], v[240:243], v[80:83]
  v_cvt_pk_bf16_f32 v143, v126, v127
  v_mov_b32 v220, v28
  v_mfma_f32_16x16x32_bf16 v[84:87], v[188:191], v[244:247], v[84:87]
  s_lshl_b32 s39, s80, 4
  ds_read_b64_tr_b16 v[176:177], v12 offset:24576
  ds_read_b64_tr_b16 v[178:179], v12 offset:25088
  v_mfma_f32_16x16x32_bf16 v[84:87], v[184:187], v[228:231], v[84:87]
  s_add_u32 m0, s82, 122752
  s_add_u32 s39, s39, s79
  s_lshl_b32 s39, s39, 2
  v_mfma_f32_16x16x32_bf16 v[88:91], v[184:187], v[232:235], v[88:91]
  buffer_load_dwordx4 v4, s[16:19], s56 offen offset:128 lds
  v_mfma_f32_16x16x32_bf16 v[88:91], v[188:191], v[248:251], v[88:91]
  s_add_u32 s39, s39, s81
  ds_read_b64_tr_b16 v[180:181], v12 offset:20480
  ds_read_b64_tr_b16 v[182:183], v12 offset:20992
  s_lshl_b32 s39, s39, 11
  v_mfma_f32_16x16x32_bf16 v[92:95], v[188:191], v[252:255], v[92:95]
  v_mfma_f32_16x16x32_bf16 v[92:95], v[184:187], v[236:239], v[92:95]
  v_mfma_f32_16x16x32_bf16 v[96:99], v[136:139], v[196:199], 0
  v_mfma_f32_16x16x32_bf16 v[112:115], v[136:139], v[200:203], 0
  v_mfma_f32_16x16x32_bf16 v[100:103], v[140:143], v[204:207], 0
  v_mfma_f32_16x16x32_bf16 v[116:119], v[140:143], v[208:211], 0
  v_mfma_f32_16x16x32_bf16 v[104:107], v[136:139], v[212:215], 0
  v_mfma_f32_16x16x32_bf16 v[120:123], v[136:139], v[216:219], 0
  v_mfma_f32_16x16x32_bf16 v[108:111], v[140:143], v[128:131], 0
  v_mfma_f32_16x16x32_bf16 v[124:127], v[140:143], v[132:135], 0
  s_cmp_lt_u32 s97, 16
  s_cbranch_scc0 L_ox1_gated_mix__spectral_gfnet__swiglu_ffn__prompt_kernel
L_x1_gated_mix__spectral_gfnet__swiglu_ffn__prompt_kernel:
  s_waitcnt lgkmcnt(6)
  v_mfma_f32_16x16x32_bf16 v[128:131], v[160:163], a[0:3], 0
  ds_read_b64_tr_b16 v[184:185], v9 offset:16384
  ds_read_b64_tr_b16 v[186:187], v9 offset:16896
  v_mfma_f32_16x16x32_bf16 v[128:131], v[164:167], a[16:19], v[128:131]
  buffer_load_dword v218, v222, s[28:31], 0 offen sc1
  v_mfma_f32_16x16x32_bf16 v[128:131], v[168:171], a[32:35], v[128:131]
  s_add_u32 m0, s82, 118656
  v_mul_f32 v24, s96, v32
  v_mul_f32 v25, s96, v33
  v_mfma_f32_16x16x32_bf16 v[132:135], v[168:171], a[36:39], 0
  buffer_load_dwordx4 v4, s[16:19], s57 offen offset:128 lds
  v_mfma_f32_16x16x32_bf16 v[132:135], v[164:167], a[20:23], v[132:135]
  ds_read_b64_tr_b16 v[188:189], v9 offset:12288
  ds_read_b64_tr_b16 v[190:191], v9 offset:12800
  s_or_b32 s86, s80, s88
  s_cmp_lg_u32 s86, 0
  s_cbranch_scc0 L_ony_gated_mix__spectral_gfnet__swiglu_ffn__prompt_kernel
L_ny_gated_mix__spectral_gfnet__swiglu_ffn__prompt_kernel:
  v_mfma_f32_16x16x32_bf16 v[132:135], v[160:163], a[4:7], v[132:135]
  s_mul_i32 s6, s87, 4352
  s_lshl_b32 s7, s88, 4
  s_add_u32 s6, s6, s7
  v_mfma_f32_16x16x32_bf16 v[136:139], v[160:163], a[8:11], 0
  s_add_u32 s6, s6, 0
  v_mul_u32_u24 v204, 272, v1
  v_lshl_add_u32 v204, v2, 2, v204
  v_mfma_f32_16x16x32_bf16 v[136:139], v[164:167], a[24:27], v[136:139]
  s_add_u32 m0, s82, 114560
  ds_read_b64_tr_b16 v[192:193], v9 offset:8192
  ds_read_b64_tr_b16 v[194:195], v9 offset:8704
  v_mfma_f32_16x16x32_bf16 v[136:139], v[168:171], a[40:43], v[136:139]
  buffer_load_dwordx4 v4, s[16:19], s58 offen offset:128 lds
  v_mfma_f32_16x16x32_bf16 v[140:143], v[168:171], a[44:47], 0
  v_add_u32 v204, s6, v204
  v_fma_f32 v96, v220, v114, v96
  v_mfma_f32_16x16x32_bf16 v[140:143], v[164:167], a[28:31], v[140:143]
  v_add_f32 v97, v97, v115
  v_fma_f32 v112, v220, v98, -v112
  v_mfma_f32_16x16x32_bf16 v[140:143], v[160:163], a[12:15], v[140:143]
  s_waitcnt lgkmcnt(6)
  v_sub_f32 v113, v99, v113
  v_cvt_pk_bf16_f32 v196, v96, v97
  v_mfma_f32_16x16x32_bf16 v[144:147], v[172:175], a[0:3], 0
  ds_read_b64_tr_b16 v[160:161], v12 offset:16384
  ds_read_b64_tr_b16 v[162:163], v12 offset:16896
  v_mfma_f32_16x16x32_bf16 v[144:147], v[176:179], a[16:19], v[144:147]
  v_cvt_pk_bf16_f32 v197, v112, v113
  v_mul_f32 v26, s96, v34
  v_mfma_f32_16x16x32_bf16 v[144:147], v[180:183], a[32:35], v[144:147]
  s_add_u32 m0, s82, 102272
  v_mul_f32 v27, s96, v35
  v_mfma_f32_16x16x32_bf16 v[148:151], v[180:183], a[36:39], 0
  buffer_load_dwordx4 v4, s[16:19], s59 offen offset:128 lds
  v_mfma_f32_16x16x32_bf16 v[148:151], v[176:179], a[20:23], v[148:151]
  ds_read_b64_tr_b16 v[164:165], v12 offset:12288
  ds_read_b64_tr_b16 v[166:167], v12 offset:12800
  v_mfma_f32_16x16x32_bf16 v[148:151], v[172:175], a[4:7], v[148:151]
  ds_write2_b32 v204, v196, v197 offset0:0 offset1:8
  v_mfma_f32_16x16x32_bf16 v[152:155], v[172:175], a[8:11], 0
  v_fma_f32 v100, v220, v118, v100
  v_add_f32 v101, v101, v119
  v_mfma_f32_16x16x32_bf16 v[152:155], v[176:179], a[24:27], v[152:155]
  s_add_u32 m0, s82, 98176
  ds_read_b64_tr_b16 v[168:169], v12 offset:8192
  ds_read_b64_tr_b16 v[170:171], v12 offset:8704
  v_mfma_f32_16x16x32_bf16 v[152:155], v[180:183], a[40:43], v[152:155]
  buffer_load_dwordx4 v4, s[16:19], s60 offen offset:128 lds
  v_mfma_f32_16x16x32_bf16 v[156:159], v[180:183], a[44:47], 0
  v_fma_f32 v116, v220, v102, -v116
  v_sub_f32 v117, v103, v117
  v_mfma_f32_16x16x32_bf16 v[156:159], v[176:179], a[28:31], v[156:159]
  v_cvt_pk_bf16_f32 v198, v100, v101
  v_cvt_pk_bf16_f32 v199, v116, v117
  v_mfma_f32_16x16x32_bf16 v[156:159], v[172:175], a[12:15], v[156:159]
  s_waitcnt vmcnt(20) lgkmcnt(7)
  v_exp_f32 v24, v24
  v_mfma_f32_16x16x32_bf16 v[128:131], v[184:187], a[48:51], v[128:131]
  s_barrier
  v_mfma_f32_16x16x32_bf16 v[128:131], v[188:191], a[64:67], v[128:131]
  ds_read_b64_tr_b16 v[172:173], v9 offset:4096
  ds_read_b64_tr_b16 v[174:175], v9 offset:4608
  v_mfma_f32_16x16x32_bf16 v[128:131], v[192:195], a[80:83], v[128:131]
  ds_write2_b32 v204, v198, v199 offset0:16 offset1:24
  v_mfma_f32_16x16x32_bf16 v[132:135], v[192:195], a[84:87], v[132:135]
  s_add_u32 m0, s82, 159616
  v_fma_f32 v104, v220, v122, v104
  v_add_f32 v105, v105, v123
  v_mfma_f32_16x16x32_bf16 v[132:135], v[188:191], a[68:71], v[132:135]
  buffer_load_dwordx4 v4, s[16:19], s61 offen offset:128 lds
  v_mfma_f32_16x16x32_bf16 v[132:135], v[184:187], a[52:55], v[132:135]
  ds_read_b64_tr_b16 v[176:177], v9 offset:0
  ds_read_b64_tr_b16 v[178:179], v9 offset:512
  v_mfma_f32_16x16x32_bf16 v[136:139], v[184:187], a[56:59], v[136:139]
  v_fma_f32 v120, v220, v106, -v120
  v_sub_f32 v121, v107, v121
  v_mfma_f32_16x16x32_bf16 v[136:139], v[188:191], a[72:75], v[136:139]
  s_add_u32 m0, s82, 155520
  v_cvt_pk_bf16_f32 v200, v104, v105
  v_cvt_pk_bf16_f32 v201, v120, v121
  v_mfma_f32_16x16x32_bf16 v[136:139], v[192:195], a[88:91], v[136:139]
  buffer_load_dwordx4 v4, s[16:19], s62 offen offset:128 lds
  v_mfma_f32_16x16x32_bf16 v[140:143], v[192:195], a[92:95], v[140:143]
  ds_read_b64_tr_b16 v[180:181], v7 offset:28672
  ds_read_b64_tr_b16 v[182:183], v7 offset:29184
  v_mfma_f32_16x16x32_bf16 v[140:143], v[188:191], a[76:79], v[140:143]
  ds_write2_b32 v204, v200, v201 offset0:32 offset1:40
  v_mfma_f32_16x16x32_bf16 v[140:143], v[184:187], a[60:63], v[140:143]
  s_waitcnt lgkmcnt(8)
  v_fma_f32 v108, v220, v126, v108
  v_add_f32 v109, v109, v127
  v_mfma_f32_16x16x32_bf16 v[144:147], v[160:163], a[48:51], v[144:147]
  ds_read_b64_tr_b16 v[184:185], v12 offset:4096
  ds_read_b64_tr_b16 v[186:187], v12 offset:4608
  v_mfma_f32_16x16x32_bf16 v[144:147], v[164:167], a[64:67], v[144:147]
  v_fma_f32 v124, v220, v110, -v124
  v_sub_f32 v125, v111, v125
  v_mfma_f32_16x16x32_bf16 v[144:147], v[168:171], a[80:83], v[144:147]
  s_add_u32 m0, s82, 151424
  v_cvt_pk_bf16_f32 v202, v108, v109
  v_cvt_pk_bf16_f32 v203, v124, v125
  v_mfma_f32_16x16x32_bf16 v[148:151], v[168:171], a[84:87], v[148:151]
  buffer_load_dwordx4 v4, s[16:19], s63 offen offset:128 lds
  v_mfma_f32_16x16x32_bf16 v[148:151], v[164:167], a[68:71], v[148:151]
  ds_read_b64_tr_b16 v[188:189], v12 offset:0
  ds_read_b64_tr_b16 v[190:191], v12 offset:512
  v_mfma_f32_16x16x32_bf16 v[148:151], v[160:163], a[52:55], v[148:151]
  ds_write2_b32 v204, v202, v203 offset0:48 offset1:56
  v_mfma_f32_16x16x32_bf16 v[152:155], v[160:163], a[56:59], v[152:155]
  s_mul_i32 s6, s81, 2176
  v_exp_f32 v25, v25
  v_mfma_f32_16x16x32_bf16 v[152:155], v[164:167], a[72:75], v[152:155]
  s_add_u32 m0, s82, 110464
  ds_read_b64_tr_b16 v[192:193], v10 offset:28672
  ds_read_b64_tr_b16 v[194:195], v10 offset:29184
  v_mfma_f32_16x16x32_bf16 v[152:155], v[168:171], a[88:91], v[152:155]
  buffer_load_dwordx4 v4, s[16:19], s64 offen offset:128 lds
  v_mfma_f32_16x16x32_bf16 v[156:159], v[168:171], a[92:95], v[156:159]
  s_add_u32 s6, s6, 0
  v_lshl_add_u32 v204, v2, 4, v21
  v_add_u32 v204, s6, v204
  v_mfma_f32_16x16x32_bf16 v[156:159], v[164:167], a[76:79], v[156:159]
  v_lshrrev_b32 v13, 2, v1
  v_lshl_add_u32 v13, v2, 3, v13
  v_mfma_f32_16x16x32_bf16 v[156:159], v[160:163], a[60:63], v[156:159]
  s_waitcnt lgkmcnt(8)
  v_lshlrev_b32 v13, 6, v13
  v_and_b32 v216, 3, v1
  v_mfma_f32_16x16x32_bf16 v[128:131], v[172:175], a[96:99], v[128:131]
  ds_read_b64_tr_b16 v[160:161], v7 offset:61440
  ds_read_b64_tr_b16 v[162:163], v7 offset:61952
  v_mfma_f32_16x16x32_bf16 v[128:131], v[176:179], a[112:115], v[128:131]
  v_lshl_add_u32 v13, v216, 3, v13
  v_and_b32 v217, 1, v2
  v_mfma_f32_16x16x32_bf16 v[128:131], v[180:183], a[128:131], v[128:131]
  s_add_u32 m0, s82, 106368
  v_xor_b32 v217, s88, v217
  v_lshl_add_u32 v13, v217, 5, v13
  v_mfma_f32_16x16x32_bf16 v[132:135], v[180:183], a[132:135], v[132:135]
  buffer_load_dwordx4 v4, s[16:19], s65 offen offset:128 lds
  v_mfma_f32_16x16x32_bf16 v[132:135], v[176:179], a[116:119], v[132:135]
  ds_read_b64_tr_b16 v[164:165], v7 offset:57344
  ds_read_b64_tr_b16 v[166:167], v7 offset:57856
  v_mfma_f32_16x16x32_bf16 v[132:135], v[172:175], a[100:103], v[132:135]
  v_lshrrev_b32 v16, 2, v1
  v_lshl_add_u32 v16, v2, 2, v16
  v_mfma_f32_16x16x32_bf16 v[136:139], v[172:175], a[104:107], v[136:139]
  v_bfe_u32 v217, v16, 1, 2
  v_xor_b32 v217, s81, v217
  v_mfma_f32_16x16x32_bf16 v[136:139], v[176:179], a[120:123], v[136:139]
  s_add_u32 m0, s82, 77568
  ds_read_b64_tr_b16 v[168:169], v7 offset:53248
  ds_read_b64_tr_b16 v[170:171], v7 offset:53760
  v_lshlrev_b32 v16, 7, v16
  v_mfma_f32_16x16x32_bf16 v[136:139], v[180:183], a[136:139], v[136:139]
  buffer_load_dwordx4 v4, s[12:15], s48 offen offset:256 lds
  v_mfma_f32_16x16x32_bf16 v[140:143], v[180:183], a[140:143], v[140:143]
  v_lshl_add_u32 v16, v217, 5, v16
  v_lshl_add_u32 v16, v216, 3, v16
  v_mfma_f32_16x16x32_bf16 v[140:143], v[176:179], a[124:127], v[140:143]
  v_mov_b32 v3, 1
  v_add_u32 v14, 0x10000, v13
  v_mfma_f32_16x16x32_bf16 v[140:143], v[172:175], a[108:111], v[140:143]
  s_waitcnt lgkmcnt(6)
  v_add_u32 v15, 0x20000, v13
  v_add_u32 v17, 0x10000, v16
  v_mfma_f32_16x16x32_bf16 v[144:147], v[184:187], a[96:99], v[144:147]
  ds_read_b64_tr_b16 v[172:173], v10 offset:61440
  ds_read_b64_tr_b16 v[174:175], v10 offset:61952
  v_mfma_f32_16x16x32_bf16 v[144:147], v[188:191], a[112:115], v[144:147]
  v_add_u32 v18, 0x20000, v16
  v_mfma_f32_16x16x32_bf16 v[144:147], v[192:195], a[128:131], v[144:147]
  s_cmp_eq_u32 s81, 0
  s_cselect_b32 s77, 1, 0
  v_mfma_f32_16x16x32_bf16 v[148:151], v[192:195], a[132:135], v[148:151]
  s_lshr_b32 s75, s80, 1
  ds_read_b64_tr_b16 v[176:177], v10 offset:57344
  ds_read_b64_tr_b16 v[178:179], v10 offset:57856
  v_mfma_f32_16x16x32_bf16 v[148:151], v[188:191], a[116:119], v[148:151]
  s_lshl_b32 s75, s75, 7
  v_exp_f32 v26, v26
  v_mfma_f32_16x16x32_bf16 v[148:151], v[184:187], a[100:103], v[148:151]
  s_add_u32 m0, s82, 73472
  v_exp_f32 v27, v27
  v_mfma_f32_16x16x32_bf16 v[152:155], v[184:187], a[104:107], v[152:155]
  buffer_load_dwordx4 v4, s[12:15], s49 offen offset:256 lds
  v_mfma_f32_16x16x32_bf16 v[152:155], v[188:191], a[120:123], v[152:155]
  s_add_u32 s75, s75, 6422528
  v_add_f32 v24, 1.0, v24
  v_add_f32 v25, 1.0, v25
  v_add_f32 v26, 1.0, v26
  v_mfma_f32_16x16x32_bf16 v[152:155], v[192:195], a[136:139], v[152:155]
  s_add_u32 s76, s79, 34
  ds_read_b64_tr_b16 v[180:181], v10 offset:53248
  ds_read_b64_tr_b16 v[182:183], v10 offset:53760
  v_mfma_f32_16x16x32_bf16 v[156:159], v[192:195], a[140:143], v[156:159]
  s_cmp_lt_u32 s97, 16
  s_cselect_b32 s76, s76, 8
  v_add_f32 v27, 1.0, v27
  v_mfma_f32_16x16x32_bf16 v[156:159], v[188:191], a[124:127], v[156:159]
  s_lshl_b32 s76, s76, 7
  v_rcp_f32 v24, v24
  v_mfma_f32_16x16x32_bf16 v[156:159], v[184:187], a[108:111], v[156:159]
  s_waitcnt vmcnt(21) lgkmcnt(6)
  v_rcp_f32 v25, v25
  v_mfma_f32_16x16x32_bf16 v[128:131], v[160:163], a[144:147], v[128:131]
  s_barrier
  v_mfma_f32_16x16x32_bf16 v[128:131], v[164:167], a[160:163], v[128:131]
  s_add_u32 s76, s76, 6422528
  ds_read_b64_tr_b16 v[184:185], v7 offset:49152
  ds_read_b64_tr_b16 v[186:187], v7 offset:49664
  v_mfma_f32_16x16x32_bf16 v[128:131], v[168:171], a[176:179], v[128:131]
  ds_read_b128 v[196:199], v204
  ds_read_b128 v[200:203], v204 offset:1088
  v_mfma_f32_16x16x32_bf16 v[132:135], v[168:171], a[180:183], v[132:135]
  s_add_u32 m0, s82, 147200
  v_rcp_f32 v26, v26
  v_mfma_f32_16x16x32_bf16 v[132:135], v[164:167], a[164:167], v[132:135]
  buffer_load_dwordx4 v4, s[12:15], s50 offen offset:256 lds
  v_mfma_f32_16x16x32_bf16 v[132:135], v[160:163], a[148:151], v[132:135]
  ds_read_b64_tr_b16 v[188:189], v7 offset:36864
  ds_read_b64_tr_b16 v[190:191], v7 offset:37376
  v_mfma_f32_16x16x32_bf16 v[136:139], v[160:163], a[152:155], v[136:139]
  v_rcp_f32 v27, v27
  v_mul_f32 v32, v32, v24
  v_mfma_f32_16x16x32_bf16 v[136:139], v[164:167], a[168:171], v[136:139]
  s_add_u32 m0, s82, 143104
  v_mul_f32 v33, v33, v25
  v_mul_f32 v34, v34, v26
  v_mfma_f32_16x16x32_bf16 v[136:139], v[168:171], a[184:187], v[136:139]
  buffer_load_dwordx4 v4, s[12:15], s51 offen offset:256 lds
  v_mfma_f32_16x16x32_bf16 v[140:143], v[168:171], a[188:191], v[140:143]
  ds_read_b64_tr_b16 v[192:193], v7 offset:32768
  ds_read_b64_tr_b16 v[194:195], v7 offset:33280
  v_mfma_f32_16x16x32_bf16 v[140:143], v[164:167], a[172:175], v[140:143]
  v_mul_f32 v35, v35, v27
  v_mul_f32 v28, s96, v36
  v_mfma_f32_16x16x32_bf16 v[140:143], v[160:163], a[156:159], v[140:143]
  s_waitcnt lgkmcnt(8)
  v_mul_f32 v29, s96, v37
  v_mul_f32 v30, s96, v38
  v_mfma_f32_16x16x32_bf16 v[144:147], v[172:175], a[144:147], v[144:147]
  ds_read_b64_tr_b16 v[160:161], v10 offset:49152
  ds_read_b64_tr_b16 v[162:163], v10 offset:49664
  v_mfma_f32_16x16x32_bf16 v[144:147], v[176:179], a[160:163], v[144:147]
  v_mul_f32 v31, s96, v39
  v_exp_f32 v28, v28
  v_mfma_f32_16x16x32_bf16 v[144:147], v[180:183], a[176:179], v[144:147]
  s_add_u32 m0, s82, 139008
  v_exp_f32 v29, v29
  v_mfma_f32_16x16x32_bf16 v[148:151], v[180:183], a[180:183], v[148:151]
  buffer_load_dwordx4 v4, s[12:15], s52 offen offset:256 lds
  v_mfma_f32_16x16x32_bf16 v[148:151], v[176:179], a[164:167], v[148:151]
  ds_read_b64_tr_b16 v[164:165], v10 offset:36864
  ds_read_b64_tr_b16 v[166:167], v10 offset:37376
  v_mfma_f32_16x16x32_bf16 v[148:151], v[172:175], a[148:151], v[148:151]
  s_waitcnt lgkmcnt(9)
  buffer_store_dwordx4 v[196:199], v21, s[24:27], s39 offen sc1
  v_mfma_f32_16x16x32_bf16 v[152:155], v[172:175], a[152:155], v[152:155]
  s_waitcnt lgkmcnt(8)
  buffer_store_dwordx4 v[200:203], v21, s[24:27], s39 offen offset:1024 sc1
  v_mfma_f32_16x16x32_bf16 v[152:155], v[176:179], a[168:171], v[152:155]
  s_add_u32 m0, s82, 134912
  ds_read_b64_tr_b16 v[168:169], v10 offset:32768
  ds_read_b64_tr_b16 v[170:171], v10 offset:33280
  v_mfma_f32_16x16x32_bf16 v[152:155], v[180:183], a[184:187], v[152:155]
  buffer_load_dwordx4 v4, s[12:15], s53 offen offset:256 lds
  v_mfma_f32_16x16x32_bf16 v[156:159], v[180:183], a[188:191], v[156:159]
  v_exp_f32 v30, v30
  v_mfma_f32_16x16x32_bf16 v[156:159], v[176:179], a[172:175], v[156:159]
  v_exp_f32 v31, v31
  v_add_f32 v28, 1.0, v28
  v_mfma_f32_16x16x32_bf16 v[156:159], v[172:175], a[156:159], v[156:159]
  s_waitcnt lgkmcnt(6)
  v_add_f32 v29, 1.0, v29
  v_add_f32 v30, 1.0, v30
  v_mfma_f32_16x16x32_bf16 v[128:131], v[184:187], a[192:195], v[128:131]
  ds_read_b64_tr_b16 v[172:173], v7 offset:24576
  ds_read_b64_tr_b16 v[174:175], v7 offset:25088
  v_mfma_f32_16x16x32_bf16 v[128:131], v[188:191], a[208:211], v[128:131]
  buffer_load_dword v23, v20, s[20:23], 0 offen
  v_mfma_f32_16x16x32_bf16 v[128:131], v[192:195], a[224:227], v[128:131]
  v_add_u32 v20, 3456, v20
  v_add_f32 v31, 1.0, v31
  v_mfma_f32_16x16x32_bf16 v[132:135], v[192:195], a[228:231], v[132:135]
  ds_read_b64_tr_b16 v[176:177], v7 offset:20480
  ds_read_b64_tr_b16 v[178:179], v7 offset:20992
  v_mfma_f32_16x16x32_bf16 v[132:135], v[188:191], a[212:215], v[132:135]
  v_rcp_f32 v28, v28
  v_mfma_f32_16x16x32_bf16 v[132:135], v[184:187], a[196:199], v[132:135]
  s_add_u32 m0, s82, 130816
  v_rcp_f32 v29, v29
  v_mfma_f32_16x16x32_bf16 v[136:139], v[184:187], a[200:203], v[136:139]
  buffer_load_dwordx4 v4, s[12:15], s54 offen offset:256 lds
  v_mfma_f32_16x16x32_bf16 v[136:139], v[188:191], a[216:219], v[136:139]
  v_rcp_f32 v30, v30
  v_mfma_f32_16x16x32_bf16 v[136:139], v[192:195], a[232:235], v[136:139]
  ds_read_b64_tr_b16 v[180:181], v8 offset:28672
  ds_read_b64_tr_b16 v[182:183], v8 offset:29184
  v_mfma_f32_16x16x32_bf16 v[140:143], v[192:195], a[236:239], v[140:143]
  v_rcp_f32 v31, v31
  v_mul_f32 v36, v36, v28
  v_mfma_f32_16x16x32_bf16 v[140:143], v[188:191], a[220:223], v[140:143]
  v_mul_f32 v37, v37, v29
  v_mul_f32 v38, v38, v30
  v_mfma_f32_16x16x32_bf16 v[140:143], v[184:187], a[204:207], v[140:143]
  s_waitcnt lgkmcnt(6)
  v_mul_f32 v39, v39, v31
  v_mul_f32 v24, s96, v40
  v_mfma_f32_16x16x32_bf16 v[144:147], v[160:163], a[192:195], v[144:147]
  ds_read_b64_tr_b16 v[184:185], v10 offset:24576
  ds_read_b64_tr_b16 v[186:187], v10 offset:25088
  v_mul_f32 v25, s96, v41
  v_mfma_f32_16x16x32_bf16 v[144:147], v[164:167], a[208:211], v[144:147]
  v_mul_f32 v26, s96, v42
  v_mul_f32 v27, s96, v43
  v_mfma_f32_16x16x32_bf16 v[144:147], v[168:171], a[224:227], v[144:147]
  v_exp_f32 v24, v24
  v_mfma_f32_16x16x32_bf16 v[148:151], v[168:171], a[228:231], v[148:151]
  v_exp_f32 v25, v25
  v_mfma_f32_16x16x32_bf16 v[148:151], v[164:167], a[212:215], v[148:151]
  ds_read_b64_tr_b16 v[188:189], v10 offset:20480
  ds_read_b64_tr_b16 v[190:191], v10 offset:20992
  v_mfma_f32_16x16x32_bf16 v[148:151], v[160:163], a[196:199], v[148:151]
  v_exp_f32 v26, v26
  v_mfma_f32_16x16x32_bf16 v[152:155], v[160:163], a[200:203], v[152:155]
  v_exp_f32 v27, v27
  v_mfma_f32_16x16x32_bf16 v[152:155], v[164:167], a[216:219], v[152:155]
  v_add_f32 v24, 1.0, v24
  v_add_f32 v25, 1.0, v25
  v_mfma_f32_16x16x32_bf16 v[152:155], v[168:171], a[232:235], v[152:155]
  ds_read_b64_tr_b16 v[192:193], v11 offset:28672
  ds_read_b64_tr_b16 v[194:195], v11 offset:29184
  v_add_f32 v26, 1.0, v26
  v_mfma_f32_16x16x32_bf16 v[156:159], v[168:171], a[236:239], v[156:159]
  v_add_f32 v27, 1.0, v27
  v_mfma_f32_16x16x32_bf16 v[156:159], v[164:167], a[220:223], v[156:159]
  v_rcp_f32 v24, v24
  v_mfma_f32_16x16x32_bf16 v[156:159], v[160:163], a[204:207], v[156:159]
  s_waitcnt vmcnt(23) lgkmcnt(6)
  v_rcp_f32 v25, v25
  v_mfma_f32_16x16x32_bf16 v[128:131], v[172:175], a[240:243], v[128:131]
  s_barrier
  v_mfma_f32_16x16x32_bf16 v[128:131], v[176:179], v[224:227], v[128:131]
  ds_read_b64_tr_b16 v[160:161], v8 offset:24576
  ds_read_b64_tr_b16 v[162:163], v8 offset:25088
  v_mfma_f32_16x16x32_bf16 v[128:131], v[180:183], v[240:243], v[128:131]
  v_rcp_f32 v26, v26
  v_mfma_f32_16x16x32_bf16 v[132:135], v[180:183], v[244:247], v[132:135]
  s_add_u32 m0, s82, 61184
  v_rcp_f32 v27, v27
  v_mul_f32 v40, v40, v24
  v_mfma_f32_16x16x32_bf16 v[132:135], v[176:179], v[228:231], v[132:135]
  buffer_load_dwordx4 v4, s[12:15], s55 offen offset:256 lds
  v_mfma_f32_16x16x32_bf16 v[132:135], v[172:175], a[244:247], v[132:135]
  ds_read_b64_tr_b16 v[164:165], v8 offset:20480
  ds_read_b64_tr_b16 v[166:167], v8 offset:20992
  v_mfma_f32_16x16x32_bf16 v[136:139], v[172:175], a[248:251], v[136:139]
  v_mul_f32 v41, v41, v25
  v_mul_f32 v42, v42, v26
  v_mfma_f32_16x16x32_bf16 v[136:139], v[176:179], v[232:235], v[136:139]
  s_add_u32 m0, s82, 57088
  v_mul_f32 v43, v43, v27
  v_mul_f32 v28, s96, v44
  v_mfma_f32_16x16x32_bf16 v[136:139], v[180:183], v[248:251], v[136:139]
  buffer_load_dwordx4 v4, s[12:15], s56 offen offset:256 lds
  v_mfma_f32_16x16x32_bf16 v[140:143], v[180:183], v[252:255], v[140:143]
  ds_read_b64_tr_b16 v[168:169], v8 offset:16384
  ds_read_b64_tr_b16 v[170:171], v8 offset:16896
  v_mfma_f32_16x16x32_bf16 v[140:143], v[176:179], v[236:239], v[140:143]
  v_mul_f32 v29, s96, v45
  v_mul_f32 v30, s96, v46
  v_mfma_f32_16x16x32_bf16 v[140:143], v[172:175], a[252:255], v[140:143]
  s_waitcnt lgkmcnt(6)
  v_mul_f32 v31, s96, v47
  v_exp_f32 v28, v28
  v_mfma_f32_16x16x32_bf16 v[144:147], v[184:187], a[240:243], v[144:147]
  ds_read_b64_tr_b16 v[172:173], v11 offset:24576
  ds_read_b64_tr_b16 v[174:175], v11 offset:25088
  v_mfma_f32_16x16x32_bf16 v[144:147], v[188:191], v[224:227], v[144:147]
  v_exp_f32 v29, v29
  v_mfma_f32_16x16x32_bf16 v[144:147], v[192:195], v[240:243], v[144:147]
  s_add_u32 m0, s82, 52992
  v_exp_f32 v30, v30
  v_mfma_f32_16x16x32_bf16 v[148:151], v[192:195], v[244:247], v[148:151]
  buffer_load_dwordx4 v4, s[12:15], s57 offen offset:256 lds
  v_mfma_f32_16x16x32_bf16 v[148:151], v[188:191], v[228:231], v[148:151]
  ds_read_b64_tr_b16 v[176:177], v11 offset:20480
  ds_read_b64_tr_b16 v[178:179], v11 offset:20992
  v_mfma_f32_16x16x32_bf16 v[148:151], v[184:187], a[244:247], v[148:151]
  v_exp_f32 v31, v31
  v_mfma_f32_16x16x32_bf16 v[152:155], v[184:187], a[248:251], v[152:155]
  v_add_f32 v28, 1.0, v28
  v_add_f32 v29, 1.0, v29
  v_add_f32 v30, 1.0, v30
  v_mfma_f32_16x16x32_bf16 v[152:155], v[188:191], v[232:235], v[152:155]
  s_add_u32 m0, s82, 48896
  ds_read_b64_tr_b16 v[180:181], v11 offset:16384
  ds_read_b64_tr_b16 v[182:183], v11 offset:16896
  v_mfma_f32_16x16x32_bf16 v[152:155], v[192:195], v[248:251], v[152:155]
  buffer_load_dwordx4 v4, s[12:15], s58 offen offset:256 lds
  v_mfma_f32_16x16x32_bf16 v[156:159], v[192:195], v[252:255], v[156:159]
  v_add_f32 v31, 1.0, v31
  v_mfma_f32_16x16x32_bf16 v[156:159], v[188:191], v[236:239], v[156:159]
  v_rcp_f32 v28, v28
  v_mfma_f32_16x16x32_bf16 v[156:159], v[184:187], a[252:255], v[156:159]
  s_waitcnt lgkmcnt(6)
  v_rcp_f32 v29, v29
  v_mfma_f32_16x16x32_bf16 v[96:99], v[160:163], a[0:3], 0
  ds_read_b64_tr_b16 v[184:185], v8 offset:4096
  ds_read_b64_tr_b16 v[186:187], v8 offset:4608
  v_mfma_f32_16x16x32_bf16 v[96:99], v[164:167], a[16:19], v[96:99]
  v_rcp_f32 v30, v30
  v_mfma_f32_16x16x32_bf16 v[96:99], v[168:171], a[32:35], v[96:99]
  s_add_u32 m0, s82, 36608
  v_rcp_f32 v31, v31
  v_mul_f32 v44, v44, v28
  v_mfma_f32_16x16x32_bf16 v[100:103], v[168:171], a[36:39], 0
  buffer_load_dwordx4 v4, s[12:15], s59 offen offset:256 lds
  v_mfma_f32_16x16x32_bf16 v[100:103], v[164:167], a[20:23], v[100:103]
  ds_read_b64_tr_b16 v[188:189], v8 offset:0
  ds_read_b64_tr_b16 v[190:191], v8 offset:512
  v_mfma_f32_16x16x32_bf16 v[100:103], v[160:163], a[4:7], v[100:103]
  v_mul_f32 v45, v45, v29
  v_mul_f32 v46, v46, v30
  v_mfma_f32_16x16x32_bf16 v[104:107], v[160:163], a[8:11], 0
  v_mul_f32 v47, v47, v31
  v_mul_f32 v24, s96, v48
  v_mfma_f32_16x16x32_bf16 v[104:107], v[164:167], a[24:27], v[104:107]
  s_add_u32 m0, s82, 32512
  ds_read_b64_tr_b16 v[192:193], v7 offset:45056
  ds_read_b64_tr_b16 v[194:195], v7 offset:45568
  v_mfma_f32_16x16x32_bf16 v[104:107], v[168:171], a[40:43], v[104:107]
  buffer_load_dwordx4 v4, s[12:15], s60 offen offset:256 lds
  v_mfma_f32_16x16x32_bf16 v[108:111], v[168:171], a[44:47], 0
  v_mul_f32 v25, s96, v49
  v_mul_f32 v26, s96, v50
  v_mul_f32 v27, s96, v51
  v_mfma_f32_16x16x32_bf16 v[108:111], v[164:167], a[28:31], v[108:111]
  v_exp_f32 v24, v24
  v_mfma_f32_16x16x32_bf16 v[108:111], v[160:163], a[12:15], v[108:111]
  s_waitcnt lgkmcnt(6)
  v_exp_f32 v25, v25
  v_mfma_f32_16x16x32_bf16 v[112:115], v[172:175], a[0:3], 0
  ds_read_b64_tr_b16 v[160:161], v11 offset:4096
  ds_read_b64_tr_b16 v[162:163], v11 offset:4608
  v_mfma_f32_16x16x32_bf16 v[112:115], v[176:179], a[16:19], v[112:115]
  v_lshrrev_b32 v212, 2, v0
  v_mul_u32_u24 v212, 36992, v212
  v_mfma_f32_16x16x32_bf16 v[112:115], v[180:183], a[32:35], v[112:115]
  v_and_b32 v213, 3, v0
  v_lshl_add_u32 v212, v213, 4, v212
  v_mfma_f32_16x16x32_bf16 v[116:119], v[180:183], a[36:39], 0
  s_cmp_lt_u32 s98, 288
  s_cselect_b32 s38, 0, 0x80000000
  v_or_b32 v212, s38, v212
  v_mfma_f32_16x16x32_bf16 v[116:119], v[176:179], a[20:23], v[116:119]
  s_add_u32 s38, s36, 591872
  ds_read_b64_tr_b16 v[164:165], v11 offset:0
  ds_read_b64_tr_b16 v[166:167], v11 offset:512
  v_mfma_f32_16x16x32_bf16 v[116:119], v[172:175], a[4:7], v[116:119]
  buffer_load_dwordx4 v[196:199], v212, s[32:35], s36 offen
  v_mfma_f32_16x16x32_bf16 v[120:123], v[172:175], a[8:11], 0
  buffer_load_dwordx4 v[200:203], v212, s[32:35], s38 offen
  v_mfma_f32_16x16x32_bf16 v[120:123], v[176:179], a[24:27], v[120:123]
  v_exp_f32 v26, v26
  v_mfma_f32_16x16x32_bf16 v[120:123], v[180:183], a[40:43], v[120:123]
  ds_read_b64_tr_b16 v[168:169], v10 offset:45056
  ds_read_b64_tr_b16 v[170:171], v10 offset:45568
  v_mfma_f32_16x16x32_bf16 v[124:127], v[180:183], a[44:47], 0
  v_exp_f32 v27, v27
  v_add_f32 v24, 1.0, v24
  v_mfma_f32_16x16x32_bf16 v[124:127], v[176:179], a[28:31], v[124:127]
  v_add_f32 v25, 1.0, v25
  v_add_f32 v26, 1.0, v26
  v_add_f32 v27, 1.0, v27
  v_mfma_f32_16x16x32_bf16 v[124:127], v[172:175], a[12:15], v[124:127]
  v_rcp_f32 v24, v24
  s_waitcnt vmcnt(27)
  v_readfirstlane_b32 s91, v218
  s_nop 1
  s_cmp_ge_u32 s91, s77
  s_cbranch_scc0 L_sp0_gated_mix__spectral_gfnet__swiglu_ffn__prompt_kernel
L_bk0_gated_mix__spectral_gfnet__swiglu_ffn__prompt_kernel:
  s_waitcnt vmcnt(11) lgkmcnt(6)
  v_mfma_f32_16x16x32_bf16 v[96:99], v[184:187], a[48:51], v[96:99]
  s_barrier
  v_mfma_f32_16x16x32_bf16 v[96:99], v[188:191], a[64:67], v[96:99]
  ds_read_b64_tr_b16 v[172:173], v7 offset:40960
  ds_read_b64_tr_b16 v[174:175], v7 offset:41472
  v_mfma_f32_16x16x32_bf16 v[96:99], v[192:195], a[80:83], v[96:99]
  buffer_atomic_add v3, v222, s[24:27], s75 offen sc1
  v_mfma_f32_16x16x32_bf16 v[100:103], v[192:195], a[84:87], v[100:103]
  s_add_u32 m0, s82, 93952
  v_rcp_f32 v25, v25
  v_mfma_f32_16x16x32_bf16 v[100:103], v[188:191], a[68:71], v[100:103]
  buffer_load_dwordx4 v4, s[12:15], s61 offen offset:256 lds
  v_mfma_f32_16x16x32_bf16 v[100:103], v[184:187], a[52:55], v[100:103]
  ds_read_b64_tr_b16 v[176:177], v8 offset:61440
  ds_read_b64_tr_b16 v[178:179], v8 offset:61952
  v_mfma_f32_16x16x32_bf16 v[104:107], v[184:187], a[56:59], v[104:107]
  buffer_atomic_add v3, v222, s[24:27], s76 offen sc1
  v_mfma_f32_16x16x32_bf16 v[104:107], v[188:191], a[72:75], v[104:107]
  s_add_u32 m0, s82, 89856
  v_rcp_f32 v26, v26
  v_mfma_f32_16x16x32_bf16 v[104:107], v[192:195], a[88:91], v[104:107]
  buffer_load_dwordx4 v4, s[12:15], s62 offen offset:256 lds
  v_mfma_f32_16x16x32_bf16 v[108:111], v[192:195], a[92:95], v[108:111]
  ds_read_b64_tr_b16 v[180:181], v8 offset:57344
  ds_read_b64_tr_b16 v[182:183], v8 offset:57856
  v_mfma_f32_16x16x32_bf16 v[108:111], v[188:191], a[76:79], v[108:111]
  v_rcp_f32 v27, v27
  v_mul_f32 v48, v48, v24
  v_mfma_f32_16x16x32_bf16 v[108:111], v[184:187], a[60:63], v[108:111]
  s_waitcnt lgkmcnt(6)
  v_mul_f32 v49, v49, v25
  v_mul_f32 v50, v50, v26
  v_mul_f32 v51, v51, v27
  v_mfma_f32_16x16x32_bf16 v[112:115], v[160:163], a[48:51], v[112:115]
  ds_read_b64_tr_b16 v[184:185], v10 offset:40960
  ds_read_b64_tr_b16 v[186:187], v10 offset:41472
  v_mfma_f32_16x16x32_bf16 v[112:115], v[164:167], a[64:67], v[112:115]
  v_mul_f32 v28, s96, v52
  v_mul_f32 v29, s96, v53
  v_mfma_f32_16x16x32_bf16 v[112:115], v[168:171], a[80:83], v[112:115]
  s_add_u32 m0, s82, 85760
  v_mul_f32 v30, s96, v54
  v_mul_f32 v31, s96, v55
  v_mfma_f32_16x16x32_bf16 v[116:119], v[168:171], a[84:87], v[116:119]
  buffer_load_dwordx4 v4, s[12:15], s63 offen offset:256 lds
  v_mfma_f32_16x16x32_bf16 v[116:119], v[164:167], a[68:71], v[116:119]
  ds_read_b64_tr_b16 v[188:189], v11 offset:61440
  ds_read_b64_tr_b16 v[190:191], v11 offset:61952
  v_mfma_f32_16x16x32_bf16 v[116:119], v[160:163], a[52:55], v[116:119]
  v_exp_f32 v28, v28
  v_mfma_f32_16x16x32_bf16 v[120:123], v[160:163], a[56:59], v[120:123]
  v_exp_f32 v29, v29
  v_mfma_f32_16x16x32_bf16 v[120:123], v[164:167], a[72:75], v[120:123]
  s_add_u32 m0, s82, 81664
  ds_read_b64_tr_b16 v[192:193], v11 offset:57344
  ds_read_b64_tr_b16 v[194:195], v11 offset:57856
  v_mfma_f32_16x16x32_bf16 v[120:123], v[168:171], a[88:91], v[120:123]
  buffer_load_dwordx4 v4, s[12:15], s64 offen offset:256 lds
  v_mfma_f32_16x16x32_bf16 v[124:127], v[168:171], a[92:95], v[124:127]
  v_exp_f32 v30, v30
  v_mfma_f32_16x16x32_bf16 v[124:127], v[164:167], a[76:79], v[124:127]
  v_exp_f32 v31, v31
  v_add_f32 v28, 1.0, v28
  v_mfma_f32_16x16x32_bf16 v[124:127], v[160:163], a[60:63], v[124:127]
  s_waitcnt lgkmcnt(6)
  v_add_f32 v29, 1.0, v29
  v_add_f32 v30, 1.0, v30
  v_mfma_f32_16x16x32_bf16 v[96:99], v[172:175], a[96:99], v[96:99]
  ds_read_b64_tr_b16 v[160:161], v8 offset:53248
  ds_read_b64_tr_b16 v[162:163], v8 offset:53760
  v_add_f32 v31, 1.0, v31
  v_mfma_f32_16x16x32_bf16 v[96:99], v[176:179], a[112:115], v[96:99]
  v_rcp_f32 v28, v28
  v_mfma_f32_16x16x32_bf16 v[96:99], v[180:183], a[128:131], v[96:99]
  v_rcp_f32 v29, v29
  v_mfma_f32_16x16x32_bf16 v[100:103], v[180:183], a[132:135], v[100:103]
  v_rcp_f32 v30, v30
  v_mfma_f32_16x16x32_bf16 v[100:103], v[176:179], a[116:119], v[100:103]
  ds_read_b64_tr_b16 v[164:165], v8 offset:49152
  ds_read_b64_tr_b16 v[166:167], v8 offset:49664
  v_mfma_f32_16x16x32_bf16 v[100:103], v[172:175], a[100:103], v[100:103]
  v_rcp_f32 v31, v31
  v_mfma_f32_16x16x32_bf16 v[104:107], v[172:175], a[104:107], v[104:107]
  v_mul_f32 v52, v52, v28
  v_mul_f32 v53, v53, v29
  v_mfma_f32_16x16x32_bf16 v[104:107], v[176:179], a[120:123], v[104:107]
  v_mul_f32 v54, v54, v30
  v_mul_f32 v55, v55, v31
  v_mul_f32 v24, s96, v56
  v_mfma_f32_16x16x32_bf16 v[104:107], v[180:183], a[136:139], v[104:107]
  ds_read_b64_tr_b16 v[168:169], v8 offset:36864
  ds_read_b64_tr_b16 v[170:171], v8 offset:37376
  v_mfma_f32_16x16x32_bf16 v[108:111], v[180:183], a[140:143], v[108:111]
  v_mul_f32 v25, s96, v57
  v_mul_f32 v26, s96, v58
  v_mfma_f32_16x16x32_bf16 v[108:111], v[176:179], a[124:127], v[108:111]
  v_mul_f32 v27, s96, v59
  v_mfma_f32_16x16x32_bf16 v[108:111], v[172:175], a[108:111], v[108:111]
  s_waitcnt lgkmcnt(6)
  v_exp_f32 v24, v24
  v_mfma_f32_16x16x32_bf16 v[112:115], v[184:187], a[96:99], v[112:115]
  ds_read_b64_tr_b16 v[172:173], v11 offset:53248
  ds_read_b64_tr_b16 v[174:175], v11 offset:53760
  v_mfma_f32_16x16x32_bf16 v[112:115], v[188:191], a[112:115], v[112:115]
  v_exp_f32 v25, v25
  v_mfma_f32_16x16x32_bf16 v[112:115], v[192:195], a[128:131], v[112:115]
  v_exp_f32 v26, v26
  v_mfma_f32_16x16x32_bf16 v[116:119], v[192:195], a[132:135], v[116:119]
  v_exp_f32 v27, v27
  v_add_f32 v24, 1.0, v24
  v_mfma_f32_16x16x32_bf16 v[116:119], v[188:191], a[116:119], v[116:119]
  ds_read_b64_tr_b16 v[176:177], v11 offset:49152
  ds_read_b64_tr_b16 v[178:179], v11 offset:49664
  v_mfma_f32_16x16x32_bf16 v[116:119], v[184:187], a[100:103], v[116:119]
  v_add_f32 v25, 1.0, v25
  v_add_f32 v26, 1.0, v26
  v_mfma_f32_16x16x32_bf16 v[120:123], v[184:187], a[104:107], v[120:123]
  v_add_f32 v27, 1.0, v27
  v_mfma_f32_16x16x32_bf16 v[120:123], v[188:191], a[120:123], v[120:123]
  v_rcp_f32 v24, v24
  v_mfma_f32_16x16x32_bf16 v[120:123], v[192:195], a[136:139], v[120:123]
  ds_read_b64_tr_b16 v[180:181], v11 offset:36864
  ds_read_b64_tr_b16 v[182:183], v11 offset:37376
  v_mfma_f32_16x16x32_bf16 v[124:127], v[192:195], a[140:143], v[124:127]
  v_rcp_f32 v25, v25
  v_mfma_f32_16x16x32_bf16 v[124:127], v[188:191], a[124:127], v[124:127]
  v_rcp_f32 v26, v26
  v_mfma_f32_16x16x32_bf16 v[124:127], v[184:187], a[108:111], v[124:127]
  s_waitcnt lgkmcnt(6)
  v_rcp_f32 v27, v27
  v_mul_f32 v56, v56, v24
  v_mfma_f32_16x16x32_bf16 v[96:99], v[160:163], a[144:147], v[96:99]
  s_barrier
  v_mfma_f32_16x16x32_bf16 v[96:99], v[164:167], a[160:163], v[96:99]
  ds_read_b64_tr_b16 v[184:185], v8 offset:32768
  ds_read_b64_tr_b16 v[186:187], v8 offset:33280
  v_mul_f32 v57, v57, v25
  v_mfma_f32_16x16x32_bf16 v[96:99], v[168:171], a[176:179], v[96:99]
  v_mul_f32 v58, v58, v26
  v_mul_f32 v59, v59, v27
  v_mfma_f32_16x16x32_bf16 v[100:103], v[168:171], a[180:183], v[100:103]
  s_add_u32 m0, s82, 126720
  v_mul_f32 v28, s96, v60
  v_mul_f32 v29, s96, v61
  v_mfma_f32_16x16x32_bf16 v[100:103], v[164:167], a[164:167], v[100:103]
  buffer_load_dwordx4 v4, s[12:15], s65 offen offset:256 lds
  v_mfma_f32_16x16x32_bf16 v[100:103], v[160:163], a[148:151], v[100:103]
  ds_read_b64_tr_b16 v[188:189], v9 offset:28672
  ds_read_b64_tr_b16 v[190:191], v9 offset:29184
  v_mfma_f32_16x16x32_bf16 v[104:107], v[160:163], a[152:155], v[104:107]
  v_mul_f32 v30, s96, v62
  v_mul_f32 v31, s96, v63
  v_mfma_f32_16x16x32_bf16 v[104:107], v[164:167], a[168:171], v[104:107]
  s_add_u32 m0, s82, 122624
  v_exp_f32 v28, v28
  v_mfma_f32_16x16x32_bf16 v[104:107], v[168:171], a[184:187], v[104:107]
  buffer_load_dwordx4 v4, s[16:19], s48 offen offset:256 lds
  v_mfma_f32_16x16x32_bf16 v[108:111], v[168:171], a[188:191], v[108:111]
  ds_read_b64_tr_b16 v[192:193], v9 offset:24576
  ds_read_b64_tr_b16 v[194:195], v9 offset:25088
  v_mfma_f32_16x16x32_bf16 v[108:111], v[164:167], a[172:175], v[108:111]
  v_exp_f32 v29, v29
  v_mfma_f32_16x16x32_bf16 v[108:111], v[160:163], a[156:159], v[108:111]
  s_waitcnt lgkmcnt(6)
  v_exp_f32 v30, v30
  v_exp_f32 v31, v31
  v_mfma_f32_16x16x32_bf16 v[112:115], v[172:175], a[144:147], v[112:115]
  ds_read_b64_tr_b16 v[160:161], v11 offset:32768
  ds_read_b64_tr_b16 v[162:163], v11 offset:33280
  v_mfma_f32_16x16x32_bf16 v[112:115], v[176:179], a[160:163], v[112:115]
  v_add_f32 v28, 1.0, v28
  v_add_f32 v29, 1.0, v29
  v_mfma_f32_16x16x32_bf16 v[112:115], v[180:183], a[176:179], v[112:115]
  s_add_u32 m0, s82, 69376
  v_add_f32 v30, 1.0, v30
  v_add_f32 v31, 1.0, v31
  v_mfma_f32_16x16x32_bf16 v[116:119], v[180:183], a[180:183], v[116:119]
  buffer_load_dwordx4 v4, s[16:19], s49 offen offset:256 lds
  v_mfma_f32_16x16x32_bf16 v[116:119], v[176:179], a[164:167], v[116:119]
  ds_read_b64_tr_b16 v[164:165], v12 offset:28672
  ds_read_b64_tr_b16 v[166:167], v12 offset:29184
  v_mfma_f32_16x16x32_bf16 v[116:119], v[172:175], a[148:151], v[116:119]
  v_rcp_f32 v28, v28
  v_mfma_f32_16x16x32_bf16 v[120:123], v[172:175], a[152:155], v[120:123]
  v_rcp_f32 v29, v29
  v_mfma_f32_16x16x32_bf16 v[120:123], v[176:179], a[168:171], v[120:123]
  s_add_u32 m0, s82, 65280
  ds_read_b64_tr_b16 v[168:169], v12 offset:24576
  ds_read_b64_tr_b16 v[170:171], v12 offset:25088
  v_mfma_f32_16x16x32_bf16 v[120:123], v[180:183], a[184:187], v[120:123]
  buffer_load_dwordx4 v4, s[16:19], s50 offen offset:256 lds
  v_mfma_f32_16x16x32_bf16 v[124:127], v[180:183], a[188:191], v[124:127]
  v_rcp_f32 v30, v30
  v_mfma_f32_16x16x32_bf16 v[124:127], v[176:179], a[172:175], v[124:127]
  v_rcp_f32 v31, v31
  v_mul_f32 v60, v60, v28
  v_mfma_f32_16x16x32_bf16 v[124:127], v[172:175], a[156:159], v[124:127]
  s_waitcnt lgkmcnt(6)
  v_mul_f32 v61, v61, v29
  v_mul_f32 v62, v62, v30
  v_mul_f32 v63, v63, v31
  v_mfma_f32_16x16x32_bf16 v[96:99], v[184:187], a[192:195], v[96:99]
  ds_read_b64_tr_b16 v[172:173], v9 offset:20480
  ds_read_b64_tr_b16 v[174:175], v9 offset:20992
  v_mfma_f32_16x16x32_bf16 v[96:99], v[188:191], a[208:211], v[96:99]
  buffer_load_dword v23, v20, s[20:23], 0 offen
  v_mfma_f32_16x16x32_bf16 v[96:99], v[192:195], a[224:227], v[96:99]
  s_add_u32 m0, s82, 44800
  v_add_u32 v20, 3456, v20
  v_mul_f32 v32, v32, v64
  v_mfma_f32_16x16x32_bf16 v[100:103], v[192:195], a[228:231], v[100:103]
  buffer_load_dwordx4 v4, s[16:19], s51 offen offset:256 lds
  v_mfma_f32_16x16x32_bf16 v[100:103], v[188:191], a[212:215], v[100:103]
  ds_read_b64_tr_b16 v[176:177], v8 offset:45056
  ds_read_b64_tr_b16 v[178:179], v8 offset:45568
  v_mul_f32 v33, v33, v65
  v_mfma_f32_16x16x32_bf16 v[100:103], v[184:187], a[196:199], v[100:103]
  v_mul_f32 v34, v34, v66
  v_mul_f32 v35, v35, v67
  v_mfma_f32_16x16x32_bf16 v[104:107], v[184:187], a[200:203], v[104:107]
  v_mul_f32 v48, v48, v80
  v_mul_f32 v49, v49, v81
  v_mfma_f32_16x16x32_bf16 v[104:107], v[188:191], a[216:219], v[104:107]
  s_add_u32 m0, s82, 40704
  ds_read_b64_tr_b16 v[180:181], v8 offset:40960
  ds_read_b64_tr_b16 v[182:183], v8 offset:41472
  v_mfma_f32_16x16x32_bf16 v[104:107], v[192:195], a[232:235], v[104:107]
  buffer_load_dwordx4 v4, s[16:19], s52 offen offset:256 lds
  v_mfma_f32_16x16x32_bf16 v[108:111], v[192:195], a[236:239], v[108:111]
  v_mul_f32 v50, v50, v82
  v_mul_f32 v51, v51, v83
  v_mfma_f32_16x16x32_bf16 v[108:111], v[188:191], a[220:223], v[108:111]
  v_cvt_pk_bf16_f32 v64, v32, v33
  v_cvt_pk_bf16_f32 v65, v34, v35
  v_cvt_pk_bf16_f32 v66, v48, v49
  v_mfma_f32_16x16x32_bf16 v[108:111], v[184:187], a[204:207], v[108:111]
  s_waitcnt lgkmcnt(6)
  v_cvt_pk_bf16_f32 v67, v50, v51
  v_mul_f32 v24, s96, v128
  v_mfma_f32_16x16x32_bf16 v[112:115], v[160:163], a[192:195], v[112:115]
  ds_read_b64_tr_b16 v[184:185], v12 offset:20480
  ds_read_b64_tr_b16 v[186:187], v12 offset:20992
  v_mfma_f32_16x16x32_bf16 v[112:115], v[164:167], a[208:211], v[112:115]
  ds_write_b128 v19, v[64:67] offset:0
  v_mfma_f32_16x16x32_bf16 v[112:115], v[168:171], a[224:227], v[112:115]
  v_mul_f32 v36, v36, v68
  v_mul_f32 v37, v37, v69
  v_mfma_f32_16x16x32_bf16 v[116:119], v[168:171], a[228:231], v[116:119]
  v_mul_f32 v38, v38, v70
  v_mul_f32 v39, v39, v71
  v_mul_f32 v52, v52, v84
  v_mfma_f32_16x16x32_bf16 v[116:119], v[164:167], a[212:215], v[116:119]
  ds_read_b64_tr_b16 v[188:189], v11 offset:45056
  ds_read_b64_tr_b16 v[190:191], v11 offset:45568
  v_mfma_f32_16x16x32_bf16 v[116:119], v[160:163], a[196:199], v[116:119]
  v_mul_f32 v53, v53, v85
  v_mul_f32 v54, v54, v86
  v_mfma_f32_16x16x32_bf16 v[120:123], v[160:163], a[200:203], v[120:123]
  v_mul_f32 v55, v55, v87
  v_cvt_pk_bf16_f32 v68, v36, v37
  v_mfma_f32_16x16x32_bf16 v[120:123], v[164:167], a[216:219], v[120:123]
  v_cvt_pk_bf16_f32 v69, v38, v39
  v_cvt_pk_bf16_f32 v70, v52, v53
  v_mfma_f32_16x16x32_bf16 v[120:123], v[168:171], a[232:235], v[120:123]
  ds_read_b64_tr_b16 v[192:193], v11 offset:40960
  ds_read_b64_tr_b16 v[194:195], v11 offset:41472
  v_cvt_pk_bf16_f32 v71, v54, v55
  v_mfma_f32_16x16x32_bf16 v[124:127], v[168:171], a[236:239], v[124:127]
  ds_write_b128 v19, v[68:71] offset:1024
  v_mfma_f32_16x16x32_bf16 v[124:127], v[164:167], a[220:223], v[124:127]
  v_mul_f32 v40, v40, v72
  v_mul_f32 v41, v41, v73
  v_mfma_f32_16x16x32_bf16 v[124:127], v[160:163], a[204:207], v[124:127]
  s_waitcnt vmcnt(23) lgkmcnt(8)
  v_mul_f32 v42, v42, v74
  v_mul_f32 v43, v43, v75
  v_mfma_f32_16x16x32_bf16 v[96:99], v[172:175], a[240:243], v[96:99]
  s_barrier
  v_mfma_f32_16x16x32_bf16 v[96:99], v[176:179], v[224:227], v[96:99]
  ds_read_b64_tr_b16 v[160:161], v8 offset:12288
  ds_read_b64_tr_b16 v[162:163], v8 offset:12800
  v_mul_f32 v56, v56, v88
  v_mfma_f32_16x16x32_bf16 v[96:99], v[180:183], v[240:243], v[96:99]
  v_mul_f32 v57, v57, v89
  v_mul_f32 v58, v58, v90
  v_mfma_f32_16x16x32_bf16 v[100:103], v[180:183], v[244:247], v[100:103]
  s_add_u32 m0, s82, 159488
  v_mul_f32 v59, v59, v91
  v_cvt_pk_bf16_f32 v72, v40, v41
  v_mfma_f32_16x16x32_bf16 v[100:103], v[176:179], v[228:231], v[100:103]
  buffer_load_dwordx4 v4, s[16:19], s53 offen offset:256 lds
  v_mfma_f32_16x16x32_bf16 v[100:103], v[172:175], a[244:247], v[100:103]
  ds_read_b64_tr_b16 v[164:165], v8 offset:8192
  ds_read_b64_tr_b16 v[166:167], v8 offset:8704
  v_mfma_f32_16x16x32_bf16 v[104:107], v[172:175], a[248:251], v[104:107]
  v_cvt_pk_bf16_f32 v73, v42, v43
  v_cvt_pk_bf16_f32 v74, v56, v57
  v_cvt_pk_bf16_f32 v75, v58, v59
  v_mfma_f32_16x16x32_bf16 v[104:107], v[176:179], v[232:235], v[104:107]
  s_add_u32 m0, s82, 155392
  v_mul_f32 v25, s96, v129
  v_mul_f32 v26, s96, v130
  v_mfma_f32_16x16x32_bf16 v[104:107], v[180:183], v[248:251], v[104:107]
  buffer_load_dwordx4 v4, s[16:19], s54 offen offset:256 lds
  v_mfma_f32_16x16x32_bf16 v[108:111], v[180:183], v[252:255], v[108:111]
  ds_read_b64_tr_b16 v[168:169], v9 offset:16384
  ds_read_b64_tr_b16 v[170:171], v9 offset:16896
  v_mfma_f32_16x16x32_bf16 v[108:111], v[176:179], v[236:239], v[108:111]
  ds_write_b128 v19, v[72:75] offset:2048
  v_mfma_f32_16x16x32_bf16 v[108:111], v[172:175], a[252:255], v[108:111]
  s_waitcnt lgkmcnt(8)
  v_mul_f32 v44, v44, v76
  v_mul_f32 v45, v45, v77
  v_mul_f32 v46, v46, v78
  v_mfma_f32_16x16x32_bf16 v[112:115], v[184:187], a[240:243], v[112:115]
  ds_read_b64_tr_b16 v[172:173], v11 offset:12288
  ds_read_b64_tr_b16 v[174:175], v11 offset:12800
  v_mul_f32 v47, v47, v79
  v_mfma_f32_16x16x32_bf16 v[112:115], v[188:191], v[224:227], v[112:115]
  v_mul_f32 v60, v60, v92
  v_mul_f32 v61, v61, v93
  v_mfma_f32_16x16x32_bf16 v[112:115], v[192:195], v[240:243], v[112:115]
  s_add_u32 m0, s82, 118528
  v_mul_f32 v62, v62, v94
  v_mul_f32 v63, v63, v95
  v_cvt_pk_bf16_f32 v76, v44, v45
  v_mfma_f32_16x16x32_bf16 v[116:119], v[192:195], v[244:247], v[116:119]
  buffer_load_dwordx4 v4, s[16:19], s55 offen offset:256 lds
  v_mfma_f32_16x16x32_bf16 v[116:119], v[188:191], v[228:231], v[116:119]
  ds_read_b64_tr_b16 v[176:177], v11 offset:8192
  ds_read_b64_tr_b16 v[178:179], v11 offset:8704
  v_mfma_f32_16x16x32_bf16 v[116:119], v[184:187], a[244:247], v[116:119]
  v_cvt_pk_bf16_f32 v77, v46, v47
  v_cvt_pk_bf16_f32 v78, v60, v61
  v_cvt_pk_bf16_f32 v79, v62, v63
  v_mfma_f32_16x16x32_bf16 v[120:123], v[184:187], a[248:251], v[120:123]
  ds_write_b128 v19, v[76:79] offset:3072
  v_mfma_f32_16x16x32_bf16 v[120:123], v[188:191], v[232:235], v[120:123]
  s_add_u32 m0, s82, 114432
  ds_read_b64_tr_b16 v[180:181], v12 offset:16384
  ds_read_b64_tr_b16 v[182:183], v12 offset:16896
  v_mfma_f32_16x16x32_bf16 v[120:123], v[192:195], v[248:251], v[120:123]
  buffer_load_dwordx4 v4, s[16:19], s56 offen offset:256 lds
  v_mfma_f32_16x16x32_bf16 v[124:127], v[192:195], v[252:255], v[124:127]
  s_add_u32 s47, s46, 0
  v_mul_f32 v27, s96, v131
  v_mfma_f32_16x16x32_bf16 v[124:127], v[188:191], v[236:239], v[124:127]
  buffer_store_dwordx4 v[64:67], v19, s[24:27], s47 offen offset:0 sc1
  v_mfma_f32_16x16x32_bf16 v[124:127], v[184:187], a[252:255], v[124:127]
  s_waitcnt lgkmcnt(8)
  v_exp_f32 v24, v24
  v_mfma_f32_16x16x32_bf16 v[32:35], v[160:163], a[0:3], 0
  ds_read_b64_tr_b16 v[184:185], v9 offset:12288
  ds_read_b64_tr_b16 v[186:187], v9 offset:12800
  v_mfma_f32_16x16x32_bf16 v[32:35], v[164:167], a[16:19], v[32:35]
  v_exp_f32 v25, v25
  v_mfma_f32_16x16x32_bf16 v[32:35], v[168:171], a[32:35], v[32:35]
  s_add_u32 m0, s82, 102144
  v_exp_f32 v26, v26
  v_mfma_f32_16x16x32_bf16 v[36:39], v[168:171], a[36:39], 0
  buffer_load_dwordx4 v4, s[16:19], s57 offen offset:256 lds
  v_mfma_f32_16x16x32_bf16 v[36:39], v[164:167], a[20:23], v[36:39]
  ds_read_b64_tr_b16 v[188:189], v9 offset:8192
  ds_read_b64_tr_b16 v[190:191], v9 offset:8704
  v_mfma_f32_16x16x32_bf16 v[36:39], v[160:163], a[4:7], v[36:39]
  v_exp_f32 v27, v27
  v_mfma_f32_16x16x32_bf16 v[40:43], v[160:163], a[8:11], 0
  v_add_f32 v24, 1.0, v24
  v_add_f32 v25, 1.0, v25
  v_mfma_f32_16x16x32_bf16 v[40:43], v[164:167], a[24:27], v[40:43]
  s_add_u32 m0, s82, 98048
  ds_read_b64_tr_b16 v[192:193], v9 offset:4096
  ds_read_b64_tr_b16 v[194:195], v9 offset:4608
  v_mfma_f32_16x16x32_bf16 v[40:43], v[168:171], a[40:43], v[40:43]
  buffer_load_dwordx4 v4, s[16:19], s58 offen offset:256 lds
  v_mfma_f32_16x16x32_bf16 v[44:47], v[168:171], a[44:47], 0
  v_add_f32 v26, 1.0, v26
  v_add_f32 v27, 1.0, v27
  v_mfma_f32_16x16x32_bf16 v[44:47], v[164:167], a[28:31], v[44:47]
  v_rcp_f32 v24, v24
  v_mfma_f32_16x16x32_bf16 v[44:47], v[160:163], a[12:15], v[44:47]
  s_waitcnt lgkmcnt(6)
  v_rcp_f32 v25, v25
  v_mfma_f32_16x16x32_bf16 v[48:51], v[172:175], a[0:3], 0
  ds_read_b64_tr_b16 v[160:161], v12 offset:12288
  ds_read_b64_tr_b16 v[162:163], v12 offset:12800
  v_mfma_f32_16x16x32_bf16 v[48:51], v[176:179], a[16:19], v[48:51]
  v_lshrrev_b32 v212, 2, v0
  v_mul_u32_u24 v212, 36992, v212
  v_mfma_f32_16x16x32_bf16 v[48:51], v[180:183], a[32:35], v[48:51]
  v_and_b32 v213, 3, v0
  v_lshl_add_u32 v212, v213, 4, v212
  v_mfma_f32_16x16x32_bf16 v[52:55], v[180:183], a[36:39], 0
  s_cmp_lt_u32 s99, 288
  s_cselect_b32 s38, 0, 0x80000000
  v_or_b32 v212, s38, v212
  v_mfma_f32_16x16x32_bf16 v[52:55], v[176:179], a[20:23], v[52:55]
  s_add_u32 s38, s37, 591872
  ds_read_b64_tr_b16 v[164:165], v12 offset:8192
  ds_read_b64_tr_b16 v[166:167], v12 offset:8704
  v_mfma_f32_16x16x32_bf16 v[52:55], v[172:175], a[4:7], v[52:55]
  buffer_load_dwordx4 v[204:207], v212, s[32:35], s37 offen
  v_mfma_f32_16x16x32_bf16 v[56:59], v[172:175], a[8:11], 0
  buffer_load_dwordx4 v[208:211], v212, s[32:35], s38 offen
  v_mfma_f32_16x16x32_bf16 v[56:59], v[176:179], a[24:27], v[56:59]
  v_rcp_f32 v26, v26
  v_mfma_f32_16x16x32_bf16 v[56:59], v[180:183], a[40:43], v[56:59]
  ds_read_b64_tr_b16 v[168:169], v12 offset:4096
  ds_read_b64_tr_b16 v[170:171], v12 offset:4608
  v_mfma_f32_16x16x32_bf16 v[60:63], v[180:183], a[44:47], 0
  v_rcp_f32 v27, v27
  v_mul_f32 v128, v128, v24
  v_mfma_f32_16x16x32_bf16 v[60:63], v[176:179], a[28:31], v[60:63]
  v_mul_f32 v129, v129, v25
  v_mul_f32 v130, v130, v26
  v_mfma_f32_16x16x32_bf16 v[60:63], v[172:175], a[12:15], v[60:63]
  s_waitcnt vmcnt(25) lgkmcnt(6)
  v_mul_f32 v131, v131, v27
  v_mul_f32 v28, s96, v132
  v_mfma_f32_16x16x32_bf16 v[32:35], v[184:187], a[48:51], v[32:35]
  s_barrier
  v_mfma_f32_16x16x32_bf16 v[32:35], v[188:191], a[64:67], v[32:35]
  ds_read_b64_tr_b16 v[172:173], v9 offset:0
  ds_read_b64_tr_b16 v[174:175], v9 offset:512
  v_mfma_f32_16x16x32_bf16 v[32:35], v[192:195], a[80:83], v[32:35]
  v_mul_f32 v29, s96, v133
  v_mul_f32 v30, s96, v134
  v_mfma_f32_16x16x32_bf16 v[36:39], v[192:195], a[84:87], v[36:39]
  s_add_u32 m0, s82, 151296
  v_mul_f32 v31, s96, v135
  v_mfma_f32_16x16x32_bf16 v[36:39], v[188:191], a[68:71], v[36:39]
  buffer_load_dwordx4 v4, s[16:19], s59 offen offset:256 lds
  v_mfma_f32_16x16x32_bf16 v[36:39], v[184:187], a[52:55], v[36:39]
  ds_read_b64_tr_b16 v[176:177], v7 offset:61440
  ds_read_b64_tr_b16 v[178:179], v7 offset:61952
  v_mfma_f32_16x16x32_bf16 v[40:43], v[184:187], a[56:59], v[40:43]
  buffer_store_dwordx4 v[68:71], v19, s[24:27], s47 offen offset:1024 sc1
  v_mfma_f32_16x16x32_bf16 v[40:43], v[188:191], a[72:75], v[40:43]
  s_add_u32 m0, s82, 147200
  v_exp_f32 v28, v28
  v_mfma_f32_16x16x32_bf16 v[40:43], v[192:195], a[88:91], v[40:43]
  buffer_load_dwordx4 v4, s[16:19], s60 offen offset:256 lds
  v_mfma_f32_16x16x32_bf16 v[44:47], v[192:195], a[92:95], v[44:47]
  ds_read_b64_tr_b16 v[180:181], v7 offset:57344
  ds_read_b64_tr_b16 v[182:183], v7 offset:57856
  v_mfma_f32_16x16x32_bf16 v[44:47], v[188:191], a[76:79], v[44:47]
  v_exp_f32 v29, v29
  v_mfma_f32_16x16x32_bf16 v[44:47], v[184:187], a[60:63], v[44:47]
  s_waitcnt lgkmcnt(6)
  v_exp_f32 v30, v30
  v_mfma_f32_16x16x32_bf16 v[48:51], v[160:163], a[48:51], v[48:51]
  ds_read_b64_tr_b16 v[184:185], v12 offset:0
  ds_read_b64_tr_b16 v[186:187], v12 offset:512
  v_mfma_f32_16x16x32_bf16 v[48:51], v[164:167], a[64:67], v[48:51]
  v_exp_f32 v31, v31
  v_add_f32 v28, 1.0, v28
  v_mfma_f32_16x16x32_bf16 v[48:51], v[168:171], a[80:83], v[48:51]
  s_add_u32 m0, s82, 110336
  v_add_f32 v29, 1.0, v29
  v_add_f32 v30, 1.0, v30
  v_mfma_f32_16x16x32_bf16 v[52:55], v[168:171], a[84:87], v[52:55]
  buffer_load_dwordx4 v4, s[16:19], s61 offen offset:256 lds
  v_mfma_f32_16x16x32_bf16 v[52:55], v[164:167], a[68:71], v[52:55]
  ds_read_b64_tr_b16 v[188:189], v10 offset:61440
  ds_read_b64_tr_b16 v[190:191], v10 offset:61952
  v_mfma_f32_16x16x32_bf16 v[52:55], v[160:163], a[52:55], v[52:55]
  v_add_f32 v31, 1.0, v31
  v_mfma_f32_16x16x32_bf16 v[56:59], v[160:163], a[56:59], v[56:59]
  v_rcp_f32 v28, v28
  v_mfma_f32_16x16x32_bf16 v[56:59], v[164:167], a[72:75], v[56:59]
  s_add_u32 m0, s82, 106240
  ds_read_b64_tr_b16 v[192:193], v10 offset:57344
  ds_read_b64_tr_b16 v[194:195], v10 offset:57856
  v_mfma_f32_16x16x32_bf16 v[56:59], v[168:171], a[88:91], v[56:59]
  buffer_load_dwordx4 v4, s[16:19], s62 offen offset:256 lds
  v_mfma_f32_16x16x32_bf16 v[60:63], v[168:171], a[92:95], v[60:63]
  v_rcp_f32 v29, v29
  v_mfma_f32_16x16x32_bf16 v[60:63], v[164:167], a[76:79], v[60:63]
  s_lshr_b32 s75, s98, 5
  v_rcp_f32 v30, v30
  v_mfma_f32_16x16x32_bf16 v[60:63], v[160:163], a[60:63], v[60:63]
  s_waitcnt lgkmcnt(6)
  v_rcp_f32 v31, v31
  v_mul_f32 v132, v132, v28
  v_mfma_f32_16x16x32_bf16 v[32:35], v[172:175], a[96:99], v[32:35]
  ds_read_b64_tr_b16 v[160:161], v7 offset:53248
  ds_read_b64_tr_b16 v[162:163], v7 offset:53760
  v_mfma_f32_16x16x32_bf16 v[32:35], v[176:179], a[112:115], v[32:35]
  s_cmp_eq_u32 s75, 9
  s_cselect_b32 s75, 0, s75
  v_mul_f32 v133, v133, v29
  v_mfma_f32_16x16x32_bf16 v[32:35], v[180:183], a[128:131], v[32:35]
  s_add_u32 m0, s82, 77568
  v_mul_f32 v134, v134, v30
  v_mul_f32 v135, v135, v31
  v_mfma_f32_16x16x32_bf16 v[36:39], v[180:183], a[132:135], v[36:39]
  buffer_load_dwordx4 v4, s[16:19], s63 offen offset:256 lds
  v_mfma_f32_16x16x32_bf16 v[36:39], v[176:179], a[116:119], v[36:39]
  s_add_u32 s75, s75, 0
  ds_read_b64_tr_b16 v[164:165], v7 offset:49152
  ds_read_b64_tr_b16 v[166:167], v7 offset:49664
  v_mfma_f32_16x16x32_bf16 v[36:39], v[172:175], a[100:103], v[36:39]
  s_add_u32 s83, s79, 34
  v_mul_f32 v24, s96, v136
  v_mul_f32 v25, s96, v137
  v_mfma_f32_16x16x32_bf16 v[40:43], v[172:175], a[104:107], v[40:43]
  s_cmp_gt_u32 s98, 288
  s_cselect_b32 s75, s83, s75
  v_mul_f32 v26, s96, v138
  v_mul_f32 v27, s96, v139
  v_mfma_f32_16x16x32_bf16 v[40:43], v[176:179], a[120:123], v[40:43]
  s_add_u32 m0, s82, 73472
  ds_read_b64_tr_b16 v[168:169], v7 offset:36864
  ds_read_b64_tr_b16 v[170:171], v7 offset:37376
  v_mfma_f32_16x16x32_bf16 v[40:43], v[180:183], a[136:139], v[40:43]
  buffer_load_dwordx4 v4, s[16:19], s64 offen offset:256 lds
  v_mfma_f32_16x16x32_bf16 v[44:47], v[180:183], a[140:143], v[44:47]
  s_lshl_b32 s75, s75, 7
  v_exp_f32 v24, v24
  v_mfma_f32_16x16x32_bf16 v[44:47], v[176:179], a[124:127], v[44:47]
  s_add_u32 s75, s75, 6422528
  v_exp_f32 v25, v25
  v_mfma_f32_16x16x32_bf16 v[44:47], v[172:175], a[108:111], v[44:47]
  s_waitcnt lgkmcnt(6)
  v_exp_f32 v26, v26
  v_mfma_f32_16x16x32_bf16 v[48:51], v[184:187], a[96:99], v[48:51]
  s_lshr_b32 s76, s99, 5
  ds_read_b64_tr_b16 v[172:173], v10 offset:53248
  ds_read_b64_tr_b16 v[174:175], v10 offset:53760
  v_mfma_f32_16x16x32_bf16 v[48:51], v[188:191], a[112:115], v[48:51]
  buffer_store_dwordx4 v[72:75], v19, s[24:27], s47 offen offset:2048 sc1
  v_mfma_f32_16x16x32_bf16 v[48:51], v[192:195], a[128:131], v[48:51]
  s_cmp_eq_u32 s76, 9
  s_cselect_b32 s76, 0, s76
  v_mfma_f32_16x16x32_bf16 v[52:55], v[192:195], a[132:135], v[52:55]
  s_add_u32 s76, s76, 0
  v_exp_f32 v27, v27
  v_add_f32 v24, 1.0, v24
  v_mfma_f32_16x16x32_bf16 v[52:55], v[188:191], a[116:119], v[52:55]
  s_add_u32 s83, s79, 34
  ds_read_b64_tr_b16 v[176:177], v10 offset:49152
  ds_read_b64_tr_b16 v[178:179], v10 offset:49664
  v_mfma_f32_16x16x32_bf16 v[52:55], v[184:187], a[100:103], v[52:55]
  s_cmp_gt_u32 s99, 288
  s_cselect_b32 s76, s83, s76
  v_add_f32 v25, 1.0, v25
  v_mfma_f32_16x16x32_bf16 v[56:59], v[184:187], a[104:107], v[56:59]
  s_lshl_b32 s76, s76, 7
  v_add_f32 v26, 1.0, v26
  v_add_f32 v27, 1.0, v27
  v_mfma_f32_16x16x32_bf16 v[56:59], v[188:191], a[120:123], v[56:59]
  s_add_u32 s76, s76, 6422528
  v_rcp_f32 v24, v24
  v_mfma_f32_16x16x32_bf16 v[56:59], v[192:195], a[136:139], v[56:59]
  ds_read_b64_tr_b16 v[180:181], v10 offset:36864
  ds_read_b64_tr_b16 v[182:183], v10 offset:37376
  v_mfma_f32_16x16x32_bf16 v[60:63], v[192:195], a[140:143], v[60:63]
  v_rcp_f32 v25, v25
  v_mfma_f32_16x16x32_bf16 v[60:63], v[188:191], a[124:127], v[60:63]
  v_rcp_f32 v26, v26
  v_mfma_f32_16x16x32_bf16 v[60:63], v[184:187], a[108:111], v[60:63]
  s_waitcnt vmcnt(23) lgkmcnt(6)
  v_rcp_f32 v27, v27
  v_mul_f32 v136, v136, v24
  v_mfma_f32_16x16x32_bf16 v[32:35], v[160:163], a[144:147], v[32:35]
  s_barrier
  v_mfma_f32_16x16x32_bf16 v[32:35], v[164:167], a[160:163], v[32:35]
  ds_read_b64_tr_b16 v[184:185], v7 offset:32768
  ds_read_b64_tr_b16 v[186:187], v7 offset:33280
  v_mfma_f32_16x16x32_bf16 v[32:35], v[168:171], a[176:179], v[32:35]
  v_mul_f32 v137, v137, v25
  v_mul_f32 v138, v138, v26
  v_mfma_f32_16x16x32_bf16 v[36:39], v[168:171], a[180:183], v[36:39]
  s_add_u32 m0, s82, 143104
  v_mul_f32 v139, v139, v27
  v_mul_f32 v28, s96, v140
  v_mfma_f32_16x16x32_bf16 v[36:39], v[164:167], a[164:167], v[36:39]
  buffer_load_dwordx4 v4, s[16:19], s65 offen offset:256 lds
  v_mfma_f32_16x16x32_bf16 v[36:39], v[160:163], a[148:151], v[36:39]
  ds_read_b64_tr_b16 v[188:189], v8 offset:28672
  ds_read_b64_tr_b16 v[190:191], v8 offset:29184
  v_mfma_f32_16x16x32_bf16 v[40:43], v[160:163], a[152:155], v[40:43]
  v_mul_f32 v29, s96, v141
  v_mul_f32 v30, s96, v142
  v_mfma_f32_16x16x32_bf16 v[40:43], v[164:167], a[168:171], v[40:43]
  s_add_u32 m0, s82, 138880
  v_mul_f32 v31, s96, v143
  v_exp_f32 v28, v28
  v_mfma_f32_16x16x32_bf16 v[40:43], v[168:171], a[184:187], v[40:43]
  buffer_load_dwordx4 v4, s[12:15], s48 offen offset:384 lds
  v_mfma_f32_16x16x32_bf16 v[44:47], v[168:171], a[188:191], v[44:47]
  ds_read_b64_tr_b16 v[192:193], v8 offset:24576
  ds_read_b64_tr_b16 v[194:195], v8 offset:25088
  v_mfma_f32_16x16x32_bf16 v[44:47], v[164:167], a[172:175], v[44:47]
  v_exp_f32 v29, v29
  v_mfma_f32_16x16x32_bf16 v[44:47], v[160:163], a[156:159], v[44:47]
  s_waitcnt lgkmcnt(6)
  v_exp_f32 v30, v30
  v_mfma_f32_16x16x32_bf16 v[48:51], v[172:175], a[144:147], v[48:51]
  s_lshr_b32 s92, s79, 1
  ds_read_b64_tr_b16 v[160:161], v10 offset:32768
  ds_read_b64_tr_b16 v[162:163], v10 offset:33280
  v_mfma_f32_16x16x32_bf16 v[48:51], v[176:179], a[160:163], v[48:51]
  s_lshl_b32 s93, s81, 3
  v_exp_f32 v31, v31
  v_mfma_f32_16x16x32_bf16 v[48:51], v[180:183], a[176:179], v[48:51]
  s_add_u32 m0, s82, 134784
  v_add_f32 v28, 1.0, v28
  v_add_f32 v29, 1.0, v29
  v_mfma_f32_16x16x32_bf16 v[52:55], v[180:183], a[180:183], v[52:55]
  buffer_load_dwordx4 v4, s[12:15], s49 offen offset:384 lds
  v_mfma_f32_16x16x32_bf16 v[52:55], v[176:179], a[164:167], v[52:55]
  s_add_u32 s92, s92, s93
  ds_read_b64_tr_b16 v[164:165], v11 offset:28672
  ds_read_b64_tr_b16 v[166:167], v11 offset:29184
  v_lshl_add_u32 v214, v0, 5, s92
  v_mfma_f32_16x16x32_bf16 v[52:55], v[172:175], a[148:151], v[52:55]
  v_mul_u32_u24 v214, 9216, v214
  v_add_f32 v30, 1.0, v30
  v_mfma_f32_16x16x32_bf16 v[56:59], v[172:175], a[152:155], v[56:59]
  s_mul_i32 s92, s80, 576
  v_add_f32 v31, 1.0, v31
  v_mfma_f32_16x16x32_bf16 v[56:59], v[176:179], a[168:171], v[56:59]
  s_add_u32 m0, s82, 130688
  ds_read_b64_tr_b16 v[168:169], v11 offset:24576
  ds_read_b64_tr_b16 v[170:171], v11 offset:25088
  v_mfma_f32_16x16x32_bf16 v[56:59], v[180:183], a[184:187], v[56:59]
  buffer_load_dwordx4 v4, s[12:15], s50 offen offset:384 lds
  v_mfma_f32_16x16x32_bf16 v[60:63], v[180:183], a[188:191], v[60:63]
  buffer_store_dwordx4 v[76:79], v19, s[24:27], s47 offen offset:3072 sc1
  v_mfma_f32_16x16x32_bf16 v[60:63], v[176:179], a[172:175], v[60:63]
  s_and_b32 s93, s80, 1
  v_rcp_f32 v28, v28
  v_mfma_f32_16x16x32_bf16 v[60:63], v[172:175], a[156:159], v[60:63]
  s_waitcnt lgkmcnt(6)
  v_rcp_f32 v29, v29
  v_mfma_f32_16x16x32_bf16 v[32:35], v[184:187], a[192:195], v[32:35]
  s_lshl_b32 s93, s93, 6
  ds_read_b64_tr_b16 v[172:173], v8 offset:20480
  ds_read_b64_tr_b16 v[174:175], v8 offset:20992
  v_mfma_f32_16x16x32_bf16 v[32:35], v[188:191], a[208:211], v[32:35]
  buffer_load_dword v218, v222, s[24:27], s75 offen sc1
  v_mfma_f32_16x16x32_bf16 v[32:35], v[192:195], a[224:227], v[32:35]
  buffer_load_dword v219, v222, s[24:27], s76 offen sc1
  v_mfma_f32_16x16x32_bf16 v[36:39], v[192:195], a[228:231], v[36:39]
  s_add_u32 s92, s92, s93
  v_rcp_f32 v30, v30
  v_mfma_f32_16x16x32_bf16 v[36:39], v[188:191], a[212:215], v[36:39]
  s_cmp_gt_u32 s98, 288
  s_cselect_b32 s77, 0, 32
  ds_read_b64_tr_b16 v[176:177], v8 offset:16384
  ds_read_b64_tr_b16 v[178:179], v8 offset:16896
  v_mfma_f32_16x16x32_bf16 v[36:39], v[184:187], a[196:199], v[36:39]
  buffer_load_dword v216, v214, s[16:19], s92 offen offset:384
  v_mfma_f32_16x16x32_bf16 v[40:43], v[184:187], a[200:203], v[40:43]
  buffer_load_dword v23, v20, s[20:23], 0 offen
  v_mfma_f32_16x16x32_bf16 v[40:43], v[188:191], a[216:219], v[40:43]
  v_add_u32 v20, 3456, v20
  v_rcp_f32 v31, v31
  v_mul_f32 v140, v140, v28
  v_mfma_f32_16x16x32_bf16 v[40:43], v[192:195], a[232:235], v[40:43]
  ds_read_b64_tr_b16 v[180:181], v8 offset:61440
  ds_read_b64_tr_b16 v[182:183], v8 offset:61952
  v_mfma_f32_16x16x32_bf16 v[44:47], v[192:195], a[236:239], v[44:47]
  s_cmp_gt_u32 s99, 288
  s_cselect_b32 s78, 0, 32
  v_mul_f32 v141, v141, v29
  v_mfma_f32_16x16x32_bf16 v[44:47], v[188:191], a[220:223], v[44:47]
  s_cmp_eq_u32 s81, 0
  s_cselect_b32 s77, s77, 0
  s_cselect_b32 s78, s78, 0
  v_mfma_f32_16x16x32_bf16 v[44:47], v[184:187], a[204:207], v[44:47]
  s_waitcnt lgkmcnt(6)
  v_mul_f32 v142, v142, v30
  v_mul_f32 v143, v143, v31
  v_mfma_f32_16x16x32_bf16 v[48:51], v[160:163], a[192:195], v[48:51]
  ds_read_b64_tr_b16 v[184:185], v11 offset:20480
  ds_read_b64_tr_b16 v[186:187], v11 offset:20992
  v_mfma_f32_16x16x32_bf16 v[48:51], v[164:167], a[208:211], v[48:51]
  v_mul_f32 v24, s96, v144
  v_mul_f32 v25, s96, v145
  v_mfma_f32_16x16x32_bf16 v[48:51], v[168:171], a[224:227], v[48:51]
  v_mul_f32 v26, s96, v146
  v_mul_f32 v27, s96, v147
  v_mfma_f32_16x16x32_bf16 v[52:55], v[168:171], a[228:231], v[52:55]
  v_exp_f32 v24, v24
  v_mfma_f32_16x16x32_bf16 v[52:55], v[164:167], a[212:215], v[52:55]
  ds_read_b64_tr_b16 v[188:189], v11 offset:16384
  ds_read_b64_tr_b16 v[190:191], v11 offset:16896
  v_mfma_f32_16x16x32_bf16 v[52:55], v[160:163], a[196:199], v[52:55]
  v_exp_f32 v25, v25
  v_mfma_f32_16x16x32_bf16 v[56:59], v[160:163], a[200:203], v[56:59]
  v_exp_f32 v26, v26
  v_mfma_f32_16x16x32_bf16 v[56:59], v[164:167], a[216:219], v[56:59]
  v_exp_f32 v27, v27
  v_add_f32 v24, 1.0, v24
  v_mfma_f32_16x16x32_bf16 v[56:59], v[168:171], a[232:235], v[56:59]
  ds_read_b64_tr_b16 v[192:193], v11 offset:61440
  ds_read_b64_tr_b16 v[194:195], v11 offset:61952
  v_mfma_f32_16x16x32_bf16 v[60:63], v[168:171], a[236:239], v[60:63]
  v_add_f32 v25, 1.0, v25
  v_add_f32 v26, 1.0, v26
  v_add_f32 v27, 1.0, v27
  v_mfma_f32_16x16x32_bf16 v[60:63], v[164:167], a[220:223], v[60:63]
  v_rcp_f32 v24, v24
  v_mfma_f32_16x16x32_bf16 v[60:63], v[160:163], a[204:207], v[60:63]
  s_waitcnt vmcnt(25) lgkmcnt(6)
  v_rcp_f32 v25, v25
  v_mfma_f32_16x16x32_bf16 v[32:35], v[172:175], a[240:243], v[32:35]
  s_barrier
  v_mfma_f32_16x16x32_bf16 v[32:35], v[176:179], v[224:227], v[32:35]
  ds_read_b64_tr_b16 v[160:161], v8 offset:57344
  ds_read_b64_tr_b16 v[162:163], v8 offset:57856
  v_mfma_f32_16x16x32_bf16 v[32:35], v[180:183], v[240:243], v[32:35]
  v_rcp_f32 v26, v26
  v_mfma_f32_16x16x32_bf16 v[36:39], v[180:183], v[244:247], v[36:39]
  s_add_u32 m0, s82, 93824
  v_rcp_f32 v27, v27
  v_mul_f32 v144, v144, v24
  v_mfma_f32_16x16x32_bf16 v[36:39], v[176:179], v[228:231], v[36:39]
  buffer_load_dwordx4 v4, s[12:15], s51 offen offset:384 lds
  v_mfma_f32_16x16x32_bf16 v[36:39], v[172:175], a[244:247], v[36:39]
  ds_read_b64_tr_b16 v[164:165], v8 offset:4096
  ds_read_b64_tr_b16 v[166:167], v8 offset:4608
  v_mfma_f32_16x16x32_bf16 v[40:43], v[172:175], a[248:251], v[40:43]
  v_mul_f32 v145, v145, v25
  v_mul_f32 v146, v146, v26
  v_mfma_f32_16x16x32_bf16 v[40:43], v[176:179], v[232:235], v[40:43]
  s_add_u32 m0, s82, 89728
  v_mul_f32 v147, v147, v27
  v_mul_f32 v28, s96, v148
  v_mfma_f32_16x16x32_bf16 v[40:43], v[180:183], v[248:251], v[40:43]
  buffer_load_dwordx4 v4, s[12:15], s52 offen offset:384 lds
  v_mfma_f32_16x16x32_bf16 v[44:47], v[180:183], v[252:255], v[44:47]
  ds_read_b64_tr_b16 v[168:169], v8 offset:0
  ds_read_b64_tr_b16 v[170:171], v8 offset:512
  v_mul_f32 v29, s96, v149
  v_mfma_f32_16x16x32_bf16 v[44:47], v[176:179], v[236:239], v[44:47]
  v_mul_f32 v30, s96, v150
  v_mul_f32 v31, s96, v151
  v_mfma_f32_16x16x32_bf16 v[44:47], v[172:175], a[252:255], v[44:47]
  s_waitcnt lgkmcnt(6)
  v_exp_f32 v28, v28
  v_mfma_f32_16x16x32_bf16 v[48:51], v[184:187], a[240:243], v[48:51]
  ds_read_b64_tr_b16 v[172:173], v11 offset:57344
  ds_read_b64_tr_b16 v[174:175], v11 offset:57856
  v_mfma_f32_16x16x32_bf16 v[48:51], v[188:191], v[224:227], v[48:51]
  v_lshrrev_b32 v220, 3, v0
  v_lshlrev_b32 v220, 12, v220
  v_mfma_f32_16x16x32_bf16 v[48:51], v[192:195], v[240:243], v[48:51]
  v_and_b32 v221, 7, v0
  v_lshl_add_u32 v220, v221, 4, v220
  v_mfma_f32_16x16x32_bf16 v[52:55], v[192:195], v[244:247], v[52:55]
  s_cmp_le_u32 s99, 288
  s_cselect_b32 s38, 0, 0x80000000
  v_or_b32 v221, s38, v220
  v_mfma_f32_16x16x32_bf16 v[52:55], v[188:191], v[228:231], v[52:55]
  s_cmp_le_u32 s98, 288
  s_cselect_b32 s38, 0, 0x80000000
  ds_read_b64_tr_b16 v[176:177], v11 offset:4096
  ds_read_b64_tr_b16 v[178:179], v11 offset:4608
  v_mfma_f32_16x16x32_bf16 v[52:55], v[184:187], a[244:247], v[52:55]
  v_or_b32 v220, s38, v220
  v_mfma_f32_16x16x32_bf16 v[56:59], v[184:187], a[248:251], v[56:59]
  s_add_u32 s36, s100, 131072
  v_exp_f32 v29, v29
  v_mfma_f32_16x16x32_bf16 v[56:59], v[188:191], v[232:235], v[56:59]
  s_add_u32 s37, s101, 131072
  v_exp_f32 v30, v30
  v_mfma_f32_16x16x32_bf16 v[56:59], v[192:195], v[248:251], v[56:59]
  ds_read_b64_tr_b16 v[180:181], v11 offset:0
  ds_read_b64_tr_b16 v[182:183], v11 offset:512
  v_mfma_f32_16x16x32_bf16 v[60:63], v[192:195], v[252:255], v[60:63]
  v_exp_f32 v31, v31
  v_add_f32 v28, 1.0, v28
  v_mfma_f32_16x16x32_bf16 v[60:63], v[188:191], v[236:239], v[60:63]
  v_add_f32 v29, 1.0, v29
  v_add_f32 v30, 1.0, v30
  v_mfma_f32_16x16x32_bf16 v[60:63], v[184:187], a[252:255], v[60:63]
  s_waitcnt lgkmcnt(6)
  v_add_f32 v31, 1.0, v31
  v_mfma_f32_16x16x32_bf16 v[64:67], v[160:163], a[0:3], 0
  ds_read_b64_tr_b16 v[184:185], v7 offset:45056
  ds_read_b64_tr_b16 v[186:187], v7 offset:45568
  v_mfma_f32_16x16x32_bf16 v[64:67], v[164:167], a[16:19], v[64:67]
  v_rcp_f32 v28, v28
  v_mfma_f32_16x16x32_bf16 v[64:67], v[168:171], a[32:35], v[64:67]
  v_rcp_f32 v29, v29
  v_mfma_f32_16x16x32_bf16 v[68:71], v[168:171], a[36:39], 0
  v_rcp_f32 v30, v30
  v_mfma_f32_16x16x32_bf16 v[68:71], v[164:167], a[20:23], v[68:71]
  ds_read_b64_tr_b16 v[188:189], v7 offset:40960
  ds_read_b64_tr_b16 v[190:191], v7 offset:41472
  v_mfma_f32_16x16x32_bf16 v[68:71], v[160:163], a[4:7], v[68:71]
  v_rcp_f32 v31, v31
  v_mul_f32 v148, v148, v28
  v_mfma_f32_16x16x32_bf16 v[72:75], v[160:163], a[8:11], 0
  v_mul_f32 v149, v149, v29
  v_mul_f32 v150, v150, v30
  v_mfma_f32_16x16x32_bf16 v[72:75], v[164:167], a[24:27], v[72:75]
  v_mul_f32 v151, v151, v31
  v_mul_f32 v24, s96, v152
  v_mul_f32 v25, s96, v153
  v_mfma_f32_16x16x32_bf16 v[72:75], v[168:171], a[40:43], v[72:75]
  ds_read_b64_tr_b16 v[192:193], v9 offset:28672
  ds_read_b64_tr_b16 v[194:195], v9 offset:29184
  v_mfma_f32_16x16x32_bf16 v[76:79], v[168:171], a[44:47], 0
  v_mul_f32 v26, s96, v154
  v_mul_f32 v27, s96, v155
  v_mfma_f32_16x16x32_bf16 v[76:79], v[164:167], a[28:31], v[76:79]
  v_exp_f32 v24, v24
  v_mfma_f32_16x16x32_bf16 v[76:79], v[160:163], a[12:15], v[76:79]
  s_waitcnt lgkmcnt(6)
  v_exp_f32 v25, v25
  v_mfma_f32_16x16x32_bf16 v[80:83], v[172:175], a[0:3], 0
  ds_read_b64_tr_b16 v[160:161], v10 offset:45056
  ds_read_b64_tr_b16 v[162:163], v10 offset:45568
  v_mfma_f32_16x16x32_bf16 v[80:83], v[176:179], a[16:19], v[80:83]
  v_exp_f32 v26, v26
  v_mfma_f32_16x16x32_bf16 v[80:83], v[180:183], a[32:35], v[80:83]
  v_exp_f32 v27, v27
  v_add_f32 v24, 1.0, v24
  v_mfma_f32_16x16x32_bf16 v[84:87], v[180:183], a[36:39], 0
  v_add_f32 v25, 1.0, v25
  v_add_f32 v26, 1.0, v26
  v_mfma_f32_16x16x32_bf16 v[84:87], v[176:179], a[20:23], v[84:87]
  ds_read_b64_tr_b16 v[164:165], v10 offset:40960
  ds_read_b64_tr_b16 v[166:167], v10 offset:41472
  v_mfma_f32_16x16x32_bf16 v[84:87], v[172:175], a[4:7], v[84:87]
  v_add_f32 v27, 1.0, v27
  v_rcp_f32 v24, v24
  v_mfma_f32_16x16x32_bf16 v[88:91], v[172:175], a[8:11], 0
  v_rcp_f32 v25, v25
  v_mfma_f32_16x16x32_bf16 v[88:91], v[176:179], a[24:27], v[88:91]
  v_rcp_f32 v26, v26
  v_mfma_f32_16x16x32_bf16 v[88:91], v[180:183], a[40:43], v[88:91]
  ds_read_b64_tr_b16 v[168:169], v12 offset:28672
  ds_read_b64_tr_b16 v[170:171], v12 offset:29184
  v_mfma_f32_16x16x32_bf16 v[92:95], v[180:183], a[44:47], 0
  v_rcp_f32 v27, v27
  v_mfma_f32_16x16x32_bf16 v[92:95], v[176:179], a[28:31], v[92:95]
  v_mul_f32 v152, v152, v24
  v_mul_f32 v153, v153, v25
  v_mfma_f32_16x16x32_bf16 v[92:95], v[172:175], a[12:15], v[92:95]
  v_mul_f32 v154, v154, v26
  v_mul_f32 v155, v155, v27
  v_mul_f32 v28, s96, v156
  s_waitcnt vmcnt(5)
  v_readfirstlane_b32 s91, v218
  s_nop 1
  s_cmp_ge_u32 s91, s77
  s_cbranch_scc0 L_sp1a_gated_mix__spectral_gfnet__swiglu_ffn__prompt_kernel
L_bk1a_gated_mix__spectral_gfnet__swiglu_ffn__prompt_kernel:
  s_waitcnt vmcnt(4)
  v_readfirstlane_b32 s91, v219
  s_nop 1
  s_cmp_ge_u32 s91, s78
  s_cbranch_scc0 L_sp1b_gated_mix__spectral_gfnet__swiglu_ffn__prompt_kernel
L_bk1b_gated_mix__spectral_gfnet__swiglu_ffn__prompt_kernel:
  s_waitcnt lgkmcnt(6)
  v_mfma_f32_16x16x32_bf16 v[64:67], v[184:187], a[48:51], v[64:67]
  s_barrier
  s_cmp_lg_u32 s99, 288
  s_cbranch_scc0 L_os2n_gated_mix__spectral_gfnet__swiglu_ffn__prompt_kernel
L_s2n_gated_mix__spectral_gfnet__swiglu_ffn__prompt_kernel:
  v_mfma_f32_16x16x32_bf16 v[64:67], v[188:191], a[64:67], v[64:67]
  ds_read_b64_tr_b16 v[172:173], v9 offset:24576
  ds_read_b64_tr_b16 v[174:175], v9 offset:25088
  v_mfma_f32_16x16x32_bf16 v[64:67], v[192:195], a[80:83], v[64:67]
  s_add_u32 m0, s82, 126592
  v_mul_f32 v29, s96, v157
  v_mul_f32 v30, s96, v158
  v_mfma_f32_16x16x32_bf16 v[68:71], v[192:195], a[84:87], v[68:71]
  buffer_load_dwordx4 v4, s[12:15], s53 offen offset:384 lds
  v_mfma_f32_16x16x32_bf16 v[68:71], v[188:191], a[68:71], v[68:71]
  s_add_u32 m0, s82, 122496
  ds_read_b64_tr_b16 v[176:177], v8 offset:53248
  ds_read_b64_tr_b16 v[178:179], v8 offset:53760
  v_mul_f32 v31, s96, v159
  v_mfma_f32_16x16x32_bf16 v[68:71], v[184:187], a[52:55], v[68:71]
  buffer_load_dwordx4 v4, s[12:15], s54 offen offset:384 lds
  v_mfma_f32_16x16x32_bf16 v[72:75], v[184:187], a[56:59], v[72:75]
  s_add_u32 m0, s82, 32768
  v_exp_f32 v28, v28
  v_mfma_f32_16x16x32_bf16 v[72:75], v[188:191], a[72:75], v[72:75]
  buffer_load_dwordx4 v220, s[24:27], s100 offen sc1 lds
  v_mfma_f32_16x16x32_bf16 v[72:75], v[192:195], a[88:91], v[72:75]
  s_add_u32 m0, s82, 36864
  ds_read_b64_tr_b16 v[180:181], v8 offset:49152
  ds_read_b64_tr_b16 v[182:183], v8 offset:49664
  v_mfma_f32_16x16x32_bf16 v[76:79], v[192:195], a[92:95], v[76:79]
  buffer_load_dwordx4 v220, s[24:27], s36 offen sc1 lds
  v_mfma_f32_16x16x32_bf16 v[76:79], v[188:191], a[76:79], v[76:79]
  v_exp_f32 v29, v29
  v_mfma_f32_16x16x32_bf16 v[76:79], v[184:187], a[60:63], v[76:79]
  s_waitcnt lgkmcnt(6)
  v_exp_f32 v30, v30
  v_mfma_f32_16x16x32_bf16 v[80:83], v[160:163], a[48:51], v[80:83]
  ds_read_b64_tr_b16 v[184:185], v12 offset:24576
  ds_read_b64_tr_b16 v[186:187], v12 offset:25088
  v_mfma_f32_16x16x32_bf16 v[80:83], v[164:167], a[64:67], v[80:83]
  s_add_u32 m0, s82, 85632
  v_exp_f32 v31, v31
  v_add_f32 v28, 1.0, v28
  v_add_f32 v29, 1.0, v29
  v_mfma_f32_16x16x32_bf16 v[80:83], v[168:171], a[80:83], v[80:83]
  buffer_load_dwordx4 v4, s[12:15], s55 offen offset:384 lds
  v_mfma_f32_16x16x32_bf16 v[84:87], v[168:171], a[84:87], v[84:87]
  s_add_u32 m0, s82, 81536
  ds_read_b64_tr_b16 v[188:189], v11 offset:53248
  ds_read_b64_tr_b16 v[190:191], v11 offset:53760
  v_mfma_f32_16x16x32_bf16 v[84:87], v[164:167], a[68:71], v[84:87]
  buffer_load_dwordx4 v4, s[12:15], s56 offen offset:384 lds
  v_mfma_f32_16x16x32_bf16 v[84:87], v[160:163], a[52:55], v[84:87]
  v_add_f32 v30, 1.0, v30
  v_add_f32 v31, 1.0, v31
  v_mfma_f32_16x16x32_bf16 v[88:91], v[160:163], a[56:59], v[88:91]
  s_add_u32 m0, s82, 49152
  v_rcp_f32 v28, v28
  v_mfma_f32_16x16x32_bf16 v[88:91], v[164:167], a[72:75], v[88:91]
  buffer_load_dwordx4 v221, s[24:27], s101 offen sc1 lds
  v_mfma_f32_16x16x32_bf16 v[88:91], v[168:171], a[88:91], v[88:91]
  s_add_u32 m0, s82, 53248
  ds_read_b64_tr_b16 v[192:193], v11 offset:49152
  ds_read_b64_tr_b16 v[194:195], v11 offset:49664
  v_mfma_f32_16x16x32_bf16 v[92:95], v[168:171], a[92:95], v[92:95]
  buffer_load_dwordx4 v221, s[24:27], s37 offen sc1 lds
  v_mfma_f32_16x16x32_bf16 v[92:95], v[164:167], a[76:79], v[92:95]
  v_rcp_f32 v29, v29
  v_rcp_f32 v30, v30
  v_mfma_f32_16x16x32_bf16 v[92:95], v[160:163], a[60:63], v[92:95]
  s_waitcnt lgkmcnt(6)
  v_rcp_f32 v31, v31
  v_mfma_f32_16x16x32_bf16 v[64:67], v[172:175], a[96:99], v[64:67]
  ds_read_b64_tr_b16 v[160:161], v8 offset:36864
  ds_read_b64_tr_b16 v[162:163], v8 offset:37376
  v_mfma_f32_16x16x32_bf16 v[64:67], v[176:179], a[112:115], v[64:67]
  v_mul_f32 v156, v156, v28
  v_mul_f32 v157, v157, v29
  v_mfma_f32_16x16x32_bf16 v[64:67], v[180:183], a[128:131], v[64:67]
  s_add_u32 m0, s82, 69248
  v_mul_f32 v158, v158, v30
  v_mul_f32 v159, v159, v31
  v_mfma_f32_16x16x32_bf16 v[68:71], v[180:183], a[132:135], v[68:71]
  buffer_load_dwordx4 v4, s[12:15], s57 offen offset:384 lds
  v_mfma_f32_16x16x32_bf16 v[68:71], v[176:179], a[116:119], v[68:71]
  ds_read_b64_tr_b16 v[164:165], v8 offset:32768
  ds_read_b64_tr_b16 v[166:167], v8 offset:33280
  v_mul_f32 v128, v128, v96
  v_mfma_f32_16x16x32_bf16 v[68:71], v[172:175], a[100:103], v[68:71]
  v_mul_f32 v129, v129, v97
  v_mul_f32 v130, v130, v98
  v_mfma_f32_16x16x32_bf16 v[72:75], v[172:175], a[104:107], v[72:75]
  v_mul_f32 v131, v131, v99
  v_mul_f32 v144, v144, v112
  v_mfma_f32_16x16x32_bf16 v[72:75], v[176:179], a[120:123], v[72:75]
  s_add_u32 m0, s82, 65152
  ds_read_b64_tr_b16 v[168:169], v9 offset:20480
  ds_read_b64_tr_b16 v[170:171], v9 offset:20992
  v_mfma_f32_16x16x32_bf16 v[72:75], v[180:183], a[136:139], v[72:75]
  buffer_load_dwordx4 v4, s[12:15], s58 offen offset:384 lds
  v_mfma_f32_16x16x32_bf16 v[76:79], v[180:183], a[140:143], v[76:79]
  v_mul_f32 v145, v145, v113
  v_mul_f32 v146, v146, v114
  v_mul_f32 v147, v147, v115
  v_mfma_f32_16x16x32_bf16 v[76:79], v[176:179], a[124:127], v[76:79]
  v_cvt_pk_bf16_f32 v96, v128, v129
  v_cvt_pk_bf16_f32 v97, v130, v131
  v_mfma_f32_16x16x32_bf16 v[76:79], v[172:175], a[108:111], v[76:79]
  s_waitcnt lgkmcnt(6)
  v_cvt_pk_bf16_f32 v98, v144, v145
  v_cvt_pk_bf16_f32 v99, v146, v147
  v_mfma_f32_16x16x32_bf16 v[80:83], v[184:187], a[96:99], v[80:83]
  ds_read_b64_tr_b16 v[172:173], v11 offset:36864
  ds_read_b64_tr_b16 v[174:175], v11 offset:37376
  v_mfma_f32_16x16x32_bf16 v[80:83], v[188:191], a[112:115], v[80:83]
  ds_write_b128 v19, v[96:99] offset:16384
  v_mfma_f32_16x16x32_bf16 v[80:83], v[192:195], a[128:131], v[80:83]
  v_mul_f32 v132, v132, v100
  v_mul_f32 v133, v133, v101
  v_mul_f32 v134, v134, v102
  v_mfma_f32_16x16x32_bf16 v[84:87], v[192:195], a[132:135], v[84:87]
  v_mul_f32 v135, v135, v103
  v_mul_f32 v148, v148, v116
  v_mfma_f32_16x16x32_bf16 v[84:87], v[188:191], a[116:119], v[84:87]
  ds_read_b64_tr_b16 v[176:177], v11 offset:32768
  ds_read_b64_tr_b16 v[178:179], v11 offset:33280
  v_mfma_f32_16x16x32_bf16 v[84:87], v[184:187], a[100:103], v[84:87]
  v_mul_f32 v149, v149, v117
  v_mul_f32 v150, v150, v118
  v_mfma_f32_16x16x32_bf16 v[88:91], v[184:187], a[104:107], v[88:91]
  v_mul_f32 v151, v151, v119
  v_cvt_pk_bf16_f32 v100, v132, v133
  v_mfma_f32_16x16x32_bf16 v[88:91], v[188:191], a[120:123], v[88:91]
  v_cvt_pk_bf16_f32 v101, v134, v135
  v_cvt_pk_bf16_f32 v102, v148, v149
  v_mfma_f32_16x16x32_bf16 v[88:91], v[192:195], a[136:139], v[88:91]
  ds_read_b64_tr_b16 v[180:181], v12 offset:20480
  ds_read_b64_tr_b16 v[182:183], v12 offset:20992
  v_cvt_pk_bf16_f32 v103, v150, v151
  v_mfma_f32_16x16x32_bf16 v[92:95], v[192:195], a[140:143], v[92:95]
  ds_write_b128 v19, v[100:103] offset:17408
  v_mfma_f32_16x16x32_bf16 v[92:95], v[188:191], a[124:127], v[92:95]
  v_mul_f32 v136, v136, v104
  v_mul_f32 v137, v137, v105
  v_mfma_f32_16x16x32_bf16 v[92:95], v[184:187], a[108:111], v[92:95]
  s_waitcnt lgkmcnt(8)
  v_mul_f32 v138, v138, v106
  v_mul_f32 v139, v139, v107
  v_mfma_f32_16x16x32_bf16 v[64:67], v[160:163], a[144:147], v[64:67]
  s_barrier
  v_mfma_f32_16x16x32_bf16 v[64:67], v[164:167], a[160:163], v[64:67]
  ds_read_b64_tr_b16 v[184:185], v9 offset:16384
  ds_read_b64_tr_b16 v[186:187], v9 offset:16896
  v_mul_f32 v152, v152, v120
  v_mfma_f32_16x16x32_bf16 v[64:67], v[168:171], a[176:179], v[64:67]
  v_mul_f32 v153, v153, v121
  v_mul_f32 v154, v154, v122
  v_mfma_f32_16x16x32_bf16 v[68:71], v[168:171], a[180:183], v[68:71]
  s_add_u32 m0, s82, 159360
  v_mul_f32 v155, v155, v123
  v_cvt_pk_bf16_f32 v104, v136, v137
  v_mfma_f32_16x16x32_bf16 v[68:71], v[164:167], a[164:167], v[68:71]
  buffer_load_dwordx4 v4, s[12:15], s59 offen offset:384 lds
  v_mfma_f32_16x16x32_bf16 v[68:71], v[160:163], a[148:151], v[68:71]
  ds_read_b64_tr_b16 v[188:189], v8 offset:45056
  ds_read_b64_tr_b16 v[190:191], v8 offset:45568
  v_mfma_f32_16x16x32_bf16 v[72:75], v[160:163], a[152:155], v[72:75]
  v_cvt_pk_bf16_f32 v105, v138, v139
  v_cvt_pk_bf16_f32 v106, v152, v153
  v_cvt_pk_bf16_f32 v107, v154, v155
  v_mfma_f32_16x16x32_bf16 v[72:75], v[164:167], a[168:171], v[72:75]
  s_add_u32 m0, s82, 155264
  v_mul_f32 v24, s96, v32
  v_mul_f32 v25, s96, v33
  v_mfma_f32_16x16x32_bf16 v[72:75], v[168:171], a[184:187], v[72:75]
  buffer_load_dwordx4 v4, s[12:15], s60 offen offset:384 lds
  v_mfma_f32_16x16x32_bf16 v[76:79], v[168:171], a[188:191], v[76:79]
  ds_read_b64_tr_b16 v[192:193], v8 offset:40960
  ds_read_b64_tr_b16 v[194:195], v8 offset:41472
  v_mfma_f32_16x16x32_bf16 v[76:79], v[164:167], a[172:175], v[76:79]
  ds_write_b128 v19, v[104:107] offset:18432
  v_mfma_f32_16x16x32_bf16 v[76:79], v[160:163], a[156:159], v[76:79]
  s_waitcnt lgkmcnt(8)
  v_mul_f32 v140, v140, v108
  v_mul_f32 v141, v141, v109
  v_mul_f32 v142, v142, v110
  v_mfma_f32_16x16x32_bf16 v[80:83], v[172:175], a[144:147], v[80:83]
  ds_read_b64_tr_b16 v[160:161], v12 offset:16384
  ds_read_b64_tr_b16 v[162:163], v12 offset:16896
  v_mul_f32 v143, v143, v111
  v_mfma_f32_16x16x32_bf16 v[80:83], v[176:179], a[160:163], v[80:83]
  v_mul_f32 v156, v156, v124
  v_mul_f32 v157, v157, v125
  v_mfma_f32_16x16x32_bf16 v[80:83], v[180:183], a[176:179], v[80:83]
  s_add_u32 m0, s82, 118400
  v_mul_f32 v158, v158, v126
  v_mul_f32 v159, v159, v127
  v_mfma_f32_16x16x32_bf16 v[84:87], v[180:183], a[180:183], v[84:87]
  buffer_load_dwordx4 v4, s[12:15], s61 offen offset:384 lds
  v_mfma_f32_16x16x32_bf16 v[84:87], v[176:179], a[164:167], v[84:87]
  ds_read_b64_tr_b16 v[164:165], v11 offset:45056
  ds_read_b64_tr_b16 v[166:167], v11 offset:45568
  v_cvt_pk_bf16_f32 v108, v140, v141
  v_mfma_f32_16x16x32_bf16 v[84:87], v[172:175], a[148:151], v[84:87]
  v_cvt_pk_bf16_f32 v109, v142, v143
  v_cvt_pk_bf16_f32 v110, v156, v157
  v_mfma_f32_16x16x32_bf16 v[88:91], v[172:175], a[152:155], v[88:91]
  v_cvt_pk_bf16_f32 v111, v158, v159
  v_mul_f32 v26, s96, v34
  v_mul_f32 v27, s96, v35
  v_mfma_f32_16x16x32_bf16 v[88:91], v[176:179], a[168:171], v[88:91]
  s_add_u32 m0, s82, 114304
  ds_read_b64_tr_b16 v[168:169], v11 offset:40960
  ds_read_b64_tr_b16 v[170:171], v11 offset:41472
  v_exp_f32 v24, v24
  v_mfma_f32_16x16x32_bf16 v[88:91], v[180:183], a[184:187], v[88:91]
  buffer_load_dwordx4 v4, s[12:15], s62 offen offset:384 lds
  v_mfma_f32_16x16x32_bf16 v[92:95], v[180:183], a[188:191], v[92:95]
  ds_write_b128 v19, v[108:111] offset:19456
  v_mfma_f32_16x16x32_bf16 v[92:95], v[176:179], a[172:175], v[92:95]
  s_lshl_b32 s6, s81, 11
  s_add_u32 s6, s6, 32768
  v_add_u32 v152, s6, v21
  v_lshrrev_b32 v159, 3, v0
  v_lshlrev_b32 v159, 4, v159
  v_mfma_f32_16x16x32_bf16 v[92:95], v[172:175], a[156:159], v[92:95]
  s_waitcnt lgkmcnt(8)
  v_subrev_u32 v157, s82, v152
  v_xor_b32 v157, v157, v159
  v_mfma_f32_16x16x32_bf16 v[64:67], v[184:187], a[192:195], v[64:67]
  ds_read_b64_tr_b16 v[172:173], v8 offset:12288
  ds_read_b64_tr_b16 v[174:175], v8 offset:12800
  v_mfma_f32_16x16x32_bf16 v[64:67], v[188:191], a[208:211], v[64:67]
  v_lshrrev_b32 v153, 2, v1
  v_lshl_add_u32 v153, v2, 2, v153
  v_mfma_f32_16x16x32_bf16 v[64:67], v[192:195], a[224:227], v[64:67]
  v_lshlrev_b32 v154, 6, v153
  v_lshlrev_b32 v153, 7, v153
  v_mfma_f32_16x16x32_bf16 v[68:71], v[192:195], a[228:231], v[68:71]
  v_and_b32 v159, 3, v1
  v_lshl_add_u32 v153, v159, 3, v153
  v_mfma_f32_16x16x32_bf16 v[68:71], v[188:191], a[212:215], v[68:71]
  ds_read_b64_tr_b16 v[176:177], v8 offset:8192
  ds_read_b64_tr_b16 v[178:179], v8 offset:8704
  v_mfma_f32_16x16x32_bf16 v[68:71], v[184:187], a[196:199], v[68:71]
  v_lshl_add_u32 v154, v159, 3, v154
  v_mfma_f32_16x16x32_bf16 v[72:75], v[184:187], a[200:203], v[72:75]
  s_lshl_b32 s6, s87, 12
  v_exp_f32 v25, v25
  v_mfma_f32_16x16x32_bf16 v[72:75], v[188:191], a[216:219], v[72:75]
  s_lshl_b32 s7, s88, 6
  v_exp_f32 v26, v26
  v_mfma_f32_16x16x32_bf16 v[72:75], v[192:195], a[232:235], v[72:75]
  s_add_u32 s6, s6, s7
  ds_read_b64_tr_b16 v[180:181], v9 offset:12288
  ds_read_b64_tr_b16 v[182:183], v9 offset:12800
  v_mfma_f32_16x16x32_bf16 v[76:79], v[192:195], a[236:239], v[76:79]
  s_add_u32 s6, s6, 32768
  v_add_u32 v153, s6, v153
  v_lshlrev_b32 v155, 7, v1
  v_mfma_f32_16x16x32_bf16 v[76:79], v[188:191], a[220:223], v[76:79]
  v_lshl_add_u32 v155, v2, 3, v155
  v_add_u32 v155, s6, v155
  v_mfma_f32_16x16x32_bf16 v[76:79], v[184:187], a[204:207], v[76:79]
  s_waitcnt lgkmcnt(7)
  v_and_b32 v159, 7, v1
  v_lshlrev_b32 v159, 4, v159
  v_mfma_f32_16x16x32_bf16 v[80:83], v[160:163], a[192:195], v[80:83]
  ds_read_b64_tr_b16 v[184:185], v11 offset:12288
  ds_read_b64_tr_b16 v[186:187], v11 offset:12800
  v_mfma_f32_16x16x32_bf16 v[80:83], v[164:167], a[208:211], v[80:83]
  v_xor_b32 v155, v155, v159
  v_xor_b32 v156, 32, v155
  v_mfma_f32_16x16x32_bf16 v[80:83], v[168:171], a[224:227], v[80:83]
  s_lshl_b32 s6, s88, 11
  v_exp_f32 v27, v27
  v_mfma_f32_16x16x32_bf16 v[84:87], v[168:171], a[228:231], v[84:87]
  s_lshl_b32 s7, s87, 5
  v_add_f32 v24, 1.0, v24
  v_add_f32 v25, 1.0, v25
  v_mfma_f32_16x16x32_bf16 v[84:87], v[164:167], a[212:215], v[84:87]
  s_add_u32 s6, s6, s7
  ds_read_b64_tr_b16 v[188:189], v11 offset:8192
  ds_read_b64_tr_b16 v[190:191], v11 offset:8704
  v_mfma_f32_16x16x32_bf16 v[84:87], v[160:163], a[196:199], v[84:87]
  s_add_u32 s6, s6, 40960
  v_add_u32 v154, s6, v154
  v_add_f32 v26, 1.0, v26
  v_mfma_f32_16x16x32_bf16 v[88:91], v[160:163], a[200:203], v[88:91]
  v_add_f32 v27, 1.0, v27
  v_mfma_f32_16x16x32_bf16 v[88:91], v[164:167], a[216:219], v[88:91]
  v_rcp_f32 v24, v24
  v_mfma_f32_16x16x32_bf16 v[88:91], v[168:171], a[232:235], v[88:91]
  ds_read_b64_tr_b16 v[192:193], v12 offset:12288
  ds_read_b64_tr_b16 v[194:195], v12 offset:12800
  v_mfma_f32_16x16x32_bf16 v[92:95], v[168:171], a[236:239], v[92:95]
  v_rcp_f32 v25, v25
  v_mfma_f32_16x16x32_bf16 v[92:95], v[164:167], a[220:223], v[92:95]
  v_rcp_f32 v26, v26
  v_mfma_f32_16x16x32_bf16 v[92:95], v[160:163], a[204:207], v[92:95]
  s_waitcnt vmcnt(6) lgkmcnt(6)
  v_rcp_f32 v27, v27
  v_mfma_f32_16x16x32_bf16 v[64:67], v[172:175], a[240:243], v[64:67]
  s_barrier
  v_mfma_f32_16x16x32_bf16 v[64:67], v[176:179], v[224:227], v[64:67]
  s_add_u32 s47, s46, 16384
  ds_read_b64_tr_b16 v[160:161], v9 offset:8192
  ds_read_b64_tr_b16 v[162:163], v9 offset:8704
  v_mfma_f32_16x16x32_bf16 v[64:67], v[180:183], v[240:243], v[64:67]
  buffer_store_dwordx4 v[96:99], v19, s[24:27], s47 offen offset:0 sc1
  v_mfma_f32_16x16x32_bf16 v[68:71], v[180:183], v[244:247], v[68:71]
  s_add_u32 m0, s82, 151168
  v_mul_f32 v32, v32, v24
  v_mul_f32 v33, v33, v25
  v_mfma_f32_16x16x32_bf16 v[68:71], v[176:179], v[228:231], v[68:71]
  buffer_load_dwordx4 v4, s[12:15], s63 offen offset:384 lds
  v_mfma_f32_16x16x32_bf16 v[68:71], v[172:175], a[244:247], v[68:71]
  ds_read_b64_tr_b16 v[164:165], v9 offset:4096
  ds_read_b64_tr_b16 v[166:167], v9 offset:4608
  v_mfma_f32_16x16x32_bf16 v[72:75], v[172:175], a[248:251], v[72:75]
  v_mul_f32 v34, v34, v26
  v_mul_f32 v35, v35, v27
  v_mfma_f32_16x16x32_bf16 v[72:75], v[176:179], v[232:235], v[72:75]
  s_add_u32 m0, s82, 147072
  v_mul_f32 v28, s96, v36
  v_mul_f32 v29, s96, v37
  v_mfma_f32_16x16x32_bf16 v[72:75], v[180:183], v[248:251], v[72:75]
  buffer_load_dwordx4 v4, s[12:15], s64 offen offset:384 lds
  v_mfma_f32_16x16x32_bf16 v[76:79], v[180:183], v[252:255], v[76:79]
  ds_read_b64_tr_b16 v[168:169], v9 offset:0
  ds_read_b64_tr_b16 v[170:171], v9 offset:512
  v_mfma_f32_16x16x32_bf16 v[76:79], v[176:179], v[236:239], v[76:79]
  v_mul_f32 v30, s96, v38
  v_mul_f32 v31, s96, v39
  v_mfma_f32_16x16x32_bf16 v[76:79], v[172:175], a[252:255], v[76:79]
  s_waitcnt lgkmcnt(6)
  v_exp_f32 v28, v28
  v_mfma_f32_16x16x32_bf16 v[80:83], v[184:187], a[240:243], v[80:83]
  ds_read_b64_tr_b16 v[172:173], v12 offset:8192
  ds_read_b64_tr_b16 v[174:175], v12 offset:8704
  v_mfma_f32_16x16x32_bf16 v[80:83], v[188:191], v[224:227], v[80:83]
  v_exp_f32 v29, v29
  v_mfma_f32_16x16x32_bf16 v[80:83], v[192:195], v[240:243], v[80:83]
  s_add_u32 m0, s82, 110208
  v_exp_f32 v30, v30
  v_exp_f32 v31, v31
  v_mfma_f32_16x16x32_bf16 v[84:87], v[192:195], v[244:247], v[84:87]
  buffer_load_dwordx4 v4, s[12:15], s65 offen offset:384 lds
  v_mfma_f32_16x16x32_bf16 v[84:87], v[188:191], v[228:231], v[84:87]
  ds_read_b64_tr_b16 v[176:177], v12 offset:4096
  ds_read_b64_tr_b16 v[178:179], v12 offset:4608
  v_add_f32 v28, 1.0, v28
  v_add_f32 v29, 1.0, v29
  v_mfma_f32_16x16x32_bf16 v[84:87], v[184:187], a[244:247], v[84:87]
  v_add_f32 v30, 1.0, v30
  v_add_f32 v31, 1.0, v31
  v_rcp_f32 v28, v28
  v_mfma_f32_16x16x32_bf16 v[88:91], v[184:187], a[248:251], v[88:91]
  v_rcp_f32 v29, v29
  v_rcp_f32 v30, v30
  v_mfma_f32_16x16x32_bf16 v[88:91], v[188:191], v[232:235], v[88:91]
  s_add_u32 m0, s82, 106112
  ds_read_b64_tr_b16 v[180:181], v12 offset:0
  ds_read_b64_tr_b16 v[182:183], v12 offset:512
  v_rcp_f32 v31, v31
  v_mfma_f32_16x16x32_bf16 v[88:91], v[192:195], v[248:251], v[88:91]
  buffer_load_dwordx4 v4, s[16:19], s48 offen offset:384 lds
  buffer_store_dwordx4 v[100:103], v19, s[24:27], s47 offen offset:1024 sc1
  buffer_store_dwordx4 v[104:107], v19, s[24:27], s47 offen offset:2048 sc1
  buffer_store_dwordx4 v[108:111], v19, s[24:27], s47 offen offset:3072 sc1
  v_mfma_f32_16x16x32_bf16 v[92:95], v[192:195], v[252:255], v[92:95]
  v_mul_f32 v36, v36, v28
  v_mul_f32 v37, v37, v29
  v_mul_f32 v38, v38, v30
  v_mul_f32 v39, v39, v31
  v_mfma_f32_16x16x32_bf16 v[92:95], v[188:191], v[236:239], v[92:95]
  v_mul_f32 v24, s96, v40
  v_mul_f32 v25, s96, v41
  v_mfma_f32_16x16x32_bf16 v[92:95], v[184:187], a[252:255], v[92:95]
  v_mul_f32 v26, s96, v42
  v_mul_f32 v27, s96, v43
  s_cmp_gt_u32 s98, 288
  s_cbranch_scc1 L_s2e_gated_mix__spectral_gfnet__swiglu_ffn__prompt_kernel
  s_cmp_gt_u32 s99, 288
  s_cbranch_scc1 L_oex1_gated_mix__spectral_gfnet__swiglu_ffn__prompt_kernel
L_s2d_gated_mix__spectral_gfnet__swiglu_ffn__prompt_kernel:
  ds_write_b128 v152, v[196:199] offset:8192
  ds_write_b128 v152, v[200:203] offset:9216
  s_add_u32 s84, s100, 3145728
  s_add_u32 s85, s84, 131072
  ds_write_b128 v152, v[204:207] offset:24576
  ds_write_b128 v152, v[208:211] offset:25600
  s_add_u32 s86, s101, 3145728
  s_add_u32 s92, s86, 131072
  v_cvt_f32_u32 v96, v1
  v_lshlrev_b32 v97, 2, v2
  v_mul_f32 v96, 0x3d000000, v96
  v_cvt_f32_u32 v97, v97
  v_add_f32 v98, 0x00000000, v97
  v_add_f32 v99, 0x3f800000, v97
  v_mul_f32 v98, v98, v96
  v_mul_f32 v99, v99, v96
  v_cos_f32 v100, v98
  v_cos_f32 v101, v99
  v_sin_f32 v98, v98
  v_sin_f32 v99, v99
  v_cvt_pk_bf16_f32 v128, v100, v101
  v_cvt_pk_bf16_f32 v132, v98, v99
  v_add_f32 v98, 0x40000000, v97
  v_add_f32 v99, 0x40400000, v97
  v_mul_f32 v98, v98, v96
  v_mul_f32 v99, v99, v96
  v_cos_f32 v100, v98
  v_cos_f32 v101, v99
  v_sin_f32 v98, v98
  v_sin_f32 v99, v99
  v_cvt_pk_bf16_f32 v129, v100, v101
  v_cvt_pk_bf16_f32 v133, v98, v99
  s_waitcnt lgkmcnt(0)
  s_barrier
  ds_read_b64_tr_b16 v[112:113], v153 offset:0
  ds_read_b64_tr_b16 v[114:115], v153 offset:2048
  ds_read_b64_tr_b16 v[116:117], v153 offset:32
  ds_read_b64_tr_b16 v[118:119], v153 offset:2080
  ds_read_b64_tr_b16 v[120:121], v153 offset:16384
  ds_read_b64_tr_b16 v[122:123], v153 offset:18432
  ds_read_b64_tr_b16 v[124:125], v153 offset:16416
  ds_read_b64_tr_b16 v[126:127], v153 offset:18464
  ds_read_b64_tr_b16 v[196:197], v154 offset:0
  ds_read_b64_tr_b16 v[198:199], v154 offset:1024
  ds_read_b64_tr_b16 v[200:201], v154 offset:4096
  ds_read_b64_tr_b16 v[202:203], v154 offset:5120
  ds_read_b64_tr_b16 v[204:205], v154 offset:16384
  ds_read_b64_tr_b16 v[206:207], v154 offset:17408
  ds_read_b64_tr_b16 v[208:209], v154 offset:20480
  ds_read_b64_tr_b16 v[210:211], v154 offset:21504
  v_and_b32 v96, 1, v1
  v_mul_u32_u24 v96, 0x8000, v96
  v_lshl_add_u32 v96, v96, 16, v96
  v_xor_b32 v130, v96, v128
  v_xor_b32 v131, v96, v129
  v_xor_b32 v134, v96, v132
  v_xor_b32 v135, v96, v133
  v_xor_b32 v136, 0x80008000, v132
  v_xor_b32 v140, 0x80000000, v128
  v_xor_b32 v144, 0x80000000, v132
  v_xor_b32 v148, 0x8000, v132
  v_xor_b32 v137, 0x80008000, v133
  v_xor_b32 v141, 0x80000000, v129
  v_xor_b32 v145, 0x80000000, v133
  v_xor_b32 v149, 0x8000, v133
  v_xor_b32 v138, 0x80008000, v134
  v_xor_b32 v142, 0x80000000, v130
  v_xor_b32 v146, 0x80000000, v134
  v_xor_b32 v150, 0x8000, v134
  v_xor_b32 v139, 0x80008000, v135
  v_xor_b32 v143, 0x80000000, v131
  v_xor_b32 v147, 0x80000000, v135
  v_xor_b32 v151, 0x8000, v135
  s_waitcnt lgkmcnt(14)
  v_mfma_f32_16x16x32_bf16 v[96:99], v[128:131], v[112:115], 0
  s_waitcnt lgkmcnt(12)
  v_mfma_f32_16x16x32_bf16 v[96:99], v[132:135], v[116:119], v[96:99]
  v_mfma_f32_16x16x32_bf16 v[104:107], v[128:131], v[116:119], 0
  v_mfma_f32_16x16x32_bf16 v[104:107], v[136:139], v[112:115], v[104:107]
  v_mfma_f32_16x16x32_bf16 v[100:103], v[140:143], v[112:115], 0
  v_mfma_f32_16x16x32_bf16 v[100:103], v[144:147], v[116:119], v[100:103]
  v_mfma_f32_16x16x32_bf16 v[108:111], v[140:143], v[116:119], 0
  v_mfma_f32_16x16x32_bf16 v[108:111], v[148:151], v[112:115], v[108:111]
  s_waitcnt lgkmcnt(0)
  s_barrier
  v_mfma_f32_16x16x32_bf16 v[184:187], v[128:131], v[120:123], 0
  v_lshlrev_b32 v215, 16, v200
  v_and_b32 v200, 0xffff0000, v200
  v_mfma_f32_16x16x32_bf16 v[184:187], v[132:135], v[124:127], v[184:187]
  v_lshlrev_b32 v214, 16, v196
  v_and_b32 v196, 0xffff0000, v196
  v_mfma_f32_16x16x32_bf16 v[192:195], v[128:131], v[124:127], 0
  v_mul_f32 v212, v104, v215
  v_mul_f32 v213, v105, v200
  v_mfma_f32_16x16x32_bf16 v[192:195], v[136:139], v[120:123], v[192:195]
  v_mul_f32 v215, v96, v215
  v_mul_f32 v200, v97, v200
  v_mfma_f32_16x16x32_bf16 v[188:191], v[140:143], v[120:123], 0
  v_fma_f32 v96, v96, v214, -v212
  v_fma_f32 v97, v97, v196, -v213
  v_mfma_f32_16x16x32_bf16 v[188:191], v[144:147], v[124:127], v[188:191]
  v_fma_f32 v104, v104, v214, v215
  v_fma_f32 v105, v105, v196, v200
  v_mfma_f32_16x16x32_bf16 v[216:219], v[140:143], v[124:127], 0
  v_lshlrev_b32 v215, 16, v201
  v_and_b32 v201, 0xffff0000, v201
  v_mfma_f32_16x16x32_bf16 v[216:219], v[148:151], v[120:123], v[216:219]
  v_lshlrev_b32 v214, 16, v197
  v_and_b32 v197, 0xffff0000, v197
  v_mul_f32 v212, v106, v215
  v_mul_f32 v213, v107, v201
  v_mul_f32 v215, v98, v215
  v_mul_f32 v201, v99, v201
  v_fma_f32 v98, v98, v214, -v212
  v_fma_f32 v99, v99, v197, -v213
  v_fma_f32 v106, v106, v214, v215
  v_fma_f32 v107, v107, v197, v201
  v_lshlrev_b32 v215, 16, v202
  v_and_b32 v202, 0xffff0000, v202
  v_lshlrev_b32 v214, 16, v198
  v_and_b32 v198, 0xffff0000, v198
  v_mul_f32 v212, v108, v215
  v_mul_f32 v213, v109, v202
  v_mul_f32 v215, v100, v215
  v_mul_f32 v202, v101, v202
  v_fma_f32 v100, v100, v214, -v212
  v_fma_f32 v101, v101, v198, -v213
  v_fma_f32 v108, v108, v214, v215
  v_fma_f32 v109, v109, v198, v202
  v_lshlrev_b32 v215, 16, v203
  v_and_b32 v203, 0xffff0000, v203
  v_lshlrev_b32 v214, 16, v199
  v_and_b32 v199, 0xffff0000, v199
  v_mul_f32 v212, v110, v215
  v_mul_f32 v213, v111, v203
  v_mul_f32 v215, v102, v215
  v_mul_f32 v203, v103, v203
  v_fma_f32 v102, v102, v214, -v212
  v_fma_f32 v103, v103, v199, -v213
  v_fma_f32 v110, v110, v214, v215
  v_fma_f32 v111, v111, v199, v203
  v_cvt_pk_bf16_f32 v112, v96, v97
  v_cvt_pk_bf16_f32 v113, v98, v99
  v_cvt_pk_bf16_f32 v114, v100, v101
  v_cvt_pk_bf16_f32 v115, v102, v103
  v_cvt_pk_bf16_f32 v116, v104, v105
  v_cvt_pk_bf16_f32 v117, v106, v107
  v_cvt_pk_bf16_f32 v118, v108, v109
  v_cvt_pk_bf16_f32 v119, v110, v111
  v_lshlrev_b32 v215, 16, v208
  v_and_b32 v208, 0xffff0000, v208
  v_mfma_f32_16x16x32_bf16 v[96:99], v[112:115], v[128:131], 0
  v_lshlrev_b32 v214, 16, v204
  v_and_b32 v204, 0xffff0000, v204
  v_mfma_f32_16x16x32_bf16 v[96:99], v[116:119], v[136:139], v[96:99]
  v_mul_f32 v212, v192, v215
  v_mul_f32 v213, v193, v208
  v_mfma_f32_16x16x32_bf16 v[100:103], v[112:115], v[140:143], 0
  v_mul_f32 v215, v184, v215
  v_mul_f32 v208, v185, v208
  v_mfma_f32_16x16x32_bf16 v[100:103], v[116:119], v[148:151], v[100:103]
  v_fma_f32 v184, v184, v214, -v212
  v_fma_f32 v185, v185, v204, -v213
  v_mfma_f32_16x16x32_bf16 v[104:107], v[116:119], v[128:131], 0
  v_fma_f32 v192, v192, v214, v215
  v_fma_f32 v193, v193, v204, v208
  v_mfma_f32_16x16x32_bf16 v[104:107], v[112:115], v[132:135], v[104:107]
  v_lshlrev_b32 v215, 16, v209
  v_and_b32 v209, 0xffff0000, v209
  v_mfma_f32_16x16x32_bf16 v[108:111], v[116:119], v[140:143], 0
  v_lshlrev_b32 v214, 16, v205
  v_and_b32 v205, 0xffff0000, v205
  v_mfma_f32_16x16x32_bf16 v[108:111], v[112:115], v[144:147], v[108:111]
  v_mul_f32 v212, v194, v215
  v_mul_f32 v213, v195, v209
  v_mul_f32 v215, v186, v215
  v_mul_f32 v209, v187, v209
  v_fma_f32 v186, v186, v214, -v212
  v_fma_f32 v187, v187, v205, -v213
  v_fma_f32 v194, v194, v214, v215
  v_fma_f32 v195, v195, v205, v209
  v_lshlrev_b32 v215, 16, v210
  v_and_b32 v210, 0xffff0000, v210
  v_lshlrev_b32 v214, 16, v206
  v_and_b32 v206, 0xffff0000, v206
  v_mul_f32 v212, v216, v215
  v_mul_f32 v213, v217, v210
  v_mul_f32 v215, v188, v215
  v_mul_f32 v210, v189, v210
  v_fma_f32 v188, v188, v214, -v212
  v_fma_f32 v189, v189, v206, -v213
  v_fma_f32 v216, v216, v214, v215
  v_fma_f32 v217, v217, v206, v210
  v_lshlrev_b32 v215, 16, v211
  v_and_b32 v211, 0xffff0000, v211
  v_lshlrev_b32 v214, 16, v207
  v_and_b32 v207, 0xffff0000, v207
  v_mul_f32 v212, v218, v215
  v_mul_f32 v213, v219, v211
  v_mul_f32 v215, v190, v215
  v_mul_f32 v211, v191, v211
  v_fma_f32 v190, v190, v214, -v212
  v_fma_f32 v191, v191, v207, -v213
  v_fma_f32 v218, v218, v214, v215
  v_fma_f32 v219, v219, v207, v211
  v_cvt_pk_bf16_f32 v120, v184, v185
  v_cvt_pk_bf16_f32 v121, v186, v187
  v_cvt_pk_bf16_f32 v122, v188, v189
  v_cvt_pk_bf16_f32 v123, v190, v191
  v_cvt_pk_bf16_f32 v124, v192, v193
  v_cvt_pk_bf16_f32 v125, v194, v195
  v_cvt_pk_bf16_f32 v126, v216, v217
  v_cvt_pk_bf16_f32 v127, v218, v219
  v_cvt_pk_bf16_f32 v196, v96, v97
  v_cvt_pk_bf16_f32 v197, v98, v99
  v_mfma_f32_16x16x32_bf16 v[184:187], v[120:123], v[128:131], 0
  ds_write_b64 v155, v[196:197] offset:0
  v_cvt_pk_bf16_f32 v198, v100, v101
  v_mfma_f32_16x16x32_bf16 v[184:187], v[124:127], v[136:139], v[184:187]
  v_cvt_pk_bf16_f32 v199, v102, v103
  ds_write_b64 v155, v[198:199] offset:2048
  v_mfma_f32_16x16x32_bf16 v[188:191], v[120:123], v[140:143], 0
  v_cvt_pk_bf16_f32 v200, v104, v105
  v_cvt_pk_bf16_f32 v201, v106, v107
  v_mfma_f32_16x16x32_bf16 v[188:191], v[124:127], v[148:151], v[188:191]
  ds_write_b64 v156, v[200:201] offset:0
  v_cvt_pk_bf16_f32 v202, v108, v109
  v_mfma_f32_16x16x32_bf16 v[192:195], v[124:127], v[128:131], 0
  v_cvt_pk_bf16_f32 v203, v110, v111
  ds_write_b64 v156, v[202:203] offset:2048
  v_mfma_f32_16x16x32_bf16 v[192:195], v[120:123], v[132:135], v[192:195]
  v_mfma_f32_16x16x32_bf16 v[216:219], v[124:127], v[140:143], 0
  v_mfma_f32_16x16x32_bf16 v[216:219], v[120:123], v[144:147], v[216:219]
  v_cvt_pk_bf16_f32 v204, v184, v185
  v_cvt_pk_bf16_f32 v205, v186, v187
  ds_write_b64 v155, v[204:205] offset:16384
  v_cvt_pk_bf16_f32 v206, v188, v189
  v_cvt_pk_bf16_f32 v207, v190, v191
  ds_write_b64 v155, v[206:207] offset:18432
  v_cvt_pk_bf16_f32 v208, v192, v193
  v_cvt_pk_bf16_f32 v209, v194, v195
  ds_write_b64 v156, v[208:209] offset:16384
  v_cvt_pk_bf16_f32 v210, v216, v217
  v_cvt_pk_bf16_f32 v211, v218, v219
  ds_write_b64 v156, v[210:211] offset:18432
  s_waitcnt lgkmcnt(0)
  s_barrier
  ds_read_b128 v[112:115], v157 offset:0
  ds_read_b128 v[116:119], v157 offset:4096
  ds_read_b128 v[120:123], v157 offset:16384
  ds_read_b128 v[124:127], v157 offset:20480
  s_waitcnt lgkmcnt(3)
  buffer_store_dwordx4 v[112:115], v220, s[24:27], s84 offen sc1
  s_waitcnt lgkmcnt(2)
  buffer_store_dwordx4 v[116:119], v220, s[24:27], s85 offen sc1
  s_waitcnt lgkmcnt(1)
  buffer_store_dwordx4 v[120:123], v220, s[24:27], s86 offen sc1
  s_waitcnt lgkmcnt(0)
  buffer_store_dwordx4 v[124:127], v220, s[24:27], s92 offen sc1
L_s2e_gated_mix__spectral_gfnet__swiglu_ffn__prompt_kernel:
  s_waitcnt lgkmcnt(6)
  v_mfma_f32_16x16x32_bf16 v[128:131], v[160:163], a[0:3], 0
  s_lshr_b32 s75, s98, 5
  s_nop 4
  ds_read_b64_tr_b16 v[184:185], v8 offset:28672
  ds_read_b64_tr_b16 v[186:187], v8 offset:29184
  v_mfma_f32_16x16x32_bf16 v[128:131], v[164:167], a[16:19], v[128:131]
  s_cmp_eq_u32 s75, 9
  s_cselect_b32 s75, 0, s75
  v_mfma_f32_16x16x32_bf16 v[128:131], v[168:171], a[32:35], v[128:131]
  s_add_u32 m0, s82, 102016
  v_exp_f32 v24, v24
  v_mfma_f32_16x16x32_bf16 v[132:135], v[168:171], a[36:39], 0
  buffer_load_dwordx4 v4, s[16:19], s49 offen offset:384 lds
  v_mfma_f32_16x16x32_bf16 v[132:135], v[164:167], a[20:23], v[132:135]
  s_add_u32 s75, s75, 9
  ds_read_b64_tr_b16 v[188:189], v8 offset:24576
  ds_read_b64_tr_b16 v[190:191], v8 offset:25088
  v_mfma_f32_16x16x32_bf16 v[132:135], v[160:163], a[4:7], v[132:135]
  s_add_u32 s83, s79, 34
  v_exp_f32 v25, v25
  v_mfma_f32_16x16x32_bf16 v[136:139], v[160:163], a[8:11], 0
  s_cmp_gt_u32 s98, 288
  s_cselect_b32 s75, s83, s75
  v_mfma_f32_16x16x32_bf16 v[136:139], v[164:167], a[24:27], v[136:139]
  s_add_u32 m0, s82, 97920
  ds_read_b64_tr_b16 v[192:193], v8 offset:61440
  ds_read_b64_tr_b16 v[194:195], v8 offset:61952
  v_mfma_f32_16x16x32_bf16 v[136:139], v[168:171], a[40:43], v[136:139]
  buffer_load_dwordx4 v4, s[16:19], s50 offen offset:384 lds
  v_mfma_f32_16x16x32_bf16 v[140:143], v[168:171], a[44:47], 0
  s_lshl_b32 s75, s75, 7
  v_exp_f32 v26, v26
  v_mfma_f32_16x16x32_bf16 v[140:143], v[164:167], a[28:31], v[140:143]
  s_add_u32 s75, s75, 6422528
  v_exp_f32 v27, v27
  v_mfma_f32_16x16x32_bf16 v[140:143], v[160:163], a[12:15], v[140:143]
  s_waitcnt lgkmcnt(6)
  v_add_f32 v24, 1.0, v24
  v_add_f32 v25, 1.0, v25
  v_mfma_f32_16x16x32_bf16 v[144:147], v[172:175], a[0:3], 0
  s_lshr_b32 s38, s79, 1
  ds_read_b64_tr_b16 v[160:161], v11 offset:28672
  ds_read_b64_tr_b16 v[162:163], v11 offset:29184
  v_mfma_f32_16x16x32_bf16 v[144:147], v[176:179], a[16:19], v[144:147]
  s_lshl_b32 s39, s81, 3
  v_add_f32 v26, 1.0, v26
  v_add_f32 v27, 1.0, v27
  v_mfma_f32_16x16x32_bf16 v[144:147], v[180:183], a[32:35], v[144:147]
  s_add_u32 s38, s38, s39
  v_lshl_add_u32 v212, v0, 5, s38
  v_mul_u32_u24 v212, 9216, v212
  v_mfma_f32_16x16x32_bf16 v[148:151], v[180:183], a[36:39], 0
  s_or_b32 s38, s80, 1
  v_rcp_f32 v24, v24
  v_mfma_f32_16x16x32_bf16 v[148:151], v[176:179], a[20:23], v[148:151]
  s_mul_i32 s38, s38, 576
  ds_read_b64_tr_b16 v[164:165], v11 offset:24576
  ds_read_b64_tr_b16 v[166:167], v11 offset:25088
  v_mfma_f32_16x16x32_bf16 v[148:151], v[172:175], a[4:7], v[148:151]
  s_and_b32 s39, s80, 1
  v_rcp_f32 v25, v25
  v_mfma_f32_16x16x32_bf16 v[152:155], v[172:175], a[8:11], 0
  s_cmp_eq_u32 s39, 0
  s_cselect_b32 s8, s12, s16
  s_cselect_b32 s9, s13, s17
  v_mfma_f32_16x16x32_bf16 v[152:155], v[176:179], a[24:27], v[152:155]
  s_mov_b32 s10, 5308416
  v_rcp_f32 v26, v26
  v_mfma_f32_16x16x32_bf16 v[152:155], v[180:183], a[40:43], v[152:155]
  s_mov_b32 s11, 0x20000
  ds_read_b64_tr_b16 v[168:169], v11 offset:61440
  ds_read_b64_tr_b16 v[170:171], v11 offset:61952
  v_mfma_f32_16x16x32_bf16 v[156:159], v[180:183], a[44:47], 0
  buffer_load_dword v212, v212, s[8:11], s38 offen
  v_mfma_f32_16x16x32_bf16 v[156:159], v[176:179], a[28:31], v[156:159]
  s_lshr_b32 s76, s99, 5
  v_rcp_f32 v27, v27
  v_mfma_f32_16x16x32_bf16 v[156:159], v[172:175], a[12:15], v[156:159]
  s_waitcnt vmcnt(14) lgkmcnt(6)
  v_mul_f32 v40, v40, v24
  v_mul_f32 v41, v41, v25
  v_mfma_f32_16x16x32_bf16 v[128:131], v[184:187], a[48:51], v[128:131]
  s_barrier
  v_mfma_f32_16x16x32_bf16 v[128:131], v[188:191], a[64:67], v[128:131]
  ds_read_b64_tr_b16 v[172:173], v8 offset:57344
  ds_read_b64_tr_b16 v[174:175], v8 offset:57856
  v_mfma_f32_16x16x32_bf16 v[128:131], v[192:195], a[80:83], v[128:131]
  s_cmp_eq_u32 s76, 9
  s_cselect_b32 s76, 0, s76
  v_mul_f32 v42, v42, v26
  v_mfma_f32_16x16x32_bf16 v[132:135], v[192:195], a[84:87], v[132:135]
  s_add_u32 m0, s82, 142976
  v_mul_f32 v43, v43, v27
  v_mul_f32 v28, s96, v44
  v_mfma_f32_16x16x32_bf16 v[132:135], v[188:191], a[68:71], v[132:135]
  buffer_load_dwordx4 v4, s[16:19], s51 offen offset:384 lds
  v_mfma_f32_16x16x32_bf16 v[132:135], v[184:187], a[52:55], v[132:135]
  s_add_u32 s76, s76, 9
  ds_read_b64_tr_b16 v[176:177], v8 offset:20480
  ds_read_b64_tr_b16 v[178:179], v8 offset:20992
  v_mfma_f32_16x16x32_bf16 v[136:139], v[184:187], a[56:59], v[136:139]
  s_add_u32 s83, s79, 34
  v_mul_f32 v29, s96, v45
  v_mul_f32 v30, s96, v46
  v_mfma_f32_16x16x32_bf16 v[136:139], v[188:191], a[72:75], v[136:139]
  s_add_u32 m0, s82, 138880
  v_mul_f32 v31, s96, v47
  v_mfma_f32_16x16x32_bf16 v[136:139], v[192:195], a[88:91], v[136:139]
  buffer_load_dwordx4 v4, s[16:19], s52 offen offset:384 lds
  v_mfma_f32_16x16x32_bf16 v[140:143], v[192:195], a[92:95], v[140:143]
  ds_read_b64_tr_b16 v[180:181], v8 offset:16384
  ds_read_b64_tr_b16 v[182:183], v8 offset:16896
  v_mfma_f32_16x16x32_bf16 v[140:143], v[188:191], a[76:79], v[140:143]
  s_cmp_gt_u32 s99, 288
  s_cselect_b32 s76, s83, s76
  v_mfma_f32_16x16x32_bf16 v[140:143], v[184:187], a[60:63], v[140:143]
  s_waitcnt lgkmcnt(6)
  v_exp_f32 v28, v28
  v_mfma_f32_16x16x32_bf16 v[144:147], v[160:163], a[48:51], v[144:147]
  s_lshl_b32 s76, s76, 7
  ds_read_b64_tr_b16 v[184:185], v11 offset:57344
  ds_read_b64_tr_b16 v[186:187], v11 offset:57856
  v_mfma_f32_16x16x32_bf16 v[144:147], v[164:167], a[64:67], v[144:147]
  s_add_u32 s76, s76, 6422528
  v_exp_f32 v29, v29
  v_mfma_f32_16x16x32_bf16 v[144:147], v[168:171], a[80:83], v[144:147]
  s_add_u32 m0, s82, 134784
  v_exp_f32 v30, v30
  v_mfma_f32_16x16x32_bf16 v[148:151], v[168:171], a[84:87], v[148:151]
  buffer_load_dwordx4 v4, s[16:19], s53 offen offset:384 lds
  v_mfma_f32_16x16x32_bf16 v[148:151], v[164:167], a[68:71], v[148:151]
  ds_read_b64_tr_b16 v[188:189], v11 offset:20480
  ds_read_b64_tr_b16 v[190:191], v11 offset:20992
  v_mfma_f32_16x16x32_bf16 v[148:151], v[160:163], a[52:55], v[148:151]
  v_exp_f32 v31, v31
  v_mfma_f32_16x16x32_bf16 v[152:155], v[160:163], a[56:59], v[152:155]
  v_add_f32 v28, 1.0, v28
  v_add_f32 v29, 1.0, v29
  v_mfma_f32_16x16x32_bf16 v[152:155], v[164:167], a[72:75], v[152:155]
  s_add_u32 m0, s82, 130688
  ds_read_b64_tr_b16 v[192:193], v11 offset:16384
  ds_read_b64_tr_b16 v[194:195], v11 offset:16896
  v_mfma_f32_16x16x32_bf16 v[152:155], v[168:171], a[88:91], v[152:155]
  buffer_load_dwordx4 v4, s[16:19], s54 offen offset:384 lds
  v_mfma_f32_16x16x32_bf16 v[156:159], v[168:171], a[92:95], v[156:159]
  v_add_f32 v30, 1.0, v30
  v_add_f32 v31, 1.0, v31
  v_mfma_f32_16x16x32_bf16 v[156:159], v[164:167], a[76:79], v[156:159]
  v_rcp_f32 v28, v28
  v_mfma_f32_16x16x32_bf16 v[156:159], v[160:163], a[60:63], v[156:159]
  s_waitcnt lgkmcnt(6)
  v_rcp_f32 v29, v29
  v_mfma_f32_16x16x32_bf16 v[128:131], v[172:175], a[96:99], v[128:131]
  ds_read_b64_tr_b16 v[160:161], v8 offset:4096
  ds_read_b64_tr_b16 v[162:163], v8 offset:4608
  v_mfma_f32_16x16x32_bf16 v[128:131], v[176:179], a[112:115], v[128:131]
  v_rcp_f32 v30, v30
  v_mfma_f32_16x16x32_bf16 v[128:131], v[180:183], a[128:131], v[128:131]
  s_add_u32 m0, s82, 77440
  v_rcp_f32 v31, v31
  v_mfma_f32_16x16x32_bf16 v[132:135], v[180:183], a[132:135], v[132:135]
  buffer_load_dwordx4 v4, s[16:19], s55 offen offset:384 lds
  v_mfma_f32_16x16x32_bf16 v[132:135], v[176:179], a[116:119], v[132:135]
  ds_read_b64_tr_b16 v[164:165], v8 offset:0
  ds_read_b64_tr_b16 v[166:167], v8 offset:512
  v_mfma_f32_16x16x32_bf16 v[132:135], v[172:175], a[100:103], v[132:135]
  v_mul_f32 v44, v44, v28
  v_mul_f32 v45, v45, v29
  v_mfma_f32_16x16x32_bf16 v[136:139], v[172:175], a[104:107], v[136:139]
  v_mul_f32 v46, v46, v30
  v_mul_f32 v47, v47, v31
  v_mfma_f32_16x16x32_bf16 v[136:139], v[176:179], a[120:123], v[136:139]
  s_add_u32 m0, s82, 73344
  ds_read_b64_tr_b16 v[168:169], v9 offset:28672
  ds_read_b64_tr_b16 v[170:171], v9 offset:29184
  v_mfma_f32_16x16x32_bf16 v[136:139], v[180:183], a[136:139], v[136:139]
  buffer_load_dwordx4 v4, s[16:19], s56 offen offset:384 lds
  v_mfma_f32_16x16x32_bf16 v[140:143], v[180:183], a[140:143], v[140:143]
  v_mul_f32 v24, s96, v48
  v_mul_f32 v25, s96, v49
  v_mfma_f32_16x16x32_bf16 v[140:143], v[176:179], a[124:127], v[140:143]
  v_mul_f32 v26, s96, v50
  v_mul_f32 v27, s96, v51
  v_mfma_f32_16x16x32_bf16 v[140:143], v[172:175], a[108:111], v[140:143]
  s_waitcnt lgkmcnt(6)
  v_exp_f32 v24, v24
  v_mfma_f32_16x16x32_bf16 v[144:147], v[184:187], a[96:99], v[144:147]
  ds_read_b64_tr_b16 v[172:173], v11 offset:4096
  ds_read_b64_tr_b16 v[174:175], v11 offset:4608
  v_mfma_f32_16x16x32_bf16 v[144:147], v[188:191], a[112:115], v[144:147]
  v_exp_f32 v25, v25
  v_mfma_f32_16x16x32_bf16 v[144:147], v[192:195], a[128:131], v[144:147]
  s_add_u32 m0, s82, 61056
  v_exp_f32 v26, v26
  v_mfma_f32_16x16x32_bf16 v[148:151], v[192:195], a[132:135], v[148:151]
  buffer_load_dwordx4 v4, s[16:19], s57 offen offset:384 lds
  v_mfma_f32_16x16x32_bf16 v[148:151], v[188:191], a[116:119], v[148:151]
  ds_read_b64_tr_b16 v[176:177], v11 offset:0
  ds_read_b64_tr_b16 v[178:179], v11 offset:512
  v_mfma_f32_16x16x32_bf16 v[148:151], v[184:187], a[100:103], v[148:151]
  v_exp_f32 v27, v27
  v_mfma_f32_16x16x32_bf16 v[152:155], v[184:187], a[104:107], v[152:155]
  v_add_f32 v24, 1.0, v24
  v_add_f32 v25, 1.0, v25
  v_mfma_f32_16x16x32_bf16 v[152:155], v[188:191], a[120:123], v[152:155]
  s_add_u32 m0, s82, 56960
  ds_read_b64_tr_b16 v[180:181], v12 offset:28672
  ds_read_b64_tr_b16 v[182:183], v12 offset:29184
  v_mfma_f32_16x16x32_bf16 v[152:155], v[192:195], a[136:139], v[152:155]
  buffer_load_dwordx4 v4, s[16:19], s58 offen offset:384 lds
  v_mfma_f32_16x16x32_bf16 v[156:159], v[192:195], a[140:143], v[156:159]
  v_add_f32 v26, 1.0, v26
  v_add_f32 v27, 1.0, v27
  v_mfma_f32_16x16x32_bf16 v[156:159], v[188:191], a[124:127], v[156:159]
  v_rcp_f32 v24, v24
  v_mfma_f32_16x16x32_bf16 v[156:159], v[184:187], a[108:111], v[156:159]
  s_waitcnt vmcnt(15) lgkmcnt(6)
  v_rcp_f32 v25, v25
  v_mfma_f32_16x16x32_bf16 v[128:131], v[160:163], a[144:147], v[128:131]
  s_barrier
  v_mfma_f32_16x16x32_bf16 v[128:131], v[164:167], a[160:163], v[128:131]
  ds_read_b64_tr_b16 v[184:185], v9 offset:24576
  ds_read_b64_tr_b16 v[186:187], v9 offset:25088
  v_mfma_f32_16x16x32_bf16 v[128:131], v[168:171], a[176:179], v[128:131]
  v_rcp_f32 v26, v26
  v_mfma_f32_16x16x32_bf16 v[132:135], v[168:171], a[180:183], v[132:135]
  s_add_u32 m0, s82, 126592
  v_rcp_f32 v27, v27
  v_mfma_f32_16x16x32_bf16 v[132:135], v[164:167], a[164:167], v[132:135]
  buffer_load_dwordx4 v4, s[16:19], s59 offen offset:384 lds
  v_mfma_f32_16x16x32_bf16 v[132:135], v[160:163], a[148:151], v[132:135]
  ds_read_b64_tr_b16 v[188:189], v8 offset:53248
  ds_read_b64_tr_b16 v[190:191], v8 offset:53760
  v_mfma_f32_16x16x32_bf16 v[136:139], v[160:163], a[152:155], v[136:139]
  v_mul_f32 v48, v48, v24
  v_mul_f32 v49, v49, v25
  v_mfma_f32_16x16x32_bf16 v[136:139], v[164:167], a[168:171], v[136:139]
  s_add_u32 m0, s82, 122496
  v_mul_f32 v50, v50, v26
  v_mul_f32 v51, v51, v27
  v_mfma_f32_16x16x32_bf16 v[136:139], v[168:171], a[184:187], v[136:139]
  buffer_load_dwordx4 v4, s[16:19], s60 offen offset:384 lds
  v_mfma_f32_16x16x32_bf16 v[140:143], v[168:171], a[188:191], v[140:143]
  ds_read_b64_tr_b16 v[192:193], v8 offset:49152
  ds_read_b64_tr_b16 v[194:195], v8 offset:49664
  v_mfma_f32_16x16x32_bf16 v[140:143], v[164:167], a[172:175], v[140:143]
  v_mul_f32 v28, s96, v52
  v_mul_f32 v29, s96, v53
  v_mfma_f32_16x16x32_bf16 v[140:143], v[160:163], a[156:159], v[140:143]
  s_waitcnt lgkmcnt(6)
  v_mul_f32 v30, s96, v54
  v_mul_f32 v31, s96, v55
  v_mfma_f32_16x16x32_bf16 v[144:147], v[172:175], a[144:147], v[144:147]
  ds_read_b64_tr_b16 v[160:161], v12 offset:24576
  ds_read_b64_tr_b16 v[162:163], v12 offset:25088
  v_mfma_f32_16x16x32_bf16 v[144:147], v[176:179], a[160:163], v[144:147]
  v_exp_f32 v28, v28
  v_mfma_f32_16x16x32_bf16 v[144:147], v[180:183], a[176:179], v[144:147]
  s_add_u32 m0, s82, 93824
  v_exp_f32 v29, v29
  v_mfma_f32_16x16x32_bf16 v[148:151], v[180:183], a[180:183], v[148:151]
  buffer_load_dwordx4 v4, s[16:19], s61 offen offset:384 lds
  v_mfma_f32_16x16x32_bf16 v[148:151], v[176:179], a[164:167], v[148:151]
  ds_read_b64_tr_b16 v[164:165], v11 offset:53248
  ds_read_b64_tr_b16 v[166:167], v11 offset:53760
  v_mfma_f32_16x16x32_bf16 v[148:151], v[172:175], a[148:151], v[148:151]
  v_exp_f32 v30, v30
  v_mfma_f32_16x16x32_bf16 v[152:155], v[172:175], a[152:155], v[152:155]
  s_lshl_b32 s6, s88, 3
  v_exp_f32 v31, v31
  v_mfma_f32_16x16x32_bf16 v[152:155], v[176:179], a[168:171], v[152:155]
  s_add_u32 m0, s82, 89728
  ds_read_b64_tr_b16 v[168:169], v11 offset:49152
  ds_read_b64_tr_b16 v[170:171], v11 offset:49664
  v_mfma_f32_16x16x32_bf16 v[152:155], v[180:183], a[184:187], v[152:155]
  buffer_load_dwordx4 v4, s[16:19], s62 offen offset:384 lds
  v_mfma_f32_16x16x32_bf16 v[156:159], v[180:183], a[188:191], v[156:159]
  s_lshl_b32 s7, s87, 12
  v_add_f32 v28, 1.0, v28
  v_add_f32 v29, 1.0, v29
  v_mfma_f32_16x16x32_bf16 v[156:159], v[176:179], a[172:175], v[156:159]
  s_add_u32 s6, s6, s7
  v_add_u32 v20, s6, v22
  v_add_f32 v30, 1.0, v30
  v_mfma_f32_16x16x32_bf16 v[156:159], v[172:175], a[156:159], v[156:159]
  s_waitcnt lgkmcnt(6)
  v_add_f32 v31, 1.0, v31
  v_mfma_f32_16x16x32_bf16 v[128:131], v[184:187], a[192:195], v[128:131]
  s_lshl_b32 s6, s79, 1
  ds_read_b64_tr_b16 v[172:173], v9 offset:20480
  ds_read_b64_tr_b16 v[174:175], v9 offset:20992
  v_mfma_f32_16x16x32_bf16 v[128:131], v[188:191], a[208:211], v[128:131]
  s_and_b32 s7, s80, 1
  v_rcp_f32 v28, v28
  v_mfma_f32_16x16x32_bf16 v[128:131], v[192:195], a[224:227], v[128:131]
  s_add_u32 m0, s82, 85632
  v_rcp_f32 v29, v29
  v_mfma_f32_16x16x32_bf16 v[132:135], v[192:195], a[228:231], v[132:135]
  buffer_load_dwordx4 v4, s[16:19], s63 offen offset:384 lds
  v_mfma_f32_16x16x32_bf16 v[132:135], v[188:191], a[212:215], v[132:135]
  s_add_u32 s6, s6, s7
  ds_read_b64_tr_b16 v[176:177], v9 offset:16384
  ds_read_b64_tr_b16 v[178:179], v9 offset:16896
  v_mfma_f32_16x16x32_bf16 v[132:135], v[184:187], a[196:199], v[132:135]
  s_lshl_b32 s6, s6, 19
  v_rcp_f32 v30, v30
  v_mfma_f32_16x16x32_bf16 v[136:139], v[184:187], a[200:203], v[136:139]
  s_lshl_b32 s7, s81, 15
  v_rcp_f32 v31, v31
  v_mfma_f32_16x16x32_bf16 v[136:139], v[188:191], a[216:219], v[136:139]
  s_add_u32 m0, s82, 81536
  ds_read_b64_tr_b16 v[180:181], v8 offset:45056
  ds_read_b64_tr_b16 v[182:183], v8 offset:45568
  v_mfma_f32_16x16x32_bf16 v[136:139], v[192:195], a[232:235], v[136:139]
  buffer_load_dwordx4 v4, s[16:19], s64 offen offset:384 lds
  v_mfma_f32_16x16x32_bf16 v[140:143], v[192:195], a[236:239], v[140:143]
  s_add_u32 s6, s6, s7
  v_mul_f32 v52, v52, v28
  v_mul_f32 v53, v53, v29
  v_mfma_f32_16x16x32_bf16 v[140:143], v[188:191], a[220:223], v[140:143]
  s_lshr_b32 s7, s80, 1
  v_mul_f32 v54, v54, v30
  v_mul_f32 v55, v55, v31
  v_mfma_f32_16x16x32_bf16 v[140:143], v[184:187], a[204:207], v[140:143]
  s_waitcnt lgkmcnt(6)
  v_mul_f32 v24, s96, v56
  v_mul_f32 v25, s96, v57
  v_mfma_f32_16x16x32_bf16 v[144:147], v[160:163], a[192:195], v[144:147]
  s_lshl_b32 s7, s7, 10
  ds_read_b64_tr_b16 v[184:185], v12 offset:20480
  ds_read_b64_tr_b16 v[186:187], v12 offset:20992
  v_mfma_f32_16x16x32_bf16 v[144:147], v[164:167], a[208:211], v[144:147]
  s_add_u32 s6, s6, s7
  v_add_u32 v23, s6, v21
  v_add_u32 v221, 0x400, v6
  v_mfma_f32_16x16x32_bf16 v[144:147], v[168:171], a[224:227], v[144:147]
  s_add_u32 m0, s82, 52864
  v_mul_f32 v26, s96, v58
  v_mul_f32 v27, s96, v59
  v_mfma_f32_16x16x32_bf16 v[148:151], v[168:171], a[228:231], v[148:151]
  buffer_load_dwordx4 v4, s[16:19], s65 offen offset:384 lds
  v_mfma_f32_16x16x32_bf16 v[148:151], v[164:167], a[212:215], v[148:151]
  s_and_b32 s6, s80, 1
  ds_read_b64_tr_b16 v[188:189], v12 offset:16384
  ds_read_b64_tr_b16 v[190:191], v12 offset:16896
  v_mfma_f32_16x16x32_bf16 v[148:151], v[160:163], a[196:199], v[148:151]
  v_lshl_add_u32 v6, s6, 9, v6
  v_mfma_f32_16x16x32_bf16 v[152:155], v[160:163], a[200:203], v[152:155]
  s_lshl_b32 s83, s79, 7
  v_exp_f32 v24, v24
  v_mfma_f32_16x16x32_bf16 v[152:155], v[164:167], a[216:219], v[152:155]
  s_add_u32 m0, s82, 49152
  ds_read_b64_tr_b16 v[192:193], v11 offset:45056
  ds_read_b64_tr_b16 v[194:195], v11 offset:45568
  v_mfma_f32_16x16x32_bf16 v[152:155], v[168:171], a[232:235], v[152:155]
  buffer_load_dwordx4 v5, s[12:15], s48 offen lds
  v_mfma_f32_16x16x32_bf16 v[156:159], v[168:171], a[236:239], v[156:159]
  s_lshl_b32 s101, s80, 2
  v_exp_f32 v25, v25
  v_mfma_f32_16x16x32_bf16 v[156:159], v[164:167], a[220:223], v[156:159]
  s_add_u32 s83, s83, s101
  v_exp_f32 v26, v26
  v_mfma_f32_16x16x32_bf16 v[156:159], v[160:163], a[204:207], v[156:159]
  s_waitcnt vmcnt(13) lgkmcnt(6)
  v_exp_f32 v27, v27
  v_mfma_f32_16x16x32_bf16 v[128:131], v[172:175], a[240:243], v[128:131]
  s_barrier
  v_mfma_f32_16x16x32_bf16 v[128:131], v[176:179], v[224:227], v[128:131]
  s_add_u32 s83, s83, 6428928
  ds_read_b64_tr_b16 v[160:161], v8 offset:40960
  ds_read_b64_tr_b16 v[162:163], v8 offset:41472
  v_mfma_f32_16x16x32_bf16 v[128:131], v[180:183], v[240:243], v[128:131]
  buffer_atomic_add v3, v222, s[24:27], s75 offen sc1
  v_mfma_f32_16x16x32_bf16 v[132:135], v[180:183], v[244:247], v[132:135]
  s_add_u32 m0, s82, 159744
  v_add_f32 v24, 1.0, v24
  v_add_f32 v25, 1.0, v25
  v_mfma_f32_16x16x32_bf16 v[132:135], v[176:179], v[228:231], v[132:135]
  buffer_load_dwordx4 v5, s[12:15], s50 offen lds
  v_mfma_f32_16x16x32_bf16 v[132:135], v[172:175], a[244:247], v[132:135]
  s_xor_b32 s101, s83, 4
  ds_read_b64_tr_b16 v[164:165], v8 offset:36864
  ds_read_b64_tr_b16 v[166:167], v8 offset:37376
  v_mfma_f32_16x16x32_bf16 v[136:139], v[172:175], a[248:251], v[136:139]
  buffer_atomic_add v3, v222, s[24:27], s76 offen sc1
  v_mfma_f32_16x16x32_bf16 v[136:139], v[176:179], v[232:235], v[136:139]
  s_add_u32 m0, s82, 155648
  v_add_f32 v26, 1.0, v26
  v_add_f32 v27, 1.0, v27
  v_mfma_f32_16x16x32_bf16 v[136:139], v[180:183], v[248:251], v[136:139]
  buffer_load_dwordx4 v5, s[12:15], s52 offen lds
  v_mfma_f32_16x16x32_bf16 v[140:143], v[180:183], v[252:255], v[140:143]
  ds_read_b64_tr_b16 v[168:169], v8 offset:32768
  ds_read_b64_tr_b16 v[170:171], v8 offset:33280
  v_mfma_f32_16x16x32_bf16 v[140:143], v[176:179], v[236:239], v[140:143]
  s_cmp_eq_u32 s81, 0
  s_cselect_b32 s45, 1, 0
  v_mfma_f32_16x16x32_bf16 v[140:143], v[172:175], a[252:255], v[140:143]
  s_waitcnt lgkmcnt(6)
  v_rcp_f32 v24, v24
  v_mfma_f32_16x16x32_bf16 v[144:147], v[184:187], a[240:243], v[144:147]
  ds_read_b64_tr_b16 v[172:173], v11 offset:40960
  ds_read_b64_tr_b16 v[174:175], v11 offset:41472
  v_mfma_f32_16x16x32_bf16 v[144:147], v[188:191], v[224:227], v[144:147]
  v_rcp_f32 v25, v25
  v_mfma_f32_16x16x32_bf16 v[144:147], v[192:195], v[240:243], v[144:147]
  s_add_u32 m0, s82, 118784
  v_rcp_f32 v26, v26
  v_mfma_f32_16x16x32_bf16 v[148:151], v[192:195], v[244:247], v[148:151]
  buffer_load_dwordx4 v5, s[12:15], s54 offen lds
  v_mfma_f32_16x16x32_bf16 v[148:151], v[188:191], v[228:231], v[148:151]
  ds_read_b64_tr_b16 v[176:177], v11 offset:36864
  ds_read_b64_tr_b16 v[178:179], v11 offset:37376
  v_mfma_f32_16x16x32_bf16 v[148:151], v[184:187], a[244:247], v[148:151]
  v_rcp_f32 v27, v27
  v_mfma_f32_16x16x32_bf16 v[152:155], v[184:187], a[248:251], v[152:155]
  v_mul_f32 v56, v56, v24
  v_mul_f32 v57, v57, v25
  v_mfma_f32_16x16x32_bf16 v[152:155], v[188:191], v[232:235], v[152:155]
  s_add_u32 m0, s82, 114688
  ds_read_b64_tr_b16 v[180:181], v11 offset:32768
  ds_read_b64_tr_b16 v[182:183], v11 offset:33280
  v_mfma_f32_16x16x32_bf16 v[152:155], v[192:195], v[248:251], v[152:155]
  buffer_load_dwordx4 v5, s[12:15], s56 offen lds
  v_mfma_f32_16x16x32_bf16 v[156:159], v[192:195], v[252:255], v[156:159]
  v_mul_f32 v58, v58, v26
  v_mul_f32 v59, v59, v27
  v_mfma_f32_16x16x32_bf16 v[156:159], v[188:191], v[236:239], v[156:159]
  v_mul_f32 v28, s96, v60
  v_mul_f32 v29, s96, v61
  v_mfma_f32_16x16x32_bf16 v[156:159], v[184:187], a[252:255], v[156:159]
  s_waitcnt lgkmcnt(6)
  v_mul_f32 v30, s96, v62
  v_mul_f32 v31, s96, v63
  v_mfma_f32_16x16x32_bf16 v[96:99], v[160:163], a[0:3], 0
  ds_read_b64_tr_b16 v[184:185], v9 offset:12288
  ds_read_b64_tr_b16 v[186:187], v9 offset:12800
  v_mfma_f32_16x16x32_bf16 v[96:99], v[164:167], a[16:19], v[96:99]
  v_exp_f32 v28, v28
  v_mfma_f32_16x16x32_bf16 v[96:99], v[168:171], a[32:35], v[96:99]
  s_add_u32 m0, s82, 69632
  v_exp_f32 v29, v29
  v_mfma_f32_16x16x32_bf16 v[100:103], v[168:171], a[36:39], 0
  buffer_load_dwordx4 v5, s[12:15], s58 offen lds
  v_mfma_f32_16x16x32_bf16 v[100:103], v[164:167], a[20:23], v[100:103]
  ds_read_b64_tr_b16 v[188:189], v9 offset:8192
  ds_read_b64_tr_b16 v[190:191], v9 offset:8704
  v_mfma_f32_16x16x32_bf16 v[100:103], v[160:163], a[4:7], v[100:103]
  v_exp_f32 v30, v30
  v_mfma_f32_16x16x32_bf16 v[104:107], v[160:163], a[8:11], 0
  v_exp_f32 v31, v31
  v_mfma_f32_16x16x32_bf16 v[104:107], v[164:167], a[24:27], v[104:107]
  s_add_u32 m0, s82, 65536
  ds_read_b64_tr_b16 v[192:193], v9 offset:4096
  ds_read_b64_tr_b16 v[194:195], v9 offset:4608
  v_mfma_f32_16x16x32_bf16 v[104:107], v[168:171], a[40:43], v[104:107]
  buffer_load_dwordx4 v5, s[12:15], s60 offen lds
  v_mfma_f32_16x16x32_bf16 v[108:111], v[168:171], a[44:47], 0
  v_add_f32 v28, 1.0, v28
  v_add_f32 v29, 1.0, v29
  v_mfma_f32_16x16x32_bf16 v[108:111], v[164:167], a[28:31], v[108:111]
  v_add_f32 v30, 1.0, v30
  v_add_f32 v31, 1.0, v31
  v_mfma_f32_16x16x32_bf16 v[108:111], v[160:163], a[12:15], v[108:111]
  s_waitcnt lgkmcnt(6)
  v_rcp_f32 v28, v28
  v_mfma_f32_16x16x32_bf16 v[112:115], v[172:175], a[0:3], 0
  ds_read_b64_tr_b16 v[160:161], v12 offset:12288
  ds_read_b64_tr_b16 v[162:163], v12 offset:12800
  v_mfma_f32_16x16x32_bf16 v[112:115], v[176:179], a[16:19], v[112:115]
  v_rcp_f32 v29, v29
  v_mfma_f32_16x16x32_bf16 v[112:115], v[180:183], a[32:35], v[112:115]
  v_rcp_f32 v30, v30
  v_mfma_f32_16x16x32_bf16 v[116:119], v[180:183], a[36:39], 0
  v_rcp_f32 v31, v31
  v_mfma_f32_16x16x32_bf16 v[116:119], v[176:179], a[20:23], v[116:119]
  ds_read_b64_tr_b16 v[164:165], v12 offset:8192
  ds_read_b64_tr_b16 v[166:167], v12 offset:8704
  v_mfma_f32_16x16x32_bf16 v[116:119], v[172:175], a[4:7], v[116:119]
  v_mul_f32 v60, v60, v28
  v_mul_f32 v61, v61, v29
  v_mfma_f32_16x16x32_bf16 v[120:123], v[172:175], a[8:11], 0
  v_mul_f32 v62, v62, v30
  v_mul_f32 v63, v63, v31
  v_mfma_f32_16x16x32_bf16 v[120:123], v[176:179], a[24:27], v[120:123]
  v_mul_f32 v32, v32, v64
  v_mul_f32 v33, v33, v65
  v_mfma_f32_16x16x32_bf16 v[120:123], v[180:183], a[40:43], v[120:123]
  ds_read_b64_tr_b16 v[168:169], v12 offset:4096
  ds_read_b64_tr_b16 v[170:171], v12 offset:4608
  v_mfma_f32_16x16x32_bf16 v[124:127], v[180:183], a[44:47], 0
  v_mul_f32 v34, v34, v66
  v_mul_f32 v35, v35, v67
  v_mfma_f32_16x16x32_bf16 v[124:127], v[176:179], a[28:31], v[124:127]
  v_mul_f32 v48, v48, v80
  v_mul_f32 v49, v49, v81
  v_mfma_f32_16x16x32_bf16 v[124:127], v[172:175], a[12:15], v[124:127]
  s_waitcnt vmcnt(15) lgkmcnt(6)
  v_mul_f32 v50, v50, v82
  v_mul_f32 v51, v51, v83
  v_mfma_f32_16x16x32_bf16 v[96:99], v[184:187], a[48:51], v[96:99]
  s_barrier
  v_mfma_f32_16x16x32_bf16 v[96:99], v[188:191], a[64:67], v[96:99]
  ds_read_b64_tr_b16 v[172:173], v9 offset:0
  ds_read_b64_tr_b16 v[174:175], v9 offset:512
  v_mfma_f32_16x16x32_bf16 v[96:99], v[192:195], a[80:83], v[96:99]
  v_cvt_pk_bf16_f32 v64, v32, v33
  v_cvt_pk_bf16_f32 v65, v34, v35
  v_mfma_f32_16x16x32_bf16 v[100:103], v[192:195], a[84:87], v[100:103]
  s_add_u32 m0, s82, 151552
  v_cvt_pk_bf16_f32 v66, v48, v49
  v_cvt_pk_bf16_f32 v67, v50, v51
  v_mfma_f32_16x16x32_bf16 v[100:103], v[188:191], a[68:71], v[100:103]
  buffer_load_dwordx4 v5, s[12:15], s62 offen lds
  v_mfma_f32_16x16x32_bf16 v[100:103], v[184:187], a[52:55], v[100:103]
  ds_read_b64_tr_b16 v[176:177], v8 offset:12288
  ds_read_b64_tr_b16 v[178:179], v8 offset:12800
  v_mfma_f32_16x16x32_bf16 v[104:107], v[184:187], a[56:59], v[104:107]
  ds_write_b128 v19, v[64:67] offset:32768
  v_mfma_f32_16x16x32_bf16 v[104:107], v[188:191], a[72:75], v[104:107]
  s_add_u32 m0, s82, 147456
  v_mul_f32 v36, v36, v68
  v_mul_f32 v37, v37, v69
  v_mfma_f32_16x16x32_bf16 v[104:107], v[192:195], a[88:91], v[104:107]
  buffer_load_dwordx4 v5, s[12:15], s64 offen lds
  v_mfma_f32_16x16x32_bf16 v[108:111], v[192:195], a[92:95], v[108:111]
  ds_read_b64_tr_b16 v[180:181], v8 offset:8192
  ds_read_b64_tr_b16 v[182:183], v8 offset:8704
  v_mfma_f32_16x16x32_bf16 v[108:111], v[188:191], a[76:79], v[108:111]
  v_mul_f32 v38, v38, v70
  v_mul_f32 v39, v39, v71
  v_mfma_f32_16x16x32_bf16 v[108:111], v[184:187], a[60:63], v[108:111]
  s_waitcnt lgkmcnt(7)
  v_mul_f32 v52, v52, v84
  v_mul_f32 v53, v53, v85
  v_mfma_f32_16x16x32_bf16 v[112:115], v[160:163], a[48:51], v[112:115]
  ds_read_b64_tr_b16 v[184:185], v12 offset:0
  ds_read_b64_tr_b16 v[186:187], v12 offset:512
  v_mfma_f32_16x16x32_bf16 v[112:115], v[164:167], a[64:67], v[112:115]
  v_mul_f32 v54, v54, v86
  v_mul_f32 v55, v55, v87
  v_mfma_f32_16x16x32_bf16 v[112:115], v[168:171], a[80:83], v[112:115]
  s_add_u32 m0, s82, 110592
  v_cvt_pk_bf16_f32 v68, v36, v37
  v_cvt_pk_bf16_f32 v69, v38, v39
  v_mfma_f32_16x16x32_bf16 v[116:119], v[168:171], a[84:87], v[116:119]
  buffer_load_dwordx4 v5, s[16:19], s48 offen lds
  v_mfma_f32_16x16x32_bf16 v[116:119], v[164:167], a[68:71], v[116:119]
  ds_read_b64_tr_b16 v[188:189], v11 offset:12288
  ds_read_b64_tr_b16 v[190:191], v11 offset:12800
  v_mfma_f32_16x16x32_bf16 v[116:119], v[160:163], a[52:55], v[116:119]
  v_cvt_pk_bf16_f32 v70, v52, v53
  v_cvt_pk_bf16_f32 v71, v54, v55
  v_mfma_f32_16x16x32_bf16 v[120:123], v[160:163], a[56:59], v[120:123]
  ds_write_b128 v19, v[68:71] offset:33792
  v_mfma_f32_16x16x32_bf16 v[120:123], v[164:167], a[72:75], v[120:123]
  s_add_u32 m0, s82, 106496
  ds_read_b64_tr_b16 v[192:193], v11 offset:8192
  ds_read_b64_tr_b16 v[194:195], v11 offset:8704
  v_mfma_f32_16x16x32_bf16 v[120:123], v[168:171], a[88:91], v[120:123]
  buffer_load_dwordx4 v5, s[16:19], s50 offen lds
  v_mfma_f32_16x16x32_bf16 v[124:127], v[168:171], a[92:95], v[124:127]
  v_mul_f32 v40, v40, v72
  v_mul_f32 v41, v41, v73
  v_mfma_f32_16x16x32_bf16 v[124:127], v[164:167], a[76:79], v[124:127]
  v_mul_f32 v42, v42, v74
  v_mul_f32 v43, v43, v75
  v_mfma_f32_16x16x32_bf16 v[124:127], v[160:163], a[60:63], v[124:127]
  s_waitcnt lgkmcnt(7)
  v_mul_f32 v56, v56, v88
  v_mul_f32 v57, v57, v89
  v_mfma_f32_16x16x32_bf16 v[96:99], v[172:175], a[96:99], v[96:99]
  ds_read_b64_tr_b16 v[160:161], v7 offset:61440
  ds_read_b64_tr_b16 v[162:163], v7 offset:61952
  v_mfma_f32_16x16x32_bf16 v[96:99], v[176:179], a[112:115], v[96:99]
  v_mul_f32 v58, v58, v90
  v_mul_f32 v59, v59, v91
  v_mfma_f32_16x16x32_bf16 v[96:99], v[180:183], a[128:131], v[96:99]
  s_add_u32 m0, s82, 102400
  v_cvt_pk_bf16_f32 v72, v40, v41
  v_cvt_pk_bf16_f32 v73, v42, v43
  v_mfma_f32_16x16x32_bf16 v[100:103], v[180:183], a[132:135], v[100:103]
  buffer_load_dwordx4 v5, s[16:19], s52 offen lds
  v_mfma_f32_16x16x32_bf16 v[100:103], v[176:179], a[116:119], v[100:103]
  ds_read_b64_tr_b16 v[164:165], v7 offset:57344
  ds_read_b64_tr_b16 v[166:167], v7 offset:57856
  v_cvt_pk_bf16_f32 v74, v56, v57
  v_mfma_f32_16x16x32_bf16 v[100:103], v[172:175], a[100:103], v[100:103]
  v_cvt_pk_bf16_f32 v75, v58, v59
  v_mul_f32 v24, s96, v128
  v_mfma_f32_16x16x32_bf16 v[104:107], v[172:175], a[104:107], v[104:107]
  ds_write_b128 v19, v[72:75] offset:34816
  v_mfma_f32_16x16x32_bf16 v[104:107], v[176:179], a[120:123], v[104:107]
  s_add_u32 m0, s82, 98304
  ds_read_b64_tr_b16 v[168:169], v8 offset:61440
  ds_read_b64_tr_b16 v[170:171], v8 offset:61952
  v_mfma_f32_16x16x32_bf16 v[104:107], v[180:183], a[136:139], v[104:107]
  buffer_load_dwordx4 v5, s[16:19], s54 offen lds
  v_mfma_f32_16x16x32_bf16 v[108:111], v[180:183], a[140:143], v[108:111]
  v_mul_f32 v44, v44, v76
  v_mul_f32 v45, v45, v77
  v_mfma_f32_16x16x32_bf16 v[108:111], v[176:179], a[124:127], v[108:111]
  v_mul_f32 v46, v46, v78
  v_mul_f32 v47, v47, v79
  v_mul_f32 v60, v60, v92
  v_mfma_f32_16x16x32_bf16 v[108:111], v[172:175], a[108:111], v[108:111]
  s_waitcnt lgkmcnt(7)
  v_mul_f32 v61, v61, v93
  v_mul_f32 v62, v62, v94
  v_mfma_f32_16x16x32_bf16 v[112:115], v[184:187], a[96:99], v[112:115]
  ds_read_b64_tr_b16 v[172:173], v10 offset:61440
  ds_read_b64_tr_b16 v[174:175], v10 offset:61952
  v_mfma_f32_16x16x32_bf16 v[112:115], v[188:191], a[112:115], v[112:115]
  v_mul_f32 v63, v63, v95
  v_cvt_pk_bf16_f32 v76, v44, v45
  v_mfma_f32_16x16x32_bf16 v[112:115], v[192:195], a[128:131], v[112:115]
  v_cvt_pk_bf16_f32 v77, v46, v47
  v_cvt_pk_bf16_f32 v78, v60, v61
  v_mfma_f32_16x16x32_bf16 v[116:119], v[192:195], a[132:135], v[116:119]
  v_cvt_pk_bf16_f32 v79, v62, v63
  v_mul_f32 v25, s96, v129
  v_mfma_f32_16x16x32_bf16 v[116:119], v[188:191], a[116:119], v[116:119]
  ds_read_b64_tr_b16 v[176:177], v10 offset:57344
  ds_read_b64_tr_b16 v[178:179], v10 offset:57856
  v_mfma_f32_16x16x32_bf16 v[116:119], v[184:187], a[100:103], v[116:119]
  ds_write_b128 v19, v[76:79] offset:35840
  v_mfma_f32_16x16x32_bf16 v[120:123], v[184:187], a[104:107], v[120:123]
  s_add_u32 s47, s46, 32768
  v_mul_f32 v26, s96, v130
  v_mul_f32 v27, s96, v131
  v_mfma_f32_16x16x32_bf16 v[120:123], v[188:191], a[120:123], v[120:123]
  buffer_store_dwordx4 v[64:67], v19, s[24:27], s47 offen offset:0 sc1
  v_mfma_f32_16x16x32_bf16 v[120:123], v[192:195], a[136:139], v[120:123]
  ds_read_b64_tr_b16 v[180:181], v11 offset:61440
  ds_read_b64_tr_b16 v[182:183], v11 offset:61952
  v_mfma_f32_16x16x32_bf16 v[124:127], v[192:195], a[140:143], v[124:127]
  v_exp_f32 v24, v24
  v_mfma_f32_16x16x32_bf16 v[124:127], v[188:191], a[124:127], v[124:127]
  v_exp_f32 v25, v25
  v_mfma_f32_16x16x32_bf16 v[124:127], v[184:187], a[108:111], v[124:127]
  s_waitcnt vmcnt(16) lgkmcnt(7)
  v_exp_f32 v26, v26
  v_mfma_f32_16x16x32_bf16 v[96:99], v[160:163], a[144:147], v[96:99]
  s_barrier
  v_mfma_f32_16x16x32_bf16 v[96:99], v[164:167], a[160:163], v[96:99]
  ds_read_b64_tr_b16 v[184:185], v8 offset:57344
  ds_read_b64_tr_b16 v[186:187], v8 offset:57856
  v_exp_f32 v27, v27
  v_mfma_f32_16x16x32_bf16 v[96:99], v[168:171], a[176:179], v[96:99]
  v_add_f32 v24, 1.0, v24
  v_add_f32 v25, 1.0, v25
  v_mfma_f32_16x16x32_bf16 v[100:103], v[168:171], a[180:183], v[100:103]
  s_add_u32 m0, s82, 143360
  v_add_f32 v26, 1.0, v26
  v_add_f32 v27, 1.0, v27
  v_mfma_f32_16x16x32_bf16 v[100:103], v[164:167], a[164:167], v[100:103]
  buffer_load_dwordx4 v5, s[16:19], s56 offen lds
  v_mfma_f32_16x16x32_bf16 v[100:103], v[160:163], a[148:151], v[100:103]
  ds_read_b64_tr_b16 v[188:189], v8 offset:28672
  ds_read_b64_tr_b16 v[190:191], v8 offset:29184
  v_mfma_f32_16x16x32_bf16 v[104:107], v[160:163], a[152:155], v[104:107]
  v_rcp_f32 v24, v24
  v_mfma_f32_16x16x32_bf16 v[104:107], v[164:167], a[168:171], v[104:107]
  s_add_u32 m0, s82, 139264
  v_rcp_f32 v25, v25
  v_mfma_f32_16x16x32_bf16 v[104:107], v[168:171], a[184:187], v[104:107]
  buffer_load_dwordx4 v5, s[16:19], s58 offen lds
  v_mfma_f32_16x16x32_bf16 v[108:111], v[168:171], a[188:191], v[108:111]
  ds_read_b64_tr_b16 v[192:193], v8 offset:24576
  ds_read_b64_tr_b16 v[194:195], v8 offset:25088
  v_mfma_f32_16x16x32_bf16 v[108:111], v[164:167], a[172:175], v[108:111]
  v_rcp_f32 v26, v26
  v_mfma_f32_16x16x32_bf16 v[108:111], v[160:163], a[156:159], v[108:111]
  s_waitcnt lgkmcnt(6)
  v_rcp_f32 v27, v27
  v_mul_f32 v128, v128, v24
  v_mfma_f32_16x16x32_bf16 v[112:115], v[172:175], a[144:147], v[112:115]
  ds_read_b64_tr_b16 v[160:161], v11 offset:57344
  ds_read_b64_tr_b16 v[162:163], v11 offset:57856
  v_mfma_f32_16x16x32_bf16 v[112:115], v[176:179], a[160:163], v[112:115]
  v_mul_f32 v129, v129, v25
  v_mul_f32 v130, v130, v26
  v_mfma_f32_16x16x32_bf16 v[112:115], v[180:183], a[176:179], v[112:115]
  s_add_u32 m0, s82, 135168
  v_mul_f32 v131, v131, v27
  v_mul_f32 v28, s96, v132
  v_mfma_f32_16x16x32_bf16 v[116:119], v[180:183], a[180:183], v[116:119]
  buffer_load_dwordx4 v5, s[16:19], s60 offen lds
  v_mfma_f32_16x16x32_bf16 v[116:119], v[176:179], a[164:167], v[116:119]
  ds_read_b64_tr_b16 v[164:165], v11 offset:28672
  ds_read_b64_tr_b16 v[166:167], v11 offset:29184
  v_mul_f32 v29, s96, v133
  v_mfma_f32_16x16x32_bf16 v[116:119], v[172:175], a[148:151], v[116:119]
  buffer_store_dwordx4 v[68:71], v19, s[24:27], s47 offen offset:1024 sc1
  v_mfma_f32_16x16x32_bf16 v[120:123], v[172:175], a[152:155], v[120:123]
  v_mul_f32 v30, s96, v134
  v_mul_f32 v31, s96, v135
  v_mfma_f32_16x16x32_bf16 v[120:123], v[176:179], a[168:171], v[120:123]
  s_add_u32 m0, s82, 131072
  ds_read_b64_tr_b16 v[168:169], v11 offset:24576
  ds_read_b64_tr_b16 v[170:171], v11 offset:25088
  v_mfma_f32_16x16x32_bf16 v[120:123], v[180:183], a[184:187], v[120:123]
  buffer_load_dwordx4 v5, s[16:19], s62 offen lds
  v_mfma_f32_16x16x32_bf16 v[124:127], v[180:183], a[188:191], v[124:127]
  v_exp_f32 v28, v28
  v_mfma_f32_16x16x32_bf16 v[124:127], v[176:179], a[172:175], v[124:127]
  v_exp_f32 v29, v29
  v_mfma_f32_16x16x32_bf16 v[124:127], v[172:175], a[156:159], v[124:127]
  s_waitcnt lgkmcnt(6)
  v_exp_f32 v30, v30
  v_mfma_f32_16x16x32_bf16 v[96:99], v[184:187], a[192:195], v[96:99]
  ds_read_b64_tr_b16 v[172:173], v8 offset:20480
  ds_read_b64_tr_b16 v[174:175], v8 offset:20992
  v_mfma_f32_16x16x32_bf16 v[96:99], v[188:191], a[208:211], v[96:99]
  v_exp_f32 v31, v31
  v_add_f32 v28, 1.0, v28
  v_mfma_f32_16x16x32_bf16 v[96:99], v[192:195], a[224:227], v[96:99]
  s_add_u32 m0, s82, 77824
  v_add_f32 v29, 1.0, v29
  v_add_f32 v30, 1.0, v30
  v_mfma_f32_16x16x32_bf16 v[100:103], v[192:195], a[228:231], v[100:103]
  buffer_load_dwordx4 v5, s[16:19], s64 offen lds
  v_mfma_f32_16x16x32_bf16 v[100:103], v[188:191], a[212:215], v[100:103]
  ds_read_b64_tr_b16 v[176:177], v8 offset:16384
  ds_read_b64_tr_b16 v[178:179], v8 offset:16896
  v_mfma_f32_16x16x32_bf16 v[100:103], v[184:187], a[196:199], v[100:103]
  v_add_f32 v31, 1.0, v31
  v_mfma_f32_16x16x32_bf16 v[104:107], v[184:187], a[200:203], v[104:107]
  v_rcp_f32 v28, v28
  v_mfma_f32_16x16x32_bf16 v[104:107], v[188:191], a[216:219], v[104:107]
  s_add_u32 m0, s82, 73728
  ds_read_b64_tr_b16 v[180:181], v7 offset:53248
  ds_read_b64_tr_b16 v[182:183], v7 offset:53760
  v_mfma_f32_16x16x32_bf16 v[104:107], v[192:195], a[232:235], v[104:107]
  buffer_load_dwordx4 v221, s[20:23], s66 offen lds
  v_mfma_f32_16x16x32_bf16 v[108:111], v[192:195], a[236:239], v[108:111]
  v_rcp_f32 v29, v29
  v_mfma_f32_16x16x32_bf16 v[108:111], v[188:191], a[220:223], v[108:111]
  v_rcp_f32 v30, v30
  v_mfma_f32_16x16x32_bf16 v[108:111], v[184:187], a[204:207], v[108:111]
  s_waitcnt lgkmcnt(6)
  v_rcp_f32 v31, v31
  v_mul_f32 v132, v132, v28
  v_mfma_f32_16x16x32_bf16 v[112:115], v[160:163], a[192:195], v[112:115]
  ds_read_b64_tr_b16 v[184:185], v11 offset:20480
  ds_read_b64_tr_b16 v[186:187], v11 offset:20992
  v_mfma_f32_16x16x32_bf16 v[112:115], v[164:167], a[208:211], v[112:115]
  buffer_store_dwordx4 v[72:75], v19, s[24:27], s47 offen offset:2048 sc1
  v_mfma_f32_16x16x32_bf16 v[112:115], v[168:171], a[224:227], v[112:115]
  v_mul_f32 v133, v133, v29
  v_mul_f32 v134, v134, v30
  v_mul_f32 v135, v135, v31
  v_mfma_f32_16x16x32_bf16 v[116:119], v[168:171], a[228:231], v[116:119]
  v_mul_f32 v24, s96, v136
  v_mul_f32 v25, s96, v137
  v_mfma_f32_16x16x32_bf16 v[116:119], v[164:167], a[212:215], v[116:119]
  ds_read_b64_tr_b16 v[188:189], v11 offset:16384
  ds_read_b64_tr_b16 v[190:191], v11 offset:16896
  v_mul_f32 v26, s96, v138
  v_mul_f32 v27, s96, v139
  v_mfma_f32_16x16x32_bf16 v[116:119], v[160:163], a[196:199], v[116:119]
  v_exp_f32 v24, v24
  v_mfma_f32_16x16x32_bf16 v[120:123], v[160:163], a[200:203], v[120:123]
  v_exp_f32 v25, v25
  v_mfma_f32_16x16x32_bf16 v[120:123], v[164:167], a[216:219], v[120:123]
  v_exp_f32 v26, v26
  v_mfma_f32_16x16x32_bf16 v[120:123], v[168:171], a[232:235], v[120:123]
  ds_read_b64_tr_b16 v[192:193], v10 offset:53248
  ds_read_b64_tr_b16 v[194:195], v10 offset:53760
  buffer_store_dwordx4 v[76:79], v19, s[24:27], s47 offen offset:3072 sc1
  v_mfma_f32_16x16x32_bf16 v[124:127], v[168:171], a[236:239], v[124:127]
  v_exp_f32 v27, v27
  v_mfma_f32_16x16x32_bf16 v[124:127], v[164:167], a[220:223], v[124:127]
  v_add_f32 v24, 1.0, v24
  v_add_f32 v25, 1.0, v25
  v_mfma_f32_16x16x32_bf16 v[124:127], v[160:163], a[204:207], v[124:127]
  s_waitcnt vmcnt(20) lgkmcnt(6)
  v_add_f32 v26, 1.0, v26
  v_add_f32 v27, 1.0, v27
  v_mfma_f32_16x16x32_bf16 v[96:99], v[172:175], a[240:243], v[96:99]
  s_barrier
  v_mfma_f32_16x16x32_bf16 v[96:99], v[176:179], v[224:227], v[96:99]
  ds_read_b64_tr_b16 v[160:161], v13 offset:49152
  ds_read_b64_tr_b16 v[162:163], v13 offset:49408
  v_mfma_f32_16x16x32_bf16 v[96:99], v[180:183], v[240:243], v[96:99]
  v_rcp_f32 v24, v24
  v_mfma_f32_16x16x32_bf16 v[100:103], v[180:183], v[244:247], v[100:103]
  s_add_u32 m0, s82, 126976
  v_rcp_f32 v25, v25
  v_mfma_f32_16x16x32_bf16 v[100:103], v[176:179], v[228:231], v[100:103]
  buffer_load_dwordx4 v221, s[20:23], s67 offen lds
  v_mfma_f32_16x16x32_bf16 v[100:103], v[172:175], a[244:247], v[100:103]
  ds_read_b64_tr_b16 v[164:165], v13 offset:51200
  ds_read_b64_tr_b16 v[166:167], v13 offset:51456
  v_mfma_f32_16x16x32_bf16 v[104:107], v[172:175], a[248:251], v[104:107]
  v_rcp_f32 v26, v26
  v_mfma_f32_16x16x32_bf16 v[104:107], v[176:179], v[232:235], v[104:107]
  s_add_u32 m0, s82, 122880
  v_rcp_f32 v27, v27
  v_mul_f32 v136, v136, v24
  v_mfma_f32_16x16x32_bf16 v[104:107], v[180:183], v[248:251], v[104:107]
  buffer_load_dwordx4 v221, s[20:23], s68 offen lds
  v_mfma_f32_16x16x32_bf16 v[108:111], v[180:183], v[252:255], v[108:111]
  ds_read_b64_tr_b16 v[168:169], v15 offset:28672
  ds_read_b64_tr_b16 v[170:171], v15 offset:28928
  v_mul_f32 v137, v137, v25
  v_mfma_f32_16x16x32_bf16 v[108:111], v[176:179], v[236:239], v[108:111]
  v_mul_f32 v138, v138, v26
  v_mul_f32 v139, v139, v27
  v_mfma_f32_16x16x32_bf16 v[108:111], v[172:175], a[252:255], v[108:111]
  s_waitcnt lgkmcnt(6)
  v_mul_f32 v28, s96, v140
  v_mul_f32 v29, s96, v141
  v_mfma_f32_16x16x32_bf16 v[112:115], v[184:187], a[240:243], v[112:115]
  ds_read_b64_tr_b16 v[172:173], v15 offset:30720
  ds_read_b64_tr_b16 v[174:175], v15 offset:30976
  v_mfma_f32_16x16x32_bf16 v[112:115], v[188:191], v[224:227], v[112:115]
  v_mul_f32 v30, s96, v142
  v_mul_f32 v31, s96, v143
  v_mfma_f32_16x16x32_bf16 v[112:115], v[192:195], v[240:243], v[112:115]
  s_add_u32 m0, s82, 94208
  v_exp_f32 v28, v28
  v_mfma_f32_16x16x32_bf16 v[116:119], v[192:195], v[244:247], v[116:119]
  buffer_load_dwordx4 v6, s[20:23], s66 offen lds
  v_mfma_f32_16x16x32_bf16 v[116:119], v[188:191], v[228:231], v[116:119]
  ds_read_b64_tr_b16 v[176:177], v15 offset:24576
  ds_read_b64_tr_b16 v[178:179], v15 offset:24832
  v_exp_f32 v29, v29
  v_mfma_f32_16x16x32_bf16 v[116:119], v[184:187], a[244:247], v[116:119]
  v_exp_f32 v30, v30
  v_mfma_f32_16x16x32_bf16 v[120:123], v[184:187], a[248:251], v[120:123]
  s_lshr_b32 s75, s80, 1
  v_exp_f32 v31, v31
  v_add_f32 v28, 1.0, v28
  v_mfma_f32_16x16x32_bf16 v[120:123], v[188:191], v[232:235], v[120:123]
  s_add_u32 m0, s82, 90112
  ds_read_b64_tr_b16 v[180:181], v15 offset:26624
  ds_read_b64_tr_b16 v[182:183], v15 offset:26880
  v_mfma_f32_16x16x32_bf16 v[120:123], v[192:195], v[248:251], v[120:123]
  buffer_load_dwordx4 v6, s[20:23], s67 offen lds
  v_mfma_f32_16x16x32_bf16 v[124:127], v[192:195], v[252:255], v[124:127]
  s_lshl_b32 s75, s75, 7
  v_add_f32 v29, 1.0, v29
  v_add_f32 v30, 1.0, v30
  v_add_f32 v31, 1.0, v31
  v_mfma_f32_16x16x32_bf16 v[124:127], v[188:191], v[236:239], v[124:127]
  s_add_u32 s75, s75, 6423680
  v_rcp_f32 v28, v28
  v_mfma_f32_16x16x32_bf16 v[124:127], v[184:187], a[252:255], v[124:127]
  s_waitcnt vmcnt(21) lgkmcnt(6)
  v_rcp_f32 v29, v29
  v_rcp_f32 v30, v30
  v_mfma_f32_16x16x32_bf16 v[32:35], v[160:163], a[0:3], 0
  s_barrier
  v_mfma_f32_16x16x32_bf16 v[32:35], v[164:167], a[16:19], v[32:35]
  s_mov_b32 s76, 6424704
  ds_read_b64_tr_b16 v[184:185], v14 offset:53248
  ds_read_b64_tr_b16 v[186:187], v14 offset:53504
  v_mfma_f32_16x16x32_bf16 v[32:35], v[168:171], a[32:35], v[32:35]
  buffer_load_dword v218, v222, s[24:27], s75 offen sc1
  v_mfma_f32_16x16x32_bf16 v[36:39], v[168:171], a[36:39], 0
  s_add_u32 m0, s82, 86016
  v_rcp_f32 v31, v31
  v_mul_f32 v140, v140, v28
  v_mul_f32 v141, v141, v29
  v_mfma_f32_16x16x32_bf16 v[36:39], v[164:167], a[20:23], v[36:39]
  buffer_load_dwordx4 v6, s[20:23], s68 offen lds
  v_mfma_f32_16x16x32_bf16 v[36:39], v[160:163], a[4:7], v[36:39]
  ds_read_b64_tr_b16 v[188:189], v14 offset:55296
  ds_read_b64_tr_b16 v[190:191], v14 offset:55552
  v_mul_f32 v142, v142, v30
  v_mfma_f32_16x16x32_bf16 v[40:43], v[160:163], a[8:11], 0
  buffer_load_dword v219, v222, s[24:27], s76 offen sc1
  v_mfma_f32_16x16x32_bf16 v[40:43], v[164:167], a[24:27], v[40:43]
  s_add_u32 m0, s82, 81920
  v_mul_f32 v143, v143, v31
  v_mul_f32 v24, s96, v144
  v_mul_f32 v25, s96, v145
  v_mfma_f32_16x16x32_bf16 v[40:43], v[168:171], a[40:43], v[40:43]
  buffer_load_dwordx4 v221, s[20:23], s69 offen lds
  v_mfma_f32_16x16x32_bf16 v[44:47], v[168:171], a[44:47], 0
  s_cmp_lt_u32 s80, 2
  s_cselect_b32 s77, 33, 32
  ds_read_b64_tr_b16 v[192:193], v14 offset:49152
  ds_read_b64_tr_b16 v[194:195], v14 offset:49408
  v_mfma_f32_16x16x32_bf16 v[44:47], v[164:167], a[28:31], v[44:47]
  s_cmp_lt_u32 s95, 16
  s_cselect_b32 s78, 0, 32
  v_mul_f32 v26, s96, v146
  v_mul_f32 v27, s96, v147
  v_mfma_f32_16x16x32_bf16 v[44:47], v[160:163], a[12:15], v[44:47]
  s_waitcnt lgkmcnt(6)
  v_exp_f32 v24, v24
  v_mfma_f32_16x16x32_bf16 v[32:35], v[172:175], a[48:51], v[32:35]
  ds_read_b64_tr_b16 v[160:161], v14 offset:51200
  ds_read_b64_tr_b16 v[162:163], v14 offset:51456
  v_mfma_f32_16x16x32_bf16 v[32:35], v[176:179], a[64:67], v[32:35]
  s_cmp_eq_u32 s81, 0
  s_cselect_b32 s77, s77, 0
  s_cselect_b32 s78, s78, 0
  v_exp_f32 v25, v25
  v_mfma_f32_16x16x32_bf16 v[32:35], v[180:183], a[80:83], v[32:35]
  v_exp_f32 v26, v26
  v_mfma_f32_16x16x32_bf16 v[36:39], v[180:183], a[84:87], v[36:39]
  v_exp_f32 v27, v27
  v_add_f32 v24, 1.0, v24
  v_mfma_f32_16x16x32_bf16 v[36:39], v[176:179], a[68:71], v[36:39]
  ds_read_b64_tr_b16 v[164:165], v14 offset:4096
  ds_read_b64_tr_b16 v[166:167], v14 offset:4352
  v_add_f32 v25, 1.0, v25
  v_mfma_f32_16x16x32_bf16 v[36:39], v[172:175], a[52:55], v[36:39]
  v_add_f32 v26, 1.0, v26
  v_add_f32 v27, 1.0, v27
  v_mfma_f32_16x16x32_bf16 v[40:43], v[172:175], a[56:59], v[40:43]
  v_rcp_f32 v24, v24
  v_mfma_f32_16x16x32_bf16 v[40:43], v[176:179], a[72:75], v[40:43]
  v_rcp_f32 v25, v25
  v_rcp_f32 v26, v26
  v_mfma_f32_16x16x32_bf16 v[40:43], v[180:183], a[88:91], v[40:43]
  ds_read_b64_tr_b16 v[168:169], v14 offset:6144
  ds_read_b64_tr_b16 v[170:171], v14 offset:6400
  v_mfma_f32_16x16x32_bf16 v[44:47], v[180:183], a[92:95], v[44:47]
  v_rcp_f32 v27, v27
  v_mul_f32 v144, v144, v24
  v_mfma_f32_16x16x32_bf16 v[44:47], v[176:179], a[76:79], v[44:47]
  v_mul_f32 v145, v145, v25
  v_mul_f32 v146, v146, v26
  v_mul_f32 v147, v147, v27
  v_mfma_f32_16x16x32_bf16 v[44:47], v[172:175], a[60:63], v[44:47]
  s_waitcnt vmcnt(8) lgkmcnt(6)
  v_mul_f32 v28, s96, v148
  v_mul_f32 v29, s96, v149
  v_mfma_f32_16x16x32_bf16 v[32:35], v[184:187], a[96:99], v[32:35]
  s_barrier
  v_mfma_f32_16x16x32_bf16 v[32:35], v[188:191], a[112:115], v[32:35]
  ds_read_b64_tr_b16 v[172:173], v14 offset:0
  ds_read_b64_tr_b16 v[174:175], v14 offset:256
  v_mul_f32 v30, s96, v150
  v_mul_f32 v31, s96, v151
  v_mfma_f32_16x16x32_bf16 v[32:35], v[192:195], a[128:131], v[32:35]
  buffer_atomic_add v3, v222, s[24:27], s83 offen sc1
  v_mfma_f32_16x16x32_bf16 v[36:39], v[192:195], a[132:135], v[36:39]
  s_add_u32 m0, s82, 159744
  v_exp_f32 v28, v28
  v_mfma_f32_16x16x32_bf16 v[36:39], v[188:191], a[116:119], v[36:39]
  buffer_load_dwordx4 v221, s[20:23], s70 offen lds
  v_mfma_f32_16x16x32_bf16 v[36:39], v[184:187], a[100:103], v[36:39]
  ds_read_b64_tr_b16 v[176:177], v14 offset:2048
  ds_read_b64_tr_b16 v[178:179], v14 offset:2304
  v_exp_f32 v29, v29
  v_mfma_f32_16x16x32_bf16 v[40:43], v[184:187], a[104:107], v[40:43]
  v_exp_f32 v30, v30
  v_mfma_f32_16x16x32_bf16 v[40:43], v[188:191], a[120:123], v[40:43]
  s_add_u32 m0, s82, 155648
  v_exp_f32 v31, v31
  v_add_f32 v28, 1.0, v28
  v_mfma_f32_16x16x32_bf16 v[40:43], v[192:195], a[136:139], v[40:43]
  buffer_load_dwordx4 v221, s[20:23], s71 offen lds
  v_mfma_f32_16x16x32_bf16 v[44:47], v[192:195], a[140:143], v[44:47]
  ds_read_b64_tr_b16 v[180:181], v15 offset:20480
  ds_read_b64_tr_b16 v[182:183], v15 offset:20736
  v_add_f32 v29, 1.0, v29
  v_mfma_f32_16x16x32_bf16 v[44:47], v[188:191], a[124:127], v[44:47]
  v_add_f32 v30, 1.0, v30
  v_add_f32 v31, 1.0, v31
  v_mfma_f32_16x16x32_bf16 v[44:47], v[184:187], a[108:111], v[44:47]
  s_waitcnt lgkmcnt(6)
  v_rcp_f32 v28, v28
  v_rcp_f32 v29, v29
  v_mfma_f32_16x16x32_bf16 v[32:35], v[160:163], a[144:147], v[32:35]
  ds_read_b64_tr_b16 v[184:185], v15 offset:22528
  ds_read_b64_tr_b16 v[186:187], v15 offset:22784
  v_mfma_f32_16x16x32_bf16 v[32:35], v[164:167], a[160:163], v[32:35]
  v_rcp_f32 v30, v30
  v_mfma_f32_16x16x32_bf16 v[32:35], v[168:171], a[176:179], v[32:35]
  v_rcp_f32 v31, v31
  v_mul_f32 v148, v148, v28
  v_mul_f32 v149, v149, v29
  v_mfma_f32_16x16x32_bf16 v[36:39], v[168:171], a[180:183], v[36:39]
  ds_read_b64_tr_b16 v[188:189], v15 offset:16384
  ds_read_b64_tr_b16 v[190:191], v15 offset:16640
  v_mfma_f32_16x16x32_bf16 v[36:39], v[164:167], a[164:167], v[36:39]
  v_mul_f32 v150, v150, v30
  v_mul_f32 v151, v151, v31
  v_mul_f32 v24, s96, v152
  v_mfma_f32_16x16x32_bf16 v[36:39], v[160:163], a[148:151], v[36:39]
  s_add_u32 m0, s82, 118784
  v_mul_f32 v25, s96, v153
  v_mul_f32 v26, s96, v154
  v_mul_f32 v27, s96, v155
  v_mfma_f32_16x16x32_bf16 v[40:43], v[160:163], a[152:155], v[40:43]
  buffer_load_dwordx4 v6, s[20:23], s69 offen lds
  v_mfma_f32_16x16x32_bf16 v[40:43], v[164:167], a[168:171], v[40:43]
  v_exp_f32 v24, v24
  v_mfma_f32_16x16x32_bf16 v[40:43], v[168:171], a[184:187], v[40:43]
  ds_read_b64_tr_b16 v[192:193], v15 offset:18432
  ds_read_b64_tr_b16 v[194:195], v15 offset:18688
  v_exp_f32 v25, v25
  v_mfma_f32_16x16x32_bf16 v[44:47], v[168:171], a[188:191], v[44:47]
  v_exp_f32 v26, v26
  v_mfma_f32_16x16x32_bf16 v[44:47], v[164:167], a[172:175], v[44:47]
  v_exp_f32 v27, v27
  v_add_f32 v24, 1.0, v24
  v_mfma_f32_16x16x32_bf16 v[44:47], v[160:163], a[156:159], v[44:47]
  s_waitcnt lgkmcnt(6)
  v_add_f32 v25, 1.0, v25
  v_add_f32 v26, 1.0, v26
  v_add_f32 v27, 1.0, v27
  v_mfma_f32_16x16x32_bf16 v[32:35], v[172:175], a[192:195], v[32:35]
  s_barrier
  v_mfma_f32_16x16x32_bf16 v[32:35], v[176:179], a[208:211], v[32:35]
  ds_read_b64_tr_b16 v[160:161], v14 offset:45056
  ds_read_b64_tr_b16 v[162:163], v14 offset:45312
  v_mfma_f32_16x16x32_bf16 v[32:35], v[180:183], a[224:227], v[32:35]
  v_rcp_f32 v24, v24
  v_rcp_f32 v25, v25
  v_mfma_f32_16x16x32_bf16 v[36:39], v[180:183], a[228:231], v[36:39]
  v_rcp_f32 v26, v26
  v_mfma_f32_16x16x32_bf16 v[36:39], v[176:179], a[212:215], v[36:39]
  ds_read_b64_tr_b16 v[164:165], v14 offset:47104
  ds_read_b64_tr_b16 v[166:167], v14 offset:47360
  v_mfma_f32_16x16x32_bf16 v[36:39], v[172:175], a[196:199], v[36:39]
  s_add_u32 m0, s82, 114688
  v_rcp_f32 v27, v27
  v_mul_f32 v152, v152, v24
  v_mul_f32 v153, v153, v25
  v_mfma_f32_16x16x32_bf16 v[40:43], v[172:175], a[200:203], v[40:43]
  buffer_load_dwordx4 v6, s[20:23], s70 offen lds
  v_mfma_f32_16x16x32_bf16 v[40:43], v[176:179], a[216:219], v[40:43]
  v_mul_f32 v154, v154, v26
  v_mul_f32 v155, v155, v27
  v_mul_f32 v28, s96, v156
  v_mfma_f32_16x16x32_bf16 v[40:43], v[180:183], a[232:235], v[40:43]
  ds_read_b64_tr_b16 v[168:169], v14 offset:40960
  ds_read_b64_tr_b16 v[170:171], v14 offset:41216
  v_mul_f32 v29, s96, v157
  v_mfma_f32_16x16x32_bf16 v[44:47], v[180:183], a[236:239], v[44:47]
  v_mul_f32 v30, s96, v158
  v_mul_f32 v31, s96, v159
  v_mfma_f32_16x16x32_bf16 v[44:47], v[176:179], a[220:223], v[44:47]
  v_exp_f32 v28, v28
  v_mfma_f32_16x16x32_bf16 v[44:47], v[172:175], a[204:207], v[44:47]
  s_waitcnt lgkmcnt(6)
  v_exp_f32 v29, v29
  v_exp_f32 v30, v30
  v_mfma_f32_16x16x32_bf16 v[32:35], v[184:187], a[240:243], v[32:35]
  ds_read_b64_tr_b16 v[172:173], v14 offset:43008
  ds_read_b64_tr_b16 v[174:175], v14 offset:43264
  v_mfma_f32_16x16x32_bf16 v[32:35], v[188:191], v[224:227], v[32:35]
  v_exp_f32 v31, v31
  v_add_f32 v28, 1.0, v28
  v_mfma_f32_16x16x32_bf16 v[32:35], v[192:195], v[240:243], v[32:35]
  v_add_f32 v29, 1.0, v29
  v_add_f32 v30, 1.0, v30
  v_add_f32 v31, 1.0, v31
  v_mfma_f32_16x16x32_bf16 v[36:39], v[192:195], v[244:247], v[36:39]
  v_rcp_f32 v28, v28
  v_mfma_f32_16x16x32_bf16 v[36:39], v[188:191], v[228:231], v[36:39]
  ds_read_b64_tr_b16 v[176:177], v14 offset:36864
  ds_read_b64_tr_b16 v[178:179], v14 offset:37120
  v_mfma_f32_16x16x32_bf16 v[36:39], v[184:187], a[244:247], v[36:39]
  v_rcp_f32 v29, v29
  v_rcp_f32 v30, v30
  v_mfma_f32_16x16x32_bf16 v[40:43], v[184:187], a[248:251], v[40:43]
  v_rcp_f32 v31, v31
  v_mfma_f32_16x16x32_bf16 v[40:43], v[188:191], v[232:235], v[40:43]
  v_mul_f32 v156, v156, v28
  v_mul_f32 v157, v157, v29
  v_mul_f32 v158, v158, v30
  v_mfma_f32_16x16x32_bf16 v[40:43], v[192:195], v[248:251], v[40:43]
  ds_read_b64_tr_b16 v[180:181], v14 offset:38912
  ds_read_b64_tr_b16 v[182:183], v14 offset:39168
  v_mul_f32 v159, v159, v31
  v_mfma_f32_16x16x32_bf16 v[44:47], v[192:195], v[252:255], v[44:47]
  v_mul_f32 v96, v96, v128
  v_mul_f32 v97, v97, v129
  v_mfma_f32_16x16x32_bf16 v[44:47], v[188:191], v[236:239], v[44:47]
  v_mul_f32 v98, v98, v130
  v_mul_f32 v99, v99, v131
  v_mul_f32 v112, v112, v144
  v_mfma_f32_16x16x32_bf16 v[44:47], v[184:187], a[252:255], v[44:47]
  s_waitcnt lgkmcnt(6)
  v_mul_f32 v113, v113, v145
  v_mul_f32 v114, v114, v146
  v_mul_f32 v115, v115, v147
  v_mfma_f32_16x16x32_bf16 v[48:51], v[160:163], a[0:3], 0
  s_barrier
  v_mfma_f32_16x16x32_bf16 v[48:51], v[164:167], a[16:19], v[48:51]
  ds_read_b64_tr_b16 v[184:185], v14 offset:32768
  ds_read_b64_tr_b16 v[186:187], v14 offset:33024
  v_cvt_pk_bf16_f32 v128, v96, v97
  v_mfma_f32_16x16x32_bf16 v[48:51], v[168:171], a[32:35], v[48:51]
  v_cvt_pk_bf16_f32 v129, v98, v99
  v_cvt_pk_bf16_f32 v130, v112, v113
  v_cvt_pk_bf16_f32 v131, v114, v115
  v_mfma_f32_16x16x32_bf16 v[52:55], v[168:171], a[36:39], 0
  s_add_u32 m0, s82, 151552
  v_mul_f32 v24, s96, v32
  v_mul_f32 v25, s96, v33
  v_mfma_f32_16x16x32_bf16 v[52:55], v[164:167], a[20:23], v[52:55]
  buffer_load_dwordx4 v6, s[20:23], s71 offen lds
  v_mfma_f32_16x16x32_bf16 v[52:55], v[160:163], a[4:7], v[52:55]
  ds_read_b64_tr_b16 v[188:189], v14 offset:34816
  ds_read_b64_tr_b16 v[190:191], v14 offset:35072
  v_mul_f32 v26, s96, v34
  v_mul_f32 v27, s96, v35
  v_mfma_f32_16x16x32_bf16 v[56:59], v[160:163], a[8:11], 0
  ds_write_b128 v19, v[128:131] offset:49152
  v_mfma_f32_16x16x32_bf16 v[56:59], v[164:167], a[24:27], v[56:59]
  s_add_u32 m0, s82, 147456
  v_mul_f32 v100, v100, v132
  v_mul_f32 v101, v101, v133
  v_mul_f32 v102, v102, v134
  v_mfma_f32_16x16x32_bf16 v[56:59], v[168:171], a[40:43], v[56:59]
  buffer_load_dwordx4 v221, s[20:23], s72 offen lds
  v_mfma_f32_16x16x32_bf16 v[60:63], v[168:171], a[44:47], 0
  ds_read_b64_tr_b16 v[192:193], v15 offset:12288
  ds_read_b64_tr_b16 v[194:195], v15 offset:12544
  v_mul_f32 v103, v103, v135
  v_mfma_f32_16x16x32_bf16 v[60:63], v[164:167], a[28:31], v[60:63]
  v_mul_f32 v116, v116, v148
  v_mul_f32 v117, v117, v149
  v_mul_f32 v118, v118, v150
  v_mfma_f32_16x16x32_bf16 v[60:63], v[160:163], a[12:15], v[60:63]
  s_waitcnt lgkmcnt(7)
  v_mul_f32 v119, v119, v151
  v_cvt_pk_bf16_f32 v132, v100, v101
  v_cvt_pk_bf16_f32 v133, v102, v103
  v_mfma_f32_16x16x32_bf16 v[48:51], v[172:175], a[48:51], v[48:51]
  ds_read_b64_tr_b16 v[160:161], v15 offset:14336
  ds_read_b64_tr_b16 v[162:163], v15 offset:14592
  v_mfma_f32_16x16x32_bf16 v[48:51], v[176:179], a[64:67], v[48:51]
  v_cvt_pk_bf16_f32 v134, v116, v117
  v_cvt_pk_bf16_f32 v135, v118, v119
  v_mfma_f32_16x16x32_bf16 v[48:51], v[180:183], a[80:83], v[48:51]
  ds_write_b128 v19, v[132:135] offset:50176
  v_mfma_f32_16x16x32_bf16 v[52:55], v[180:183], a[84:87], v[52:55]
  ds_read_b64_tr_b16 v[164:165], v15 offset:8192
  ds_read_b64_tr_b16 v[166:167], v15 offset:8448
  v_mul_f32 v104, v104, v136
  v_mul_f32 v105, v105, v137
  v_mfma_f32_16x16x32_bf16 v[52:55], v[176:179], a[68:71], v[52:55]
  v_mul_f32 v106, v106, v138
  v_mul_f32 v107, v107, v139
  v_mfma_f32_16x16x32_bf16 v[52:55], v[172:175], a[52:55], v[52:55]
  s_add_u32 m0, s82, 110592
  v_mul_f32 v120, v120, v152
  v_mul_f32 v121, v121, v153
  v_mul_f32 v122, v122, v154
  v_mfma_f32_16x16x32_bf16 v[56:59], v[172:175], a[56:59], v[56:59]
  buffer_load_dwordx4 v221, s[20:23], s73 offen lds
  v_mfma_f32_16x16x32_bf16 v[56:59], v[176:179], a[72:75], v[56:59]
  v_mul_f32 v123, v123, v155
  v_cvt_pk_bf16_f32 v136, v104, v105
  v_cvt_pk_bf16_f32 v137, v106, v107
  v_mfma_f32_16x16x32_bf16 v[56:59], v[180:183], a[88:91], v[56:59]
  ds_read_b64_tr_b16 v[168:169], v15 offset:10240
  ds_read_b64_tr_b16 v[170:171], v15 offset:10496
  v_cvt_pk_bf16_f32 v138, v120, v121
  v_mfma_f32_16x16x32_bf16 v[60:63], v[180:183], a[92:95], v[60:63]
  v_cvt_pk_bf16_f32 v139, v122, v123
  v_exp_f32 v24, v24
  v_mfma_f32_16x16x32_bf16 v[60:63], v[176:179], a[76:79], v[60:63]
  ds_write_b128 v19, v[136:139] offset:51200
  v_mfma_f32_16x16x32_bf16 v[60:63], v[172:175], a[60:63], v[60:63]
  v_mul_f32 v108, v108, v140
  v_mul_f32 v109, v109, v141
  v_mul_f32 v110, v110, v142
  s_waitcnt vmcnt(11)
  v_readfirstlane_b32 s91, v218
  s_nop 1
  s_cmp_ge_u32 s91, s77
  s_cbranch_scc0 L_sp2a_gated_mix__spectral_gfnet__swiglu_ffn__prompt_kernel
L_bk2a_gated_mix__spectral_gfnet__swiglu_ffn__prompt_kernel:
  s_waitcnt vmcnt(9)
  v_readfirstlane_b32 s91, v219
  s_nop 1
  s_cmp_ge_u32 s91, s78
  s_cbranch_scc0 L_sp2b_gated_mix__spectral_gfnet__swiglu_ffn__prompt_kernel
L_bk2b_gated_mix__spectral_gfnet__swiglu_ffn__prompt_kernel:
  s_waitcnt lgkmcnt(8)
  v_mfma_f32_16x16x32_bf16 v[48:51], v[184:187], a[96:99], v[48:51]
  s_barrier
  v_mfma_f32_16x16x32_bf16 v[48:51], v[188:191], a[112:115], v[48:51]
  s_lshl_b32 s38, s89, 12
  ds_read_b64_tr_b16 v[172:173], v15 offset:4096
  ds_read_b64_tr_b16 v[174:175], v15 offset:4352
  ds_read_b128 a[0:3], v21 offset:0
  v_mfma_f32_16x16x32_bf16 v[48:51], v[192:195], a[128:131], v[48:51]
  s_add_u32 s38, s38, 3145728
  ds_read_b128 a[4:7], v21 offset:1024
  v_mul_f32 v111, v111, v143
  v_mul_f32 v124, v124, v156
  v_mfma_f32_16x16x32_bf16 v[52:55], v[192:195], a[132:135], v[52:55]
  s_add_u32 m0, s82, 106496
  ds_read_b128 a[8:11], v21 offset:2048
  v_mul_f32 v125, v125, v157
  v_mul_f32 v126, v126, v158
  v_mfma_f32_16x16x32_bf16 v[52:55], v[188:191], a[116:119], v[52:55]
  buffer_load_dwordx4 v221, s[20:23], s74 offen lds
  v_mfma_f32_16x16x32_bf16 v[52:55], v[184:187], a[100:103], v[52:55]
  s_lshl_b32 s39, s80, 17
  ds_read_b64_tr_b16 v[176:177], v15 offset:6144
  ds_read_b64_tr_b16 v[178:179], v15 offset:6400
  ds_read_b128 a[12:15], v21 offset:3072
  v_mfma_f32_16x16x32_bf16 v[56:59], v[184:187], a[104:107], v[56:59]
  s_add_u32 s39, s39, s38
  ds_read_b128 a[16:19], v21 offset:4096
  v_mul_f32 v127, v127, v159
  v_cvt_pk_bf16_f32 v140, v108, v109
  v_mfma_f32_16x16x32_bf16 v[56:59], v[188:191], a[120:123], v[56:59]
  s_add_u32 m0, s82, 102400
  ds_read_b128 a[20:23], v21 offset:5120
  v_cvt_pk_bf16_f32 v141, v110, v111
  v_cvt_pk_bf16_f32 v142, v124, v125
  v_mfma_f32_16x16x32_bf16 v[56:59], v[192:195], a[136:139], v[56:59]
  buffer_load_dwordx4 v6, s[20:23], s72 offen lds
  v_mfma_f32_16x16x32_bf16 v[60:63], v[192:195], a[140:143], v[60:63]
  ds_read_b64_tr_b16 v[180:181], v15 offset:0
  ds_read_b64_tr_b16 v[182:183], v15 offset:256
  v_cvt_pk_bf16_f32 v143, v126, v127
  v_mfma_f32_16x16x32_bf16 v[60:63], v[188:191], a[124:127], v[60:63]
  buffer_load_dword v220, v222, s[24:27], s101 offen sc1
  v_mfma_f32_16x16x32_bf16 v[60:63], v[184:187], a[108:111], v[60:63]
  s_waitcnt lgkmcnt(13)
  v_exp_f32 v25, v25
  v_mfma_f32_16x16x32_bf16 v[48:51], v[160:163], a[144:147], v[48:51]
  s_xor_b32 s6, s80, 1
  ds_read_b64_tr_b16 v[184:185], v15 offset:2048
  ds_read_b64_tr_b16 v[186:187], v15 offset:2304
  ds_read_b128 a[24:27], v21 offset:6144
  v_mfma_f32_16x16x32_bf16 v[48:51], v[164:167], a[160:163], v[48:51]
  s_sub_u32 s7, s6, s80
  ds_read_b128 a[28:31], v21 offset:7168
  v_exp_f32 v26, v26
  v_mfma_f32_16x16x32_bf16 v[48:51], v[168:171], a[176:179], v[48:51]
  s_mul_i32 s7, s7, 73728
  ds_read_b128 a[32:35], v21 offset:8192
  v_exp_f32 v27, v27
  v_mfma_f32_16x16x32_bf16 v[52:55], v[168:171], a[180:183], v[52:55]
  s_add_u32 s7, s7, s46
  ds_read_b64_tr_b16 v[188:189], v14 offset:12288
  ds_read_b64_tr_b16 v[190:191], v14 offset:12544
  ds_read_b128 a[36:39], v21 offset:9216
  v_mfma_f32_16x16x32_bf16 v[52:55], v[164:167], a[164:167], v[52:55]
  ds_read_b128 a[40:43], v21 offset:10240
  v_add_u32 v4, s7, v21
  v_mfma_f32_16x16x32_bf16 v[52:55], v[160:163], a[148:151], v[52:55]
  s_add_u32 m0, s82, 98304
  ds_read_b128 a[44:47], v21 offset:11264
  v_add_f32 v24, 1.0, v24
  v_add_f32 v25, 1.0, v25
  v_mfma_f32_16x16x32_bf16 v[56:59], v[160:163], a[152:155], v[56:59]
  buffer_load_dwordx4 v6, s[20:23], s73 offen lds
  v_mfma_f32_16x16x32_bf16 v[56:59], v[164:167], a[168:171], v[56:59]
  buffer_load_dwordx4 v[196:199], v21, s[24:27], s39 offen offset:0 sc1
  v_mfma_f32_16x16x32_bf16 v[56:59], v[168:171], a[184:187], v[56:59]
  ds_read_b64_tr_b16 v[192:193], v14 offset:14336
  ds_read_b64_tr_b16 v[194:195], v14 offset:14592
  v_add_f32 v26, 1.0, v26
  v_add_f32 v27, 1.0, v27
  v_mfma_f32_16x16x32_bf16 v[60:63], v[168:171], a[188:191], v[60:63]
  buffer_load_dwordx4 v[200:203], v21, s[24:27], s39 offen offset:1024 sc1
  v_mfma_f32_16x16x32_bf16 v[60:63], v[164:167], a[172:175], v[60:63]
  buffer_load_dwordx4 v[204:207], v21, s[24:27], s39 offen offset:2048 sc1
  v_mfma_f32_16x16x32_bf16 v[60:63], v[160:163], a[156:159], v[60:63]
  s_waitcnt lgkmcnt(12)
  v_rcp_f32 v24, v24
  v_rcp_f32 v25, v25
  v_mfma_f32_16x16x32_bf16 v[48:51], v[172:175], a[192:195], v[48:51]
  s_barrier
  v_mfma_f32_16x16x32_bf16 v[48:51], v[176:179], a[208:211], v[48:51]
  ds_read_b64_tr_b16 v[160:161], v17 offset:8192
  ds_read_b64_tr_b16 v[162:163], v17 offset:10240
  ds_read_b128 a[48:51], v21 offset:12288
  v_mfma_f32_16x16x32_bf16 v[48:51], v[180:183], a[224:227], v[48:51]
  ds_read_b128 a[52:55], v21 offset:13312
  v_rcp_f32 v26, v26
  v_mfma_f32_16x16x32_bf16 v[52:55], v[180:183], a[228:231], v[52:55]
  s_add_u32 m0, s82, 143360
  ds_read_b128 a[56:59], v21 offset:14336
  v_mfma_f32_16x16x32_bf16 v[52:55], v[176:179], a[212:215], v[52:55]
  buffer_load_dwordx4 v6, s[20:23], s74 offen lds
  v_mfma_f32_16x16x32_bf16 v[52:55], v[172:175], a[196:199], v[52:55]
  ds_read_b64_tr_b16 v[164:165], v17 offset:61440
  ds_read_b64_tr_b16 v[166:167], v17 offset:63488
  ds_read_b128 a[60:63], v21 offset:15360
  v_mfma_f32_16x16x32_bf16 v[56:59], v[172:175], a[200:203], v[56:59]
  ds_read_b128 a[64:67], v21 offset:16384
  v_rcp_f32 v27, v27
  v_mfma_f32_16x16x32_bf16 v[56:59], v[176:179], a[216:219], v[56:59]
  s_add_u32 m0, s82, 139136
  ds_read_b128 a[68:71], v21 offset:17408
  v_mul_f32 v32, v32, v24
  v_mul_f32 v33, v33, v25
  v_mfma_f32_16x16x32_bf16 v[56:59], v[180:183], a[232:235], v[56:59]
  buffer_load_dwordx4 v6, s[20:23], s66 offen offset:128 lds
  v_mfma_f32_16x16x32_bf16 v[60:63], v[180:183], a[236:239], v[60:63]
  ds_read_b64_tr_b16 v[168:169], v17 offset:57344
  ds_read_b64_tr_b16 v[170:171], v17 offset:59392
  v_mul_f32 v34, v34, v26
  v_mfma_f32_16x16x32_bf16 v[60:63], v[176:179], a[220:223], v[60:63]
  buffer_load_dwordx4 v[208:211], v21, s[24:27], s39 offen offset:3072 sc1
  v_mfma_f32_16x16x32_bf16 v[60:63], v[172:175], a[204:207], v[60:63]
  s_waitcnt lgkmcnt(12)
  v_mul_f32 v35, v35, v27
  v_mul_f32 v28, s96, v36
  v_mul_f32 v29, s96, v37
  v_mul_f32 v30, s96, v38
  v_mfma_f32_16x16x32_bf16 v[48:51], v[184:187], a[240:243], v[48:51]
  s_barrier
  v_mfma_f32_16x16x32_bf16 v[48:51], v[188:191], v[224:227], v[48:51]
  ds_read_b128 a[72:75], v21 offset:18432
  v_mul_f32 v31, s96, v39
  v_mfma_f32_16x16x32_bf16 v[48:51], v[192:195], v[240:243], v[48:51]
  ds_read_b128 a[76:79], v21 offset:19456
  v_exp_f32 v28, v28
  v_mfma_f32_16x16x32_bf16 v[52:55], v[192:195], v[244:247], v[52:55]
  s_add_u32 m0, s82, 135040
  ds_read_b128 a[80:83], v21 offset:20480
  v_exp_f32 v29, v29
  v_mfma_f32_16x16x32_bf16 v[52:55], v[188:191], v[228:231], v[52:55]
  buffer_load_dwordx4 v6, s[20:23], s67 offen offset:128 lds
  v_mfma_f32_16x16x32_bf16 v[52:55], v[184:187], a[244:247], v[52:55]
  ds_read_b128 a[84:87], v21 offset:21504
  v_exp_f32 v30, v30
  v_mfma_f32_16x16x32_bf16 v[56:59], v[184:187], a[248:251], v[56:59]
  ds_read_b128 a[88:91], v21 offset:22528
  v_exp_f32 v31, v31
  v_mfma_f32_16x16x32_bf16 v[56:59], v[188:191], v[232:235], v[56:59]
  s_add_u32 m0, s82, 130944
  ds_read_b128 a[92:95], v21 offset:23552
  v_add_f32 v28, 1.0, v28
  v_add_f32 v29, 1.0, v29
  v_mfma_f32_16x16x32_bf16 v[56:59], v[192:195], v[248:251], v[56:59]
  buffer_load_dwordx4 v6, s[20:23], s68 offen offset:128 lds
  v_mfma_f32_16x16x32_bf16 v[60:63], v[192:195], v[252:255], v[60:63]
  ds_write_b128 v19, v[140:143] offset:52224
  v_mfma_f32_16x16x32_bf16 v[60:63], v[188:191], v[236:239], v[60:63]
  s_add_u32 s47, s46, 49152
  v_add_f32 v30, 1.0, v30
  v_add_f32 v31, 1.0, v31
  v_rcp_f32 v28, v28
  v_mfma_f32_16x16x32_bf16 v[60:63], v[184:187], a[252:255], v[60:63]
  s_waitcnt lgkmcnt(1)
  v_rcp_f32 v29, v29
  v_mfma_f32_16x16x32_bf16 v[64:67], v[160:163], a[0:3], 0
  s_barrier
  v_mfma_f32_16x16x32_bf16 v[64:67], v[164:167], a[32:35], v[64:67]
  ds_read_b64_tr_b16 v[172:173], v17 offset:28672
  ds_read_b64_tr_b16 v[174:175], v17 offset:30720
  ds_read_b128 a[96:99], v21 offset:24576
  v_mfma_f32_16x16x32_bf16 v[64:67], v[168:171], a[64:67], v[64:67]
  buffer_store_dwordx4 v[128:131], v19, s[24:27], s47 offen offset:0 sc1
  v_mfma_f32_16x16x32_bf16 v[68:71], v[168:171], a[68:71], 0
  ds_read_b64_tr_b16 v[176:177], v17 offset:24576
  ds_read_b64_tr_b16 v[178:179], v17 offset:26624
  ds_read_b128 a[100:103], v21 offset:25600
  v_mfma_f32_16x16x32_bf16 v[68:71], v[164:167], a[36:39], v[68:71]
  ds_read_b128 a[104:107], v21 offset:26624
  v_rcp_f32 v30, v30
  v_mfma_f32_16x16x32_bf16 v[68:71], v[160:163], a[4:7], v[68:71]
  ds_read_b64_tr_b16 v[180:181], v17 offset:20480
  ds_read_b64_tr_b16 v[182:183], v17 offset:22528
  ds_read_b128 a[108:111], v21 offset:27648
  v_mfma_f32_16x16x32_bf16 v[72:75], v[160:163], a[8:11], 0
  s_add_u32 m0, s82, 126848
  ds_read_b128 a[112:115], v21 offset:28672
  v_rcp_f32 v31, v31
  v_mfma_f32_16x16x32_bf16 v[72:75], v[164:167], a[40:43], v[72:75]
  buffer_load_dwordx4 v6, s[20:23], s69 offen offset:128 lds
  v_mfma_f32_16x16x32_bf16 v[72:75], v[168:171], a[72:75], v[72:75]
  ds_read_b128 a[116:119], v21 offset:29696
  v_mul_f32 v36, v36, v28
  v_mul_f32 v37, v37, v29
  v_mfma_f32_16x16x32_bf16 v[76:79], v[168:171], a[76:79], 0
  ds_read_b128 a[120:123], v21 offset:30720
  v_mul_f32 v38, v38, v30
  v_mul_f32 v39, v39, v31
  v_mfma_f32_16x16x32_bf16 v[76:79], v[164:167], a[44:47], v[76:79]
  ds_read_b128 a[124:127], v21 offset:31744
  v_mul_f32 v24, s96, v40
  v_mul_f32 v25, s96, v41
  v_mfma_f32_16x16x32_bf16 v[76:79], v[160:163], a[12:15], v[76:79]
  ds_read_b128 a[128:131], v21 offset:32768
  v_mul_f32 v26, s96, v42
  v_mul_f32 v27, s96, v43
  v_mfma_f32_16x16x32_bf16 v[80:83], v[160:163], a[16:19], 0
  ds_read_b128 a[132:135], v21 offset:33792
  v_exp_f32 v24, v24
  v_mfma_f32_16x16x32_bf16 v[80:83], v[164:167], a[48:51], v[80:83]
  ds_read_b128 a[136:139], v21 offset:34816
  v_mfma_f32_16x16x32_bf16 v[80:83], v[168:171], a[80:83], v[80:83]
  ds_read_b128 a[140:143], v21 offset:35840
  v_exp_f32 v25, v25
  v_mfma_f32_16x16x32_bf16 v[84:87], v[168:171], a[84:87], 0
  v_exp_f32 v26, v26
  v_mfma_f32_16x16x32_bf16 v[84:87], v[164:167], a[52:55], v[84:87]
  s_add_u32 m0, s82, 122752
  v_exp_f32 v27, v27
  v_add_f32 v24, 1.0, v24
  v_add_f32 v25, 1.0, v25
  v_mfma_f32_16x16x32_bf16 v[84:87], v[160:163], a[20:23], v[84:87]
  buffer_load_dwordx4 v6, s[20:23], s70 offen offset:128 lds
  v_mfma_f32_16x16x32_bf16 v[88:91], v[160:163], a[24:27], 0
  buffer_store_dwordx4 v[132:135], v19, s[24:27], s47 offen offset:1024 sc1
  v_mfma_f32_16x16x32_bf16 v[88:91], v[164:167], a[56:59], v[88:91]
  v_add_f32 v26, 1.0, v26
  v_add_f32 v27, 1.0, v27
  v_rcp_f32 v24, v24
  v_mfma_f32_16x16x32_bf16 v[88:91], v[168:171], a[88:91], v[88:91]
  v_rcp_f32 v25, v25
  v_mfma_f32_16x16x32_bf16 v[92:95], v[168:171], a[92:95], 0
  v_rcp_f32 v26, v26
  v_mfma_f32_16x16x32_bf16 v[92:95], v[164:167], a[60:63], v[92:95]
  v_rcp_f32 v27, v27
  v_mul_f32 v40, v40, v24
  v_mul_f32 v41, v41, v25
  v_mfma_f32_16x16x32_bf16 v[92:95], v[160:163], a[28:31], v[92:95]
  v_mul_f32 v42, v42, v26
  v_mul_f32 v43, v43, v27
  s_waitcnt vmcnt(13)
  v_readfirstlane_b32 s91, v220
  s_nop 1
  s_cmp_ge_u32 s91, s45
  s_cbranch_scc0 L_spq1_gated_mix__spectral_gfnet__swiglu_ffn__prompt_kernel
L_bkq1_gated_mix__spectral_gfnet__swiglu_ffn__prompt_kernel:
  s_waitcnt lgkmcnt(9)
  v_mfma_f32_16x16x32_bf16 v[96:99], v[172:175], a[0:3], 0
  s_barrier
  s_lshl_b32 s84, s89, 12
  s_add_u32 s84, s84, 3145728
  s_cmp_lg_u32 s80, 0
  s_cbranch_scc0 L_onyl_gated_mix__spectral_gfnet__swiglu_ffn__prompt_kernel
L_nyl_gated_mix__spectral_gfnet__swiglu_ffn__prompt_kernel:
  s_cmp_lt_u32 s95, 16
  s_cbranch_scc0 L_od2l_gated_mix__spectral_gfnet__swiglu_ffn__prompt_kernel
L_d2l_gated_mix__spectral_gfnet__swiglu_ffn__prompt_kernel:
  v_mfma_f32_16x16x32_bf16 v[96:99], v[176:179], a[32:35], v[96:99]
  ds_read_b64_tr_b16 v[160:161], v17 offset:16384
  ds_read_b64_tr_b16 v[162:163], v17 offset:18432
  ds_read_b128 a[144:147], v21 offset:36864
  v_mul_f32 v28, s96, v44
  v_mfma_f32_16x16x32_bf16 v[96:99], v[180:183], a[64:67], v[96:99]
  ds_read_b128 a[148:151], v21 offset:37888
  v_mul_f32 v29, s96, v45
  v_mfma_f32_16x16x32_bf16 v[100:103], v[180:183], a[68:71], 0
  s_add_u32 m0, s82, 94080
  ds_read_b64_tr_b16 v[164:165], v18 offset:28672
  ds_read_b64_tr_b16 v[166:167], v18 offset:30720
  ds_read_b128 a[152:155], v21 offset:38912
  v_mfma_f32_16x16x32_bf16 v[100:103], v[176:179], a[36:39], v[100:103]
  buffer_load_dwordx4 v6, s[20:23], s71 offen offset:128 lds
  v_mfma_f32_16x16x32_bf16 v[100:103], v[172:175], a[4:7], v[100:103]
  ds_read_b128 a[156:159], v21 offset:39936
  v_mul_f32 v30, s96, v46
  v_mul_f32 v31, s96, v47
  v_mfma_f32_16x16x32_bf16 v[104:107], v[172:175], a[8:11], 0
  ds_read_b64_tr_b16 v[168:169], v18 offset:24576
  ds_read_b64_tr_b16 v[170:171], v18 offset:26624
  ds_read_b128 a[160:163], v21 offset:40960
  v_mfma_f32_16x16x32_bf16 v[104:107], v[176:179], a[40:43], v[104:107]
  ds_read_b128 a[164:167], v21 offset:41984
  v_exp_f32 v28, v28
  v_mfma_f32_16x16x32_bf16 v[104:107], v[180:183], a[72:75], v[104:107]
  s_add_u32 m0, s82, 89984
  ds_read_b128 a[168:171], v21 offset:43008
  v_exp_f32 v29, v29
  v_mfma_f32_16x16x32_bf16 v[108:111], v[180:183], a[76:79], 0
  buffer_load_dwordx4 v6, s[20:23], s72 offen offset:128 lds
  v_mfma_f32_16x16x32_bf16 v[108:111], v[176:179], a[44:47], v[108:111]
  buffer_store_dwordx4 v[136:139], v19, s[24:27], s47 offen offset:2048 sc1
  v_mfma_f32_16x16x32_bf16 v[108:111], v[172:175], a[12:15], v[108:111]
  ds_read_b128 a[172:175], v21 offset:44032
  v_exp_f32 v30, v30
  v_mfma_f32_16x16x32_bf16 v[112:115], v[172:175], a[16:19], 0
  ds_read_b128 a[176:179], v21 offset:45056
  v_exp_f32 v31, v31
  v_add_f32 v28, 1.0, v28
  v_mfma_f32_16x16x32_bf16 v[112:115], v[176:179], a[48:51], v[112:115]
  ds_read_b128 a[180:183], v21 offset:46080
  v_add_f32 v29, 1.0, v29
  v_add_f32 v30, 1.0, v30
  v_mfma_f32_16x16x32_bf16 v[112:115], v[180:183], a[80:83], v[112:115]
  s_add_u32 m0, s82, 0
  ds_read_b128 a[184:187], v21 offset:47104
  v_add_f32 v31, 1.0, v31
  v_mfma_f32_16x16x32_bf16 v[116:119], v[180:183], a[84:87], 0
  buffer_load_dwordx4 v4, s[24:27], m0 offen sc1 lds
  v_mfma_f32_16x16x32_bf16 v[116:119], v[176:179], a[52:55], v[116:119]
  ds_read_b128 a[188:191], v21 offset:48128
  v_rcp_f32 v28, v28
  v_mfma_f32_16x16x32_bf16 v[116:119], v[172:175], a[20:23], v[116:119]
  v_rcp_f32 v29, v29
  v_rcp_f32 v30, v30
  v_mfma_f32_16x16x32_bf16 v[120:123], v[172:175], a[24:27], 0
  v_rcp_f32 v31, v31
  v_mul_f32 v44, v44, v28
  v_mul_f32 v45, v45, v29
  v_mfma_f32_16x16x32_bf16 v[120:123], v[176:179], a[56:59], v[120:123]
  s_add_u32 m0, s82, 4096
  v_mul_f32 v46, v46, v30
  v_mul_f32 v47, v47, v31
  v_mul_f32 v32, v32, v48
  v_mfma_f32_16x16x32_bf16 v[120:123], v[180:183], a[88:91], v[120:123]
  buffer_load_dwordx4 v4, s[24:27], m0 offen sc1 lds
  v_mfma_f32_16x16x32_bf16 v[124:127], v[180:183], a[92:95], 0
  v_mul_f32 v33, v33, v49
  v_mul_f32 v34, v34, v50
  v_mul_f32 v35, v35, v51
  v_cvt_pk_bf16_f32 v48, v32, v33
  v_mfma_f32_16x16x32_bf16 v[124:127], v[176:179], a[60:63], v[124:127]
  v_cvt_pk_bf16_f32 v49, v34, v35
  v_mfma_f32_16x16x32_bf16 v[124:127], v[172:175], a[28:31], v[124:127]
  s_waitcnt lgkmcnt(0)
  v_mfma_f32_16x16x32_bf16 v[64:67], v[160:163], a[96:99], v[64:67]
  s_barrier
  v_mfma_f32_16x16x32_bf16 v[64:67], v[164:167], a[128:131], v[64:67]
  ds_read_b64_tr_b16 v[172:173], v17 offset:53248
  ds_read_b64_tr_b16 v[174:175], v17 offset:55296
  ds_read_b128 a[192:195], v21 offset:49152
  v_mfma_f32_16x16x32_bf16 v[64:67], v[168:171], a[160:163], v[64:67]
  buffer_store_dwordx4 v[140:143], v19, s[24:27], s47 offen offset:3072 sc1
  v_mfma_f32_16x16x32_bf16 v[68:71], v[168:171], a[164:167], v[68:71]
  ds_read_b64_tr_b16 v[176:177], v17 offset:49152
  ds_read_b64_tr_b16 v[178:179], v17 offset:51200
  ds_read_b128 a[196:199], v21 offset:50176
  v_mfma_f32_16x16x32_bf16 v[68:71], v[164:167], a[132:135], v[68:71]
  s_add_u32 m0, s82, 159616
  ds_read_b128 a[200:203], v21 offset:51200
  v_mfma_f32_16x16x32_bf16 v[68:71], v[160:163], a[100:103], v[68:71]
  buffer_load_dwordx4 v6, s[20:23], s73 offen offset:128 lds
  v_mfma_f32_16x16x32_bf16 v[72:75], v[160:163], a[104:107], v[72:75]
  ds_read_b64_tr_b16 v[180:181], v18 offset:20480
  ds_read_b64_tr_b16 v[182:183], v18 offset:22528
  ds_read_b128 a[204:207], v21 offset:52224
  v_mfma_f32_16x16x32_bf16 v[72:75], v[164:167], a[136:139], v[72:75]
  ds_read_b128 a[208:211], v21 offset:53248
  v_mfma_f32_16x16x32_bf16 v[72:75], v[168:171], a[168:171], v[72:75]
  ds_read_b128 a[212:215], v21 offset:54272
  v_mfma_f32_16x16x32_bf16 v[76:79], v[168:171], a[172:175], v[76:79]
  ds_read_b128 a[216:219], v21 offset:55296
  v_mfma_f32_16x16x32_bf16 v[76:79], v[164:167], a[140:143], v[76:79]
  ds_read_b128 a[220:223], v21 offset:56320
  v_mfma_f32_16x16x32_bf16 v[76:79], v[160:163], a[108:111], v[76:79]
  s_add_u32 m0, s82, 155520
  ds_read_b128 a[224:227], v21 offset:57344
  v_mfma_f32_16x16x32_bf16 v[80:83], v[160:163], a[112:115], v[80:83]
  buffer_load_dwordx4 v6, s[20:23], s74 offen offset:128 lds
  v_mfma_f32_16x16x32_bf16 v[80:83], v[164:167], a[144:147], v[80:83]
  ds_read_b128 a[228:231], v21 offset:58368
  v_mfma_f32_16x16x32_bf16 v[80:83], v[168:171], a[176:179], v[80:83]
  ds_read_b128 a[232:235], v21 offset:59392
  ds_write_b64 v20, v[48:49] offset:0
  v_mul_f32 v36, v36, v52
  v_mul_f32 v37, v37, v53
  v_mul_f32 v38, v38, v54
  v_mul_f32 v39, v39, v55
  v_cvt_pk_bf16_f32 v52, v36, v37
  v_cvt_pk_bf16_f32 v53, v38, v39
  ds_write_b64 v20, v[52:53] offset:1024
  v_mul_f32 v40, v40, v56
  v_mul_f32 v41, v41, v57
  v_mul_f32 v42, v42, v58
  v_mul_f32 v43, v43, v59
  v_cvt_pk_bf16_f32 v56, v40, v41
  v_cvt_pk_bf16_f32 v57, v42, v43
  ds_write_b64 v20, v[56:57] offset:2048
  v_mul_f32 v44, v44, v60
  v_mul_f32 v45, v45, v61
  v_mul_f32 v46, v46, v62
  v_mul_f32 v47, v47, v63
  v_cvt_pk_bf16_f32 v60, v44, v45
  v_cvt_pk_bf16_f32 v61, v46, v47
  ds_write_b64 v20, v[60:61] offset:3072
  v_mfma_f32_16x16x32_bf16 v[84:87], v[168:171], a[180:183], v[84:87]
  ds_read_b128 a[236:239], v21 offset:60416
  v_mfma_f32_16x16x32_bf16 v[84:87], v[164:167], a[148:151], v[84:87]
  ds_read_b128 a[240:243], v21 offset:61440
  v_mfma_f32_16x16x32_bf16 v[84:87], v[160:163], a[116:119], v[84:87]
  ds_read_b128 a[244:247], v21 offset:62464
  v_mfma_f32_16x16x32_bf16 v[88:91], v[160:163], a[120:123], v[88:91]
  s_add_u32 m0, s82, 8192
  ds_read_b128 a[248:251], v21 offset:63488
  v_mfma_f32_16x16x32_bf16 v[88:91], v[164:167], a[152:155], v[88:91]
  buffer_load_dwordx4 v4, s[24:27], m0 offen sc1 lds
  ds_read_b128 a[252:255], v21 offset:64512
  v_mfma_f32_16x16x32_bf16 v[88:91], v[168:171], a[184:187], v[88:91]
  s_and_b32 s7, s6, 1
  v_mfma_f32_16x16x32_bf16 v[92:95], v[168:171], a[188:191], v[92:95]
  s_mul_i32 s6, s6, 331776
  v_mfma_f32_16x16x32_bf16 v[92:95], v[164:167], a[156:159], v[92:95]
  s_mul_i32 s48, s7, 36864
  v_mfma_f32_16x16x32_bf16 v[92:95], v[160:163], a[124:127], v[92:95]
  s_waitcnt lgkmcnt(5)
  v_mfma_f32_16x16x32_bf16 v[96:99], v[172:175], a[96:99], v[96:99]
  s_barrier
  v_mfma_f32_16x16x32_bf16 v[96:99], v[176:179], a[128:131], v[96:99]
  ds_read_b64_tr_b16 v[160:161], v18 offset:16384
  ds_read_b64_tr_b16 v[162:163], v18 offset:18432
  ds_read_b128 v[224:227], v22 offset:0
  s_add_u32 s48, s48, s6
  v_mfma_f32_16x16x32_bf16 v[96:99], v[180:183], a[160:163], v[96:99]
  ds_read_b128 v[228:231], v22 offset:1024
  v_mfma_f32_16x16x32_bf16 v[100:103], v[180:183], a[164:167], v[100:103]
  s_add_u32 m0, s82, 151296
  ds_read_b64_tr_b16 v[164:165], v17 offset:45056
  ds_read_b64_tr_b16 v[166:167], v17 offset:47104
  v_mfma_f32_16x16x32_bf16 v[100:103], v[176:179], a[132:135], v[100:103]
  buffer_load_dwordx4 v6, s[20:23], s66 offen offset:256 lds
  v_mfma_f32_16x16x32_bf16 v[100:103], v[172:175], a[100:103], v[100:103]
  ds_read_b128 v[232:235], v22 offset:2048
  s_xor_b32 s7, s7, 1
  s_mul_i32 s7, s7, 294912
  v_mfma_f32_16x16x32_bf16 v[104:107], v[172:175], a[104:107], v[104:107]
  s_lshl_b32 s92, s81, 11
  ds_read_b64_tr_b16 v[168:169], v17 offset:40960
  ds_read_b64_tr_b16 v[170:171], v17 offset:43008
  v_mfma_f32_16x16x32_bf16 v[104:107], v[176:179], a[136:139], v[104:107]
  ds_read_b128 v[236:239], v22 offset:3072
  v_add_u32 v20, s92, v22
  v_mfma_f32_16x16x32_bf16 v[104:107], v[180:183], a[168:171], v[104:107]
  s_add_u32 m0, s82, 118528
  ds_read_b128 v[240:243], v22 offset:4096
  ds_read_b128 v[24:27], v20
  ds_read_b128 v[28:31], v20 offset:1024
  v_mfma_f32_16x16x32_bf16 v[108:111], v[180:183], a[172:175], v[108:111]
  buffer_load_dwordx4 v6, s[20:23], s67 offen offset:256 lds
  v_mfma_f32_16x16x32_bf16 v[108:111], v[176:179], a[140:143], v[108:111]
  ds_read_b128 v[244:247], v22 offset:5120
  s_add_u32 s56, s6, s7
  s_add_u32 s49, s48, 36864
  v_mfma_f32_16x16x32_bf16 v[108:111], v[172:175], a[108:111], v[108:111]
  ds_read_b128 v[248:251], v22 offset:6144
  s_add_u32 s50, s48, 73728
  v_mfma_f32_16x16x32_bf16 v[112:115], v[172:175], a[112:115], v[112:115]
  ds_read_b128 v[252:255], v22 offset:7168
  v_mfma_f32_16x16x32_bf16 v[112:115], v[176:179], a[144:147], v[112:115]
  s_add_u32 s51, s48, 110592
  v_mfma_f32_16x16x32_bf16 v[112:115], v[180:183], a[176:179], v[112:115]
  s_add_u32 m0, s82, 114432
  v_mfma_f32_16x16x32_bf16 v[116:119], v[180:183], a[180:183], v[116:119]
  buffer_load_dwordx4 v6, s[20:23], s68 offen offset:256 lds
  v_mfma_f32_16x16x32_bf16 v[116:119], v[176:179], a[148:151], v[116:119]
  s_add_u32 s52, s48, 147456
  v_mfma_f32_16x16x32_bf16 v[116:119], v[172:175], a[116:119], v[116:119]
  s_add_u32 s53, s48, 184320
  v_mfma_f32_16x16x32_bf16 v[120:123], v[172:175], a[120:123], v[120:123]
  s_add_u32 s54, s48, 221184
  v_mfma_f32_16x16x32_bf16 v[120:123], v[176:179], a[152:155], v[120:123]
  s_add_u32 m0, s82, 12288
  v_mfma_f32_16x16x32_bf16 v[120:123], v[180:183], a[184:187], v[120:123]
  buffer_load_dwordx4 v4, s[24:27], m0 offen sc1 lds
  v_mfma_f32_16x16x32_bf16 v[124:127], v[180:183], a[188:191], v[124:127]
  s_add_u32 s55, s48, 258048
  s_lshl_b32 s6, s88, 9
  s_add_u32 s6, s6, s89
  v_lshlrev_b32 v48, 5, v1
  v_add_u32 v48, s6, v48
  v_mfma_f32_16x16x32_bf16 v[124:127], v[176:179], a[156:159], v[124:127]
  s_waitcnt lgkmcnt(4)
  buffer_store_dwordx4 v[24:27], v20, s[24:27], s46 offen sc1
  v_mfma_f32_16x16x32_bf16 v[124:127], v[172:175], a[124:127], v[124:127]
  s_waitcnt vmcnt(22) lgkmcnt(0)
  v_cvt_f32_u32 v48, v48
  v_mul_f32 v48, 0x3a000000, v48
  v_lshlrev_b32 v49, 4, v2
  v_mfma_f32_16x16x32_bf16 v[64:67], v[160:163], a[192:195], v[64:67]
  s_barrier
  v_mfma_f32_16x16x32_bf16 v[64:67], v[164:167], a[224:227], v[64:67]
  s_lshl_b32 s100, s81, 12
  ds_read_b64_tr_b16 v[172:173], v17 offset:36864
  ds_read_b64_tr_b16 v[174:175], v17 offset:38912
  s_add_u32 s100, s100, 73728
  v_mfma_f32_16x16x32_bf16 v[64:67], v[168:171], v[224:227], v[64:67]
  buffer_store_dwordx4 v[28:31], v20, s[24:27], s46 offen offset:1024 sc1
  v_mfma_f32_16x16x32_bf16 v[68:71], v[168:171], v[228:231], v[68:71]
  s_add_u32 m0, s82, 147200
  ds_read_b64_tr_b16 v[176:177], v17 offset:32768
  ds_read_b64_tr_b16 v[178:179], v17 offset:34816
  v_add_u32 v192, s100, v21
  v_mfma_f32_16x16x32_bf16 v[68:71], v[164:167], a[228:231], v[68:71]
  buffer_load_dwordx4 v6, s[20:23], s69 offen offset:256 lds
  v_mfma_f32_16x16x32_bf16 v[68:71], v[160:163], a[196:199], v[68:71]
  v_lshrrev_b32 v193, 2, v1
  v_lshl_add_u32 v193, v2, 3, v193
  v_lshlrev_b32 v193, 7, v193
  v_and_b32 v194, 3, v1
  v_mfma_f32_16x16x32_bf16 v[72:75], v[160:163], a[200:203], v[72:75]
  ds_read_b64_tr_b16 v[180:181], v18 offset:12288
  ds_read_b64_tr_b16 v[182:183], v18 offset:14336
  v_mfma_f32_16x16x32_bf16 v[72:75], v[164:167], a[232:235], v[72:75]
  v_lshl_add_u32 v193, v194, 3, v193
  v_add_u32 v193, s100, v193
  v_cvt_f32_u32 v49, v49
  v_mfma_f32_16x16x32_bf16 v[72:75], v[168:171], v[232:235], v[72:75]
  s_add_u32 m0, s82, 110336
  v_add_f32 v50, v48, v48
  v_mfma_f32_16x16x32_bf16 v[76:79], v[168:171], v[236:239], v[76:79]
  buffer_load_dwordx4 v6, s[20:23], s70 offen offset:256 lds
  v_mfma_f32_16x16x32_bf16 v[76:79], v[164:167], a[236:239], v[76:79]
  s_add_u32 s90, s44, 0x1c00000
  v_cvt_pk_bf16_f32 v64, v64, v65
  v_cvt_pk_bf16_f32 v65, v66, v67
  v_cvt_pk_bf16_f32 v66, v68, v69
  v_cvt_pk_bf16_f32 v67, v70, v71
  v_mfma_f32_16x16x32_bf16 v[76:79], v[160:163], a[204:207], v[76:79]
  buffer_store_dwordx4 v[64:67], v21, s[24:27], s90 offen sc1
  v_mfma_f32_16x16x32_bf16 v[80:83], v[160:163], a[208:211], v[80:83]
  ds_write_b128 v192, v[196:199] offset:0
  v_mfma_f32_16x16x32_bf16 v[80:83], v[164:167], a[240:243], v[80:83]
  ds_write_b128 v192, v[200:203] offset:1024
  v_mfma_f32_16x16x32_bf16 v[80:83], v[168:171], v[240:243], v[80:83]
  s_add_u32 m0, s82, 106240
  v_cos_f32 v50, v50
  v_add_f32 v53, 0x00000000, v49
  v_add_f32 v54, 0x40000000, v49
  v_mfma_f32_16x16x32_bf16 v[84:87], v[168:171], v[244:247], v[84:87]
  buffer_load_dwordx4 v6, s[20:23], s71 offen offset:256 lds
  v_mfma_f32_16x16x32_bf16 v[84:87], v[164:167], a[244:247], v[84:87]
  s_add_u32 s90, s44, 0x1c04000
  v_cvt_pk_bf16_f32 v72, v72, v73
  v_cvt_pk_bf16_f32 v73, v74, v75
  v_cvt_pk_bf16_f32 v74, v76, v77
  v_mfma_f32_16x16x32_bf16 v[84:87], v[160:163], a[212:215], v[84:87]
  v_cvt_pk_bf16_f32 v75, v78, v79
  v_mul_f32 v53, v53, v48
  v_mul_f32 v54, v54, v48
  v_mfma_f32_16x16x32_bf16 v[88:91], v[160:163], a[216:219], v[88:91]
  buffer_store_dwordx4 v[72:75], v21, s[24:27], s90 offen sc1
  v_mfma_f32_16x16x32_bf16 v[88:91], v[164:167], a[248:251], v[88:91]
  s_add_u32 m0, s82, 16384
  v_cos_f32 v51, v53
  v_mfma_f32_16x16x32_bf16 v[88:91], v[168:171], v[248:251], v[88:91]
  buffer_load_dwordx4 v4, s[24:27], m0 offen sc1 lds
  v_mfma_f32_16x16x32_bf16 v[92:95], v[168:171], v[252:255], v[92:95]
  s_add_u32 s90, s44, 0x1c08000
  v_cvt_pk_bf16_f32 v80, v80, v81
  v_cvt_pk_bf16_f32 v81, v82, v83
  v_cvt_pk_bf16_f32 v82, v84, v85
  v_cvt_pk_bf16_f32 v83, v86, v87
  v_mfma_f32_16x16x32_bf16 v[92:95], v[164:167], a[252:255], v[92:95]
  buffer_store_dwordx4 v[80:83], v21, s[24:27], s90 offen sc1
  v_mfma_f32_16x16x32_bf16 v[92:95], v[160:163], a[220:223], v[92:95]
  s_waitcnt vmcnt(26) lgkmcnt(2)
  v_cos_f32 v52, v54
  v_mfma_f32_16x16x32_bf16 v[96:99], v[172:175], a[192:195], v[96:99]
  s_barrier
  v_mfma_f32_16x16x32_bf16 v[96:99], v[176:179], a[224:227], v[96:99]
  ds_read_b64_tr_b16 v[160:161], v18 offset:8192
  ds_read_b64_tr_b16 v[162:163], v18 offset:10240
  v_sin_f32 v53, v53
  v_mfma_f32_16x16x32_bf16 v[96:99], v[180:183], v[224:227], v[96:99]
  s_add_u32 s90, s44, 0x1c0c000
  v_cvt_pk_bf16_f32 v88, v88, v89
  v_cvt_pk_bf16_f32 v89, v90, v91
  v_mfma_f32_16x16x32_bf16 v[100:103], v[180:183], v[228:231], v[100:103]
  s_add_u32 m0, s82, 143104
  ds_read_b64_tr_b16 v[164:165], v18 offset:4096
  ds_read_b64_tr_b16 v[166:167], v18 offset:6144
  v_cvt_pk_bf16_f32 v90, v92, v93
  v_mfma_f32_16x16x32_bf16 v[100:103], v[176:179], a[228:231], v[100:103]
  buffer_load_dwordx4 v6, s[20:23], s72 offen offset:256 lds
  v_mfma_f32_16x16x32_bf16 v[100:103], v[172:175], a[196:199], v[100:103]
  v_cvt_pk_bf16_f32 v91, v94, v95
  v_sin_f32 v54, v54
  v_mfma_f32_16x16x32_bf16 v[104:107], v[172:175], a[200:203], v[104:107]
  ds_read_b64_tr_b16 v[168:169], v18 offset:0
  ds_read_b64_tr_b16 v[170:171], v18 offset:2048
  v_add_f32 v50, v50, v50
  v_mfma_f32_16x16x32_bf16 v[104:107], v[176:179], a[232:235], v[104:107]
  buffer_store_dwordx4 v[88:91], v21, s[24:27], s90 offen sc1
  v_mfma_f32_16x16x32_bf16 v[104:107], v[180:183], v[232:235], v[104:107]
  s_add_u32 m0, s82, 102144
  v_cvt_pk_bf16_f32 v32, v51, v52
  v_cvt_pk_bf16_f32 v36, v53, v54
  v_fma_f32 v51, v50, v52, -v51
  v_fma_f32 v53, v50, v54, -v53
  v_mfma_f32_16x16x32_bf16 v[108:111], v[180:183], v[236:239], v[108:111]
  buffer_load_dwordx4 v6, s[20:23], s73 offen offset:256 lds
  v_mfma_f32_16x16x32_bf16 v[108:111], v[176:179], a[236:239], v[108:111]
  ds_write_b128 v192, v[204:207] offset:2048
  v_mfma_f32_16x16x32_bf16 v[108:111], v[172:175], a[204:207], v[108:111]
  ds_write_b128 v192, v[208:211] offset:3072
  v_mfma_f32_16x16x32_bf16 v[112:115], v[172:175], a[208:211], v[112:115]
  ds_read_b64_tr_b16 v[196:197], v193 offset:0
  ds_read_b64_tr_b16 v[198:199], v193 offset:512
  ds_read_b64_tr_b16 v[200:201], v193 offset:32
  ds_read_b64_tr_b16 v[202:203], v193 offset:544
  v_mfma_f32_16x16x32_bf16 v[112:115], v[176:179], a[240:243], v[112:115]
  ds_read_b64_tr_b16 v[204:205], v193 offset:64
  ds_read_b64_tr_b16 v[206:207], v193 offset:576
  v_mfma_f32_16x16x32_bf16 v[112:115], v[180:183], v[240:243], v[112:115]
  s_add_u32 m0, s82, 98048
  ds_read_b64_tr_b16 v[208:209], v193 offset:96
  ds_read_b64_tr_b16 v[210:211], v193 offset:608
  v_fma_f32 v52, v50, v51, -v52
  v_mfma_f32_16x16x32_bf16 v[116:119], v[180:183], v[244:247], v[116:119]
  buffer_load_dwordx4 v6, s[20:23], s74 offen offset:256 lds
  v_mfma_f32_16x16x32_bf16 v[116:119], v[176:179], a[244:247], v[116:119]
  s_lshl_b32 s100, s89, 1
  v_fma_f32 v54, v50, v53, -v54
  v_cvt_pk_bf16_f32 v33, v51, v52
  v_cvt_pk_bf16_f32 v37, v53, v54
  v_fma_f32 v51, v50, v52, -v51
  v_mfma_f32_16x16x32_bf16 v[116:119], v[172:175], a[212:215], v[116:119]
  s_mul_i32 s100, s100, 18
  v_fma_f32 v53, v50, v54, -v53
  v_fma_f32 v52, v50, v51, -v52
  v_mfma_f32_16x16x32_bf16 v[120:123], v[172:175], a[216:219], v[120:123]
  s_add_u32 s100, s100, s80
  v_fma_f32 v54, v50, v53, -v54
  v_cvt_pk_bf16_f32 v34, v51, v52
  v_cvt_pk_bf16_f32 v38, v53, v54
  v_mfma_f32_16x16x32_bf16 v[120:123], v[176:179], a[248:251], v[120:123]
  s_add_u32 m0, s82, 20480
  v_fma_f32 v51, v50, v52, -v51
  v_fma_f32 v53, v50, v54, -v53
  v_fma_f32 v52, v50, v51, -v52
  v_mfma_f32_16x16x32_bf16 v[120:123], v[180:183], v[248:251], v[120:123]
  buffer_load_dwordx4 v4, s[24:27], m0 offen sc1 lds
  v_mfma_f32_16x16x32_bf16 v[124:127], v[180:183], v[252:255], v[124:127]
  s_lshl_b32 s100, s100, 1
  v_fma_f32 v54, v50, v53, -v54
  v_cvt_pk_bf16_f32 v35, v51, v52
  v_cvt_pk_bf16_f32 v39, v53, v54
  v_mfma_f32_16x16x32_bf16 v[124:127], v[176:179], a[252:255], v[124:127]
  s_add_u32 s100, s100, s88
  v_add_f32 v53, 0x3f800000, v49
  v_add_f32 v54, 0x40400000, v49
  v_mul_f32 v53, v53, v48
  v_mfma_f32_16x16x32_bf16 v[124:127], v[172:175], a[220:223], v[124:127]
  s_waitcnt vmcnt(26) lgkmcnt(10)
  v_mul_f32 v54, v54, v48
  v_cos_f32 v51, v53
  v_mfma_f32_16x16x32_bf16 v[64:67], v[160:163], a[0:3], 0
  s_barrier
  v_mfma_f32_16x16x32_bf16 v[64:67], v[164:167], a[32:35], v[64:67]
  s_lshl_b32 s100, s100, 10
  ds_read_b64_tr_b16 v[172:173], v17 offset:61440
  ds_read_b64_tr_b16 v[174:175], v17 offset:63488
  v_cos_f32 v52, v54
  v_mfma_f32_16x16x32_bf16 v[64:67], v[168:171], a[64:67], v[64:67]
  s_add_u32 s100, s100, 50331648
  v_sin_f32 v53, v53
  v_mfma_f32_16x16x32_bf16 v[68:71], v[168:171], a[68:71], 0
  s_add_u32 m0, s82, 138880
  ds_read_b64_tr_b16 v[176:177], v17 offset:57344
  ds_read_b64_tr_b16 v[178:179], v17 offset:59392
  v_mfma_f32_16x16x32_bf16 v[68:71], v[164:167], a[36:39], v[68:71]
  buffer_load_dwordx4 v6, s[20:23], s66 offen offset:384 lds
  v_mfma_f32_16x16x32_bf16 v[68:71], v[160:163], a[4:7], v[68:71]
  v_sin_f32 v54, v54
  v_cvt_pk_bf16_f32 v40, v51, v52
  v_cvt_pk_bf16_f32 v44, v53, v54
  v_mfma_f32_16x16x32_bf16 v[72:75], v[160:163], a[8:11], 0
  ds_read_b64_tr_b16 v[180:181], v17 offset:28672
  ds_read_b64_tr_b16 v[182:183], v17 offset:30720
  v_mfma_f32_16x16x32_bf16 v[72:75], v[164:167], a[40:43], v[72:75]
  s_add_u32 m0, s82, 134784
  v_fma_f32 v51, v50, v52, -v51
  v_fma_f32 v53, v50, v54, -v53
  v_fma_f32 v52, v50, v51, -v52
  v_mfma_f32_16x16x32_bf16 v[72:75], v[168:171], a[72:75], v[72:75]
  buffer_load_dwordx4 v6, s[20:23], s67 offen offset:384 lds
  v_mfma_f32_16x16x32_bf16 v[76:79], v[168:171], a[76:79], 0
  v_fma_f32 v54, v50, v53, -v54
  v_cvt_pk_bf16_f32 v41, v51, v52
  v_cvt_pk_bf16_f32 v45, v53, v54
  v_fma_f32 v51, v50, v52, -v51
  v_mfma_f32_16x16x32_bf16 v[76:79], v[164:167], a[44:47], v[76:79]
  v_fma_f32 v53, v50, v54, -v53
  v_fma_f32 v52, v50, v51, -v52
  v_mfma_f32_16x16x32_bf16 v[76:79], v[160:163], a[12:15], v[76:79]
  s_add_u32 m0, s82, 130688
  v_fma_f32 v54, v50, v53, -v54
  v_cvt_pk_bf16_f32 v42, v51, v52
  v_cvt_pk_bf16_f32 v46, v53, v54
  v_mfma_f32_16x16x32_bf16 v[80:83], v[160:163], a[16:19], 0
  buffer_load_dwordx4 v6, s[20:23], s68 offen offset:384 lds
  v_mfma_f32_16x16x32_bf16 v[80:83], v[164:167], a[48:51], v[80:83]
  v_fma_f32 v51, v50, v52, -v51
  v_fma_f32 v53, v50, v54, -v53
  v_fma_f32 v52, v50, v51, -v52
  v_fma_f32 v54, v50, v53, -v54
  v_mfma_f32_16x16x32_bf16 v[80:83], v[168:171], a[80:83], v[80:83]
  v_cvt_pk_bf16_f32 v43, v51, v52
  v_cvt_pk_bf16_f32 v47, v53, v54
  s_waitcnt lgkmcnt(11)
  v_xor_b32 v184, 0x80008000, v200
  v_mfma_f32_16x16x32_bf16 v[84:87], v[168:171], a[84:87], 0
  s_add_u32 m0, s82, 24576
  v_xor_b32 v185, 0x80008000, v201
  s_waitcnt lgkmcnt(10)
  v_xor_b32 v186, 0x80008000, v202
  v_xor_b32 v187, 0x80008000, v203
  v_mfma_f32_16x16x32_bf16 v[84:87], v[164:167], a[52:55], v[84:87]
  buffer_load_dwordx4 v4, s[24:27], m0 offen sc1 lds
  v_mfma_f32_16x16x32_bf16 v[84:87], v[160:163], a[20:23], v[84:87]
  s_waitcnt lgkmcnt(7)
  v_xor_b32 v188, 0x80008000, v208
  v_xor_b32 v189, 0x80008000, v209
  s_waitcnt lgkmcnt(6)
  v_xor_b32 v190, 0x80008000, v210
  v_xor_b32 v191, 0x80008000, v211
  v_mfma_f32_16x16x32_bf16 v[88:91], v[160:163], a[24:27], 0
  v_mfma_f32_16x16x32_bf16 v[88:91], v[164:167], a[56:59], v[88:91]
  s_add_u32 m0, s82, 28672
  v_mfma_f32_16x16x32_bf16 v[88:91], v[168:171], a[88:91], v[88:91]
  buffer_load_dwordx4 v4, s[24:27], m0 offen sc1 lds
  v_mfma_f32_16x16x32_bf16 v[92:95], v[168:171], a[92:95], 0
  v_mfma_f32_16x16x32_bf16 v[92:95], v[164:167], a[60:63], v[92:95]
  v_mfma_f32_16x16x32_bf16 v[92:95], v[160:163], a[28:31], v[92:95]
  v_mfma_f32_16x16x32_bf16 v[48:51], v[196:199], v[32:35], 0
  v_mfma_f32_16x16x32_bf16 v[48:51], v[184:187], v[36:39], v[48:51]
  v_mfma_f32_16x16x32_bf16 v[56:59], v[204:207], v[40:43], 0
  v_mfma_f32_16x16x32_bf16 v[56:59], v[188:191], v[44:47], v[56:59]
  s_cmp_lg_u32 s80, 0
  s_cbranch_scc0 L_onyd_gated_mix__spectral_gfnet__swiglu_ffn__prompt_kernel
L_nyd_gated_mix__spectral_gfnet__swiglu_ffn__prompt_kernel:
  s_nop 1
  v_mfma_f32_16x16x32_bf16 v[52:55], v[200:203], v[32:35], 0
  v_mfma_f32_16x16x32_bf16 v[52:55], v[196:199], v[36:39], v[52:55]
  v_mfma_f32_16x16x32_bf16 v[60:63], v[208:211], v[40:43], 0
  v_mfma_f32_16x16x32_bf16 v[60:63], v[204:207], v[44:47], v[60:63]
  s_waitcnt vmcnt(17) lgkmcnt(0)
  v_mfma_f32_16x16x32_bf16 v[64:67], v[172:175], a[96:99], v[64:67]
  s_barrier
  v_mfma_f32_16x16x32_bf16 v[64:67], v[176:179], a[128:131], v[64:67]
  ds_read_b64_tr_b16 v[160:161], v17 offset:24576
  ds_read_b64_tr_b16 v[162:163], v17 offset:26624
  v_mfma_f32_16x16x32_bf16 v[64:67], v[180:183], a[160:163], v[64:67]
  buffer_atomic_add v3, v222, s[24:27], s83 offen sc1
  v_mfma_f32_16x16x32_bf16 v[68:71], v[180:183], a[164:167], v[68:71]
  s_add_u32 m0, s82, 126592
  ds_read_b64_tr_b16 v[164:165], v18 offset:28672
  ds_read_b64_tr_b16 v[166:167], v18 offset:30720
  v_mfma_f32_16x16x32_bf16 v[68:71], v[176:179], a[132:135], v[68:71]
  buffer_load_dwordx4 v6, s[20:23], s69 offen offset:384 lds
  v_mfma_f32_16x16x32_bf16 v[68:71], v[172:175], a[100:103], v[68:71]
  v_add_f32 v196, v48, v56
  v_sub_f32 v204, v48, v56
  v_mfma_f32_16x16x32_bf16 v[72:75], v[172:175], a[104:107], v[72:75]
  ds_read_b64_tr_b16 v[168:169], v18 offset:24576
  ds_read_b64_tr_b16 v[170:171], v18 offset:26624
  v_mfma_f32_16x16x32_bf16 v[72:75], v[176:179], a[136:139], v[72:75]
  v_add_f32 v197, v49, v57
  v_sub_f32 v205, v49, v57
  v_mfma_f32_16x16x32_bf16 v[72:75], v[180:183], a[168:171], v[72:75]
  s_add_u32 m0, s82, 122496
  v_add_f32 v198, v50, v58
  v_sub_f32 v206, v50, v58
  v_mfma_f32_16x16x32_bf16 v[76:79], v[180:183], a[172:175], v[76:79]
  buffer_load_dwordx4 v6, s[20:23], s70 offen offset:384 lds
  v_mfma_f32_16x16x32_bf16 v[76:79], v[176:179], a[140:143], v[76:79]
  v_add_f32 v199, v51, v59
  v_sub_f32 v207, v51, v59
  v_mfma_f32_16x16x32_bf16 v[76:79], v[172:175], a[108:111], v[76:79]
  v_add_f32 v200, v52, v60
  v_sub_f32 v208, v52, v60
  v_mfma_f32_16x16x32_bf16 v[80:83], v[172:175], a[112:115], v[80:83]
  v_add_f32 v201, v53, v61
  v_sub_f32 v209, v53, v61
  v_mfma_f32_16x16x32_bf16 v[80:83], v[176:179], a[144:147], v[80:83]
  v_add_f32 v202, v54, v62
  v_sub_f32 v210, v54, v62
  v_mfma_f32_16x16x32_bf16 v[80:83], v[180:183], a[176:179], v[80:83]
  s_add_u32 m0, s82, 93824
  v_add_f32 v203, v55, v63
  v_sub_f32 v211, v55, v63
  v_mfma_f32_16x16x32_bf16 v[84:87], v[180:183], a[180:183], v[84:87]
  buffer_load_dwordx4 v6, s[20:23], s71 offen offset:384 lds
  v_mfma_f32_16x16x32_bf16 v[84:87], v[176:179], a[148:151], v[84:87]
  v_cvt_pk_bf16_f32 v196, v196, v197
  v_cvt_pk_bf16_f32 v197, v198, v199
  v_mfma_f32_16x16x32_bf16 v[84:87], v[172:175], a[116:119], v[84:87]
  v_cvt_pk_bf16_f32 v198, v200, v201
  v_cvt_pk_bf16_f32 v199, v202, v203
  v_mfma_f32_16x16x32_bf16 v[88:91], v[172:175], a[120:123], v[88:91]
  buffer_store_dwordx4 v[196:199], v21, s[24:27], s100 offen sc1
  v_mfma_f32_16x16x32_bf16 v[88:91], v[176:179], a[152:155], v[88:91]
  s_add_u32 m0, s82, 32768
  v_mfma_f32_16x16x32_bf16 v[88:91], v[180:183], a[184:187], v[88:91]
  buffer_load_dwordx4 v4, s[24:27], m0 offen sc1 lds
  v_mfma_f32_16x16x32_bf16 v[92:95], v[180:183], a[188:191], v[92:95]
  s_add_u32 s100, s100, 36864
  v_cvt_pk_bf16_f32 v204, v204, v205
  v_cvt_pk_bf16_f32 v205, v206, v207
  v_mfma_f32_16x16x32_bf16 v[92:95], v[176:179], a[156:159], v[92:95]
  v_cvt_pk_bf16_f32 v206, v208, v209
  v_cvt_pk_bf16_f32 v207, v210, v211
  v_mfma_f32_16x16x32_bf16 v[92:95], v[172:175], a[124:127], v[92:95]
  s_waitcnt lgkmcnt(0)
  v_mfma_f32_16x16x32_bf16 v[64:67], v[160:163], a[192:195], v[64:67]
  s_barrier
  v_mfma_f32_16x16x32_bf16 v[64:67], v[164:167], a[224:227], v[64:67]
  ds_read_b64_tr_b16 v[172:173], v18 offset:20480
  ds_read_b64_tr_b16 v[174:175], v18 offset:22528
  v_mfma_f32_16x16x32_bf16 v[64:67], v[168:171], v[224:227], v[64:67]
  buffer_store_dwordx4 v[204:207], v21, s[24:27], s100 offen sc1
  v_mfma_f32_16x16x32_bf16 v[68:71], v[168:171], v[228:231], v[68:71]
  s_add_u32 m0, s82, 159360
  ds_read_b64_tr_b16 v[176:177], v17 offset:53248
  ds_read_b64_tr_b16 v[178:179], v17 offset:55296
  v_mfma_f32_16x16x32_bf16 v[68:71], v[164:167], a[228:231], v[68:71]
  buffer_load_dwordx4 v6, s[20:23], s72 offen offset:384 lds
  v_mfma_f32_16x16x32_bf16 v[68:71], v[160:163], a[196:199], v[68:71]
  v_mfma_f32_16x16x32_bf16 v[72:75], v[160:163], a[200:203], v[72:75]
  ds_read_b64_tr_b16 v[180:181], v17 offset:49152
  ds_read_b64_tr_b16 v[182:183], v17 offset:51200
  v_mfma_f32_16x16x32_bf16 v[72:75], v[164:167], a[232:235], v[72:75]
  v_mfma_f32_16x16x32_bf16 v[72:75], v[168:171], v[232:235], v[72:75]
  s_add_u32 m0, s82, 155264
  v_mfma_f32_16x16x32_bf16 v[76:79], v[168:171], v[236:239], v[76:79]
  buffer_load_dwordx4 v6, s[20:23], s73 offen offset:384 lds
  v_mfma_f32_16x16x32_bf16 v[76:79], v[164:167], a[236:239], v[76:79]
  v_mfma_f32_16x16x32_bf16 v[76:79], v[160:163], a[204:207], v[76:79]
  v_mfma_f32_16x16x32_bf16 v[80:83], v[160:163], a[208:211], v[80:83]
  v_mfma_f32_16x16x32_bf16 v[80:83], v[164:167], a[240:243], v[80:83]
  v_mfma_f32_16x16x32_bf16 v[80:83], v[168:171], v[240:243], v[80:83]
  s_add_u32 m0, s82, 89728
  v_mfma_f32_16x16x32_bf16 v[84:87], v[168:171], v[244:247], v[84:87]
  buffer_load_dwordx4 v6, s[20:23], s74 offen offset:384 lds
  v_mfma_f32_16x16x32_bf16 v[84:87], v[164:167], a[244:247], v[84:87]
  v_mfma_f32_16x16x32_bf16 v[84:87], v[160:163], a[212:215], v[84:87]
  v_mfma_f32_16x16x32_bf16 v[88:91], v[160:163], a[216:219], v[88:91]
  v_mfma_f32_16x16x32_bf16 v[88:91], v[164:167], a[248:251], v[88:91]
  s_add_u32 m0, s82, 36864
  v_mfma_f32_16x16x32_bf16 v[88:91], v[168:171], v[248:251], v[88:91]
  buffer_load_dwordx4 v4, s[24:27], m0 offen sc1 lds
  v_mfma_f32_16x16x32_bf16 v[92:95], v[168:171], v[252:255], v[92:95]
  v_mfma_f32_16x16x32_bf16 v[92:95], v[164:167], a[252:255], v[92:95]
  v_mfma_f32_16x16x32_bf16 v[92:95], v[160:163], a[220:223], v[92:95]
  s_cmp_lt_u32 s95, 16
  s_cbranch_scc0 L_od2_gated_mix__spectral_gfnet__swiglu_ffn__prompt_kernel
L_d2_gated_mix__spectral_gfnet__swiglu_ffn__prompt_kernel:
  s_waitcnt vmcnt(24) lgkmcnt(0)
  v_mfma_f32_16x16x32_bf16 v[128:131], v[172:175], a[0:3], 0
  s_barrier
  v_mfma_f32_16x16x32_bf16 v[128:131], v[176:179], a[32:35], v[128:131]
  s_and_b32 s92, s80, 3
  ds_read_b64_tr_b16 v[160:161], v18 offset:16384
  ds_read_b64_tr_b16 v[162:163], v18 offset:18432
  v_mfma_f32_16x16x32_bf16 v[128:131], v[180:183], a[64:67], v[128:131]
  s_lshl_b32 s92, s92, 4
  v_mfma_f32_16x16x32_bf16 v[132:135], v[180:183], a[68:71], 0
  s_add_u32 m0, s82, 151552
  ds_read_b64_tr_b16 v[164:165], v17 offset:45056
  ds_read_b64_tr_b16 v[166:167], v17 offset:47104
  v_mfma_f32_16x16x32_bf16 v[132:135], v[176:179], a[36:39], v[132:135]
  buffer_load_dwordx4 v6, s[20:23], s48 offen lds
  v_mfma_f32_16x16x32_bf16 v[132:135], v[172:175], a[4:7], v[132:135]
  s_lshl_b32 s75, s79, 7
  v_mfma_f32_16x16x32_bf16 v[136:139], v[172:175], a[8:11], 0
  s_add_u32 s75, s75, 6424832
  ds_read_b64_tr_b16 v[168:169], v17 offset:40960
  ds_read_b64_tr_b16 v[170:171], v17 offset:43008
  v_mfma_f32_16x16x32_bf16 v[136:139], v[176:179], a[40:43], v[136:139]
  s_add_u32 m0, s82, 118784
  v_mfma_f32_16x16x32_bf16 v[136:139], v[180:183], a[72:75], v[136:139]
  buffer_load_dwordx4 v6, s[20:23], s49 offen lds
  v_mfma_f32_16x16x32_bf16 v[140:143], v[180:183], a[76:79], 0
  s_cmp_eq_u32 s81, 0
  s_cselect_b32 s77, 16, 0
  v_mfma_f32_16x16x32_bf16 v[140:143], v[176:179], a[44:47], v[140:143]
  s_lshr_b32 s78, s80, 2
  v_mfma_f32_16x16x32_bf16 v[140:143], v[172:175], a[12:15], v[140:143]
  s_add_u32 m0, s82, 114688
  v_mfma_f32_16x16x32_bf16 v[144:147], v[172:175], a[16:19], 0
  buffer_load_dwordx4 v6, s[20:23], s50 offen lds
  v_mfma_f32_16x16x32_bf16 v[144:147], v[176:179], a[48:51], v[144:147]
  s_lshl_b32 s6, s79, 2
  v_mfma_f32_16x16x32_bf16 v[144:147], v[180:183], a[80:83], v[144:147]
  s_add_u32 s6, s6, s78
  v_mfma_f32_16x16x32_bf16 v[148:151], v[180:183], a[84:87], 0
  s_add_u32 m0, s82, 85888
  v_mfma_f32_16x16x32_bf16 v[148:151], v[176:179], a[52:55], v[148:151]
  buffer_load_dwordx4 v6, s[20:23], s48 offen offset:128 lds
  v_mfma_f32_16x16x32_bf16 v[148:151], v[172:175], a[20:23], v[148:151]
  s_mul_i32 s6, s6, 36864
  v_mfma_f32_16x16x32_bf16 v[152:155], v[172:175], a[24:27], 0
  s_add_u32 s6, s6, 50331648
  v_add_u32 v5, s6, v21
  v_mfma_f32_16x16x32_bf16 v[152:155], v[176:179], a[56:59], v[152:155]
  s_add_u32 m0, s82, 40960
  v_mfma_f32_16x16x32_bf16 v[152:155], v[180:183], a[88:91], v[152:155]
  buffer_load_dwordx4 v4, s[24:27], m0 offen sc1 lds
  v_mfma_f32_16x16x32_bf16 v[156:159], v[180:183], a[92:95], 0
  s_and_b32 s93, s80, 1
  v_mfma_f32_16x16x32_bf16 v[156:159], v[176:179], a[60:63], v[156:159]
  s_lshl_b32 s93, s93, 2
  v_mfma_f32_16x16x32_bf16 v[156:159], v[172:175], a[28:31], v[156:159]
  s_waitcnt vmcnt(22) lgkmcnt(0)
  v_mfma_f32_16x16x32_bf16 v[128:131], v[160:163], a[96:99], v[128:131]
  s_barrier
  v_mfma_f32_16x16x32_bf16 v[128:131], v[164:167], a[128:131], v[128:131]
  s_lshl_b32 s45, s45, 1
  ds_read_b64_tr_b16 v[172:173], v18 offset:12288
  ds_read_b64_tr_b16 v[174:175], v18 offset:14336
  v_mfma_f32_16x16x32_bf16 v[128:131], v[168:171], a[160:163], v[128:131]
  buffer_load_dword v220, v222, s[24:27], s101 offen sc1
  v_mfma_f32_16x16x32_bf16 v[132:135], v[168:171], a[164:167], v[132:135]
  s_add_u32 m0, s82, 147328
  ds_read_b64_tr_b16 v[176:177], v17 offset:36864
  ds_read_b64_tr_b16 v[178:179], v17 offset:38912
  v_mfma_f32_16x16x32_bf16 v[132:135], v[164:167], a[132:135], v[132:135]
  buffer_load_dwordx4 v6, s[20:23], s49 offen offset:128 lds
  v_mfma_f32_16x16x32_bf16 v[132:135], v[160:163], a[100:103], v[132:135]
  s_add_u32 s93, s93, s87
  v_mfma_f32_16x16x32_bf16 v[136:139], v[160:163], a[104:107], v[136:139]
  s_lshl_b32 s93, s93, 2
  ds_read_b64_tr_b16 v[180:181], v17 offset:32768
  ds_read_b64_tr_b16 v[182:183], v17 offset:34816
  v_mfma_f32_16x16x32_bf16 v[136:139], v[164:167], a[136:139], v[136:139]
  s_add_u32 m0, s82, 110464
  v_mfma_f32_16x16x32_bf16 v[136:139], v[168:171], a[168:171], v[136:139]
  buffer_load_dwordx4 v6, s[20:23], s50 offen offset:128 lds
  v_mfma_f32_16x16x32_bf16 v[140:143], v[168:171], a[172:175], v[140:143]
  s_and_b32 s84, s80, 2
  v_mfma_f32_16x16x32_bf16 v[140:143], v[164:167], a[140:143], v[140:143]
  s_add_u32 s93, s93, s84
  v_mfma_f32_16x16x32_bf16 v[140:143], v[160:163], a[108:111], v[140:143]
  s_add_u32 m0, s82, 106496
  v_mfma_f32_16x16x32_bf16 v[144:147], v[160:163], a[112:115], v[144:147]
  buffer_load_dwordx4 v6, s[20:23], s51 offen lds
  v_mfma_f32_16x16x32_bf16 v[144:147], v[164:167], a[144:147], v[144:147]
  s_add_u32 s93, s93, s88
  v_mfma_f32_16x16x32_bf16 v[144:147], v[168:171], a[176:179], v[144:147]
  s_lshl_b32 s93, s93, 4
  v_add_u32 v10, s93, v1
  v_add_u32 v11, 0x80, v10
  v_mfma_f32_16x16x32_bf16 v[148:151], v[168:171], a[180:183], v[148:151]
  s_add_u32 m0, s82, 81920
  v_add_u32 v12, s92, v1
  v_add_u32 v12, 0x200, v12
  v_mfma_f32_16x16x32_bf16 v[148:151], v[164:167], a[148:151], v[148:151]
  buffer_load_dwordx4 v6, s[20:23], s52 offen lds
  v_mfma_f32_16x16x32_bf16 v[148:151], v[160:163], a[116:119], v[148:151]
  v_and_b32 v15, 1, v1
  v_lshlrev_b32 v15, 31, v15
  v_mfma_f32_16x16x32_bf16 v[152:155], v[160:163], a[120:123], v[152:155]
  v_or_b32 v15, 0.5, v15
  v_lshlrev_b32 v13, 2, v2
  v_mfma_f32_16x16x32_bf16 v[152:155], v[164:167], a[152:155], v[152:155]
  s_add_u32 m0, s82, 45056
  v_cvt_f32_u32 v13, v13
  v_mfma_f32_16x16x32_bf16 v[152:155], v[168:171], a[184:187], v[152:155]
  buffer_load_dwordx4 v4, s[24:27], m0 offen sc1 lds
  v_mfma_f32_16x16x32_bf16 v[156:159], v[168:171], a[188:191], v[156:159]
  s_mul_i32 s84, s81, 80
  v_cvt_f32_u32 v14, s84
  v_add_f32 v14, v14, v13
  v_mfma_f32_16x16x32_bf16 v[156:159], v[164:167], a[156:159], v[156:159]
  v_cvt_f32_u32 v10, v10
  v_mul_f32 v7, 0x3ce38e39, v10
  v_mfma_f32_16x16x32_bf16 v[156:159], v[160:163], a[124:127], v[156:159]
  s_waitcnt vmcnt(11) lgkmcnt(0)
  v_cvt_f32_u32 v11, v11
  v_mul_f32 v8, 0x3ce38e39, v11
  v_mfma_f32_16x16x32_bf16 v[128:131], v[172:175], a[192:195], v[128:131]
  s_barrier
  v_mfma_f32_16x16x32_bf16 v[128:131], v[176:179], a[224:227], v[128:131]
  ds_read_b64_tr_b16 v[160:161], v18 offset:8192
  ds_read_b64_tr_b16 v[162:163], v18 offset:10240
  v_mfma_f32_16x16x32_bf16 v[128:131], v[180:183], v[224:227], v[128:131]
  buffer_atomic_add v3, v222, s[24:27], s75 offen sc1
  v_mfma_f32_16x16x32_bf16 v[132:135], v[180:183], v[228:231], v[132:135]
  s_add_u32 m0, s82, 143360
  ds_read_b64_tr_b16 v[164:165], v18 offset:4096
  ds_read_b64_tr_b16 v[166:167], v18 offset:6144
  v_mfma_f32_16x16x32_bf16 v[132:135], v[176:179], a[228:231], v[132:135]
  buffer_load_dwordx4 v6, s[20:23], s53 offen lds
  v_mfma_f32_16x16x32_bf16 v[132:135], v[172:175], a[196:199], v[132:135]
  v_cvt_f32_u32 v12, v12
  v_mul_f32 v9, 0x3ce38e39, v12
  v_mfma_f32_16x16x32_bf16 v[136:139], v[172:175], a[200:203], v[136:139]
  ds_read_b64_tr_b16 v[168:169], v18 offset:0
  ds_read_b64_tr_b16 v[170:171], v18 offset:2048
  v_mfma_f32_16x16x32_bf16 v[136:139], v[176:179], a[232:235], v[136:139]
  v_cos_f32 v7, v7
  v_mfma_f32_16x16x32_bf16 v[136:139], v[180:183], v[232:235], v[136:139]
  s_add_u32 m0, s82, 102400
  v_cos_f32 v8, v8
  v_mfma_f32_16x16x32_bf16 v[140:143], v[180:183], v[236:239], v[140:143]
  buffer_load_dwordx4 v6, s[20:23], s54 offen lds
  v_mfma_f32_16x16x32_bf16 v[140:143], v[176:179], a[236:239], v[140:143]
  v_cos_f32 v9, v9
  v_mfma_f32_16x16x32_bf16 v[140:143], v[172:175], a[204:207], v[140:143]
  v_mul_f32 v10, 0x3ae38e39, v10
  v_add_f32 v7, v7, v7
  v_mfma_f32_16x16x32_bf16 v[144:147], v[172:175], a[208:211], v[144:147]
  v_mul_f32 v11, 0x3ae38e39, v11
  v_add_f32 v8, v8, v8
  v_mfma_f32_16x16x32_bf16 v[144:147], v[176:179], a[240:243], v[144:147]
  v_mul_f32 v12, 0x3ae38e39, v12
  v_add_f32 v9, v9, v9
  v_mfma_f32_16x16x32_bf16 v[144:147], v[180:183], v[240:243], v[144:147]
  s_add_u32 m0, s82, 98304
  v_lshrrev_b32 v28, 2, v1
  v_cmp_eq_u32 vcc, v28, v2
  v_mfma_f32_16x16x32_bf16 v[148:151], v[180:183], v[244:247], v[148:151]
  buffer_load_dwordx4 v6, s[20:23], s55 offen lds
  v_mfma_f32_16x16x32_bf16 v[148:151], v[176:179], a[244:247], v[148:151]
  v_and_b32 v29, 1, v1
  v_lshlrev_b32 v29, 4, v29
  v_mfma_f32_16x16x32_bf16 v[148:151], v[172:175], a[212:215], v[148:151]
  v_mov_b32 v28, 0x3f80
  v_lshlrev_b32 v29, v29, v28
  v_mfma_f32_16x16x32_bf16 v[152:155], v[172:175], a[216:219], v[152:155]
  v_cndmask_b32 v29, 0, v29, vcc
  v_and_b32 v28, 2, v1
  v_mfma_f32_16x16x32_bf16 v[152:155], v[176:179], a[248:251], v[152:155]
  s_add_u32 m0, s82, 77824
  v_cmp_eq_u32 vcc, 0, v28
  v_mov_b32 v24, 0
  v_mfma_f32_16x16x32_bf16 v[152:155], v[180:183], v[248:251], v[152:155]
  buffer_load_dwordx4 v6, s[20:23], s56 offen lds
  v_mfma_f32_16x16x32_bf16 v[156:159], v[180:183], v[252:255], v[156:159]
  v_mov_b32 v25, 0
  v_cndmask_b32 v26, 0, v29, vcc
  v_mfma_f32_16x16x32_bf16 v[156:159], v[176:179], a[252:255], v[156:159]
  v_cndmask_b32 v27, v29, 0, vcc
  v_mov_b32 v28, 0
  v_mfma_f32_16x16x32_bf16 v[156:159], v[172:175], a[220:223], v[156:159]
  v_mov_b32 v29, 0
  s_waitcnt vmcnt(10)
  v_readfirstlane_b32 s91, v220
  s_nop 1
  s_cmp_ge_u32 s91, s45
  s_cbranch_scc0 L_spq2_gated_mix__spectral_gfnet__swiglu_ffn__prompt_kernel
L_bkq2_gated_mix__spectral_gfnet__swiglu_ffn__prompt_kernel:
  s_waitcnt lgkmcnt(0)
  v_mfma_f32_16x16x32_bf16 v[32:35], v[160:163], a[0:3], 0
  s_barrier
  v_mfma_f32_16x16x32_bf16 v[32:35], v[164:167], a[32:35], v[32:35]
  ds_read_b64_tr_b16 v[172:173], v17 offset:61440
  ds_read_b64_tr_b16 v[174:175], v17 offset:63488
  v_mfma_f32_16x16x32_bf16 v[32:35], v[168:171], a[64:67], v[32:35]
  s_add_u32 m0, s82, 139136
  v_mfma_f32_16x16x32_bf16 v[36:39], v[168:171], a[68:71], 0
  buffer_load_dwordx4 v6, s[20:23], s51 offen offset:128 lds
  v_mfma_f32_16x16x32_bf16 v[36:39], v[164:167], a[36:39], v[36:39]
  ds_read_b64_tr_b16 v[176:177], v17 offset:57344
  ds_read_b64_tr_b16 v[178:179], v17 offset:59392
  v_mfma_f32_16x16x32_bf16 v[36:39], v[160:163], a[4:7], v[36:39]
  s_add_u32 m0, s82, 135040
  v_mfma_f32_16x16x32_bf16 v[40:43], v[160:163], a[8:11], 0
  buffer_load_dwordx4 v6, s[20:23], s52 offen offset:128 lds
  v_mfma_f32_16x16x32_bf16 v[40:43], v[164:167], a[40:43], v[40:43]
  ds_read_b64_tr_b16 v[180:181], v17 offset:28672
  ds_read_b64_tr_b16 v[182:183], v17 offset:30720
  v_mfma_f32_16x16x32_bf16 v[40:43], v[168:171], a[72:75], v[40:43]
  s_add_u32 m0, s82, 130944
  v_mfma_f32_16x16x32_bf16 v[44:47], v[168:171], a[76:79], 0
  buffer_load_dwordx4 v6, s[20:23], s53 offen offset:128 lds
  v_mfma_f32_16x16x32_bf16 v[44:47], v[164:167], a[44:47], v[44:47]
  v_mfma_f32_16x16x32_bf16 v[44:47], v[160:163], a[12:15], v[44:47]
  s_add_u32 m0, s82, 73600
  v_mfma_f32_16x16x32_bf16 v[48:51], v[160:163], a[16:19], 0
  buffer_load_dwordx4 v6, s[20:23], s54 offen offset:128 lds
  v_mfma_f32_16x16x32_bf16 v[48:51], v[164:167], a[48:51], v[48:51]
  v_mfma_f32_16x16x32_bf16 v[48:51], v[168:171], a[80:83], v[48:51]
  s_add_u32 m0, s82, 49152
  v_mfma_f32_16x16x32_bf16 v[52:55], v[168:171], a[84:87], 0
  buffer_load_dwordx4 v4, s[24:27], m0 offen sc1 lds
  v_mfma_f32_16x16x32_bf16 v[52:55], v[164:167], a[52:55], v[52:55]
  v_mfma_f32_16x16x32_bf16 v[52:55], v[160:163], a[20:23], v[52:55]
  s_add_u32 m0, s82, 53248
  v_mfma_f32_16x16x32_bf16 v[56:59], v[160:163], a[24:27], 0
  buffer_load_dwordx4 v4, s[24:27], m0 offen sc1 lds
  v_mfma_f32_16x16x32_bf16 v[56:59], v[164:167], a[56:59], v[56:59]
  v_mfma_f32_16x16x32_bf16 v[56:59], v[168:171], a[88:91], v[56:59]
  s_add_u32 m0, s82, 57344
  v_mfma_f32_16x16x32_bf16 v[60:63], v[168:171], a[92:95], 0
  buffer_load_dwordx4 v4, s[24:27], m0 offen sc1 lds
  v_mfma_f32_16x16x32_bf16 v[60:63], v[164:167], a[60:63], v[60:63]
  v_mfma_f32_16x16x32_bf16 v[60:63], v[160:163], a[28:31], v[60:63]
  s_waitcnt lgkmcnt(0)
  v_mfma_f32_16x16x32_bf16 v[32:35], v[172:175], a[96:99], v[32:35]
  s_barrier
  v_mfma_f32_16x16x32_bf16 v[32:35], v[176:179], a[128:131], v[32:35]
  ds_read_b64_tr_b16 v[160:161], v18 offset:28672
  ds_read_b64_tr_b16 v[162:163], v18 offset:30720
  v_mfma_f32_16x16x32_bf16 v[32:35], v[180:183], a[160:163], v[32:35]
  s_add_u32 m0, s82, 126848
  ds_read_b128 a[0:3], v21 offset:0
  v_mfma_f32_16x16x32_bf16 v[36:39], v[180:183], a[164:167], v[36:39]
  buffer_load_dwordx4 v6, s[20:23], s55 offen offset:128 lds
  v_mfma_f32_16x16x32_bf16 v[36:39], v[176:179], a[132:135], v[36:39]
  ds_read_b64_tr_b16 v[164:165], v18 offset:24576
  ds_read_b64_tr_b16 v[166:167], v18 offset:26624
  v_mfma_f32_16x16x32_bf16 v[36:39], v[172:175], a[100:103], v[36:39]
  ds_read_b128 a[4:7], v21 offset:1024
  v_mfma_f32_16x16x32_bf16 v[40:43], v[172:175], a[104:107], v[40:43]
  s_add_u32 m0, s82, 122752
  ds_read_b64_tr_b16 v[168:169], v17 offset:24576
  ds_read_b64_tr_b16 v[170:171], v17 offset:26624
  v_mfma_f32_16x16x32_bf16 v[40:43], v[176:179], a[136:139], v[40:43]
  buffer_load_dwordx4 v6, s[20:23], s56 offen offset:128 lds
  v_mfma_f32_16x16x32_bf16 v[40:43], v[180:183], a[168:171], v[40:43]
  ds_read_b128 a[8:11], v21 offset:2048
  v_mfma_f32_16x16x32_bf16 v[44:47], v[180:183], a[172:175], v[44:47]
  s_add_u32 m0, s82, 93952
  ds_read_b128 a[12:15], v21 offset:3072
  v_mfma_f32_16x16x32_bf16 v[44:47], v[176:179], a[140:143], v[44:47]
  buffer_load_dwordx4 v6, s[20:23], s48 offen offset:256 lds
  v_mfma_f32_16x16x32_bf16 v[44:47], v[172:175], a[108:111], v[44:47]
  ds_read_b128 a[16:19], v21 offset:4096
  v_mfma_f32_16x16x32_bf16 v[48:51], v[172:175], a[112:115], v[48:51]
  ds_read_b128 a[20:23], v21 offset:5120
  v_mfma_f32_16x16x32_bf16 v[48:51], v[176:179], a[144:147], v[48:51]
  s_add_u32 m0, s82, 61440
  ds_read_b128 a[24:27], v21 offset:6144
  v_mfma_f32_16x16x32_bf16 v[48:51], v[180:183], a[176:179], v[48:51]
  buffer_load_dwordx4 v4, s[24:27], m0 offen sc1 lds
  v_mfma_f32_16x16x32_bf16 v[52:55], v[180:183], a[180:183], v[52:55]
  ds_read_b128 a[28:31], v21 offset:7168
  v_mfma_f32_16x16x32_bf16 v[52:55], v[176:179], a[148:151], v[52:55]
  s_add_u32 m0, s82, 65536
  ds_read_b128 a[32:35], v21 offset:8192
  v_mfma_f32_16x16x32_bf16 v[52:55], v[172:175], a[116:119], v[52:55]
  buffer_load_dwordx4 v4, s[24:27], m0 offen sc1 lds
  v_mfma_f32_16x16x32_bf16 v[56:59], v[172:175], a[120:123], v[56:59]
  ds_read_b128 a[36:39], v21 offset:9216
  v_mfma_f32_16x16x32_bf16 v[56:59], v[176:179], a[152:155], v[56:59]
  ds_read_b128 a[40:43], v21 offset:10240
  ds_read_b128 a[44:47], v21 offset:11264
  v_mfma_f32_16x16x32_bf16 v[56:59], v[180:183], a[184:187], v[56:59]
  s_add_u32 m0, s82, 69632
  v_mfma_f32_16x16x32_bf16 v[60:63], v[180:183], a[188:191], v[60:63]
  buffer_load_dwordx4 v4, s[24:27], m0 offen sc1 lds
  v_mfma_f32_16x16x32_bf16 v[60:63], v[176:179], a[156:159], v[60:63]
  v_mfma_f32_16x16x32_bf16 v[60:63], v[172:175], a[124:127], v[60:63]
  s_waitcnt vmcnt(18) lgkmcnt(10)
  v_mfma_f32_16x16x32_bf16 v[32:35], v[160:163], a[192:195], v[32:35]
  s_barrier
  v_mfma_f32_16x16x32_bf16 v[32:35], v[164:167], a[224:227], v[32:35]
  ds_read_b64_tr_b16 v[172:173], v18 offset:20480
  ds_read_b64_tr_b16 v[174:175], v18 offset:22528
  ds_read_b128 a[48:51], v21 offset:12288
  v_mfma_f32_16x16x32_bf16 v[32:35], v[168:171], v[224:227], v[32:35]
  ds_read_b128 a[52:55], v21 offset:13312
  v_mfma_f32_16x16x32_bf16 v[36:39], v[168:171], v[228:231], v[36:39]
  ds_read_b64_tr_b16 v[176:177], v17 offset:53248
  ds_read_b64_tr_b16 v[178:179], v17 offset:55296
  ds_read_b128 a[56:59], v21 offset:14336
  v_mfma_f32_16x16x32_bf16 v[36:39], v[164:167], a[228:231], v[36:39]
  s_add_u32 m0, s82, 159488
  ds_read_b128 a[60:63], v21 offset:15360
  v_mfma_f32_16x16x32_bf16 v[36:39], v[160:163], a[196:199], v[36:39]
  buffer_load_dwordx4 v6, s[20:23], s49 offen offset:256 lds
  v_mfma_f32_16x16x32_bf16 v[40:43], v[160:163], a[200:203], v[40:43]
  ds_read_b64_tr_b16 v[180:181], v17 offset:49152
  ds_read_b64_tr_b16 v[182:183], v17 offset:51200
  v_mfma_f32_16x16x32_bf16 v[40:43], v[164:167], a[232:235], v[40:43]
  ds_read_b128 a[64:67], v21 offset:16384
  v_mfma_f32_16x16x32_bf16 v[40:43], v[168:171], v[232:235], v[40:43]
  ds_read_b128 a[68:71], v21 offset:17408
  v_mfma_f32_16x16x32_bf16 v[44:47], v[168:171], v[236:239], v[44:47]
  ds_read_b128 a[72:75], v21 offset:18432
  v_mfma_f32_16x16x32_bf16 v[44:47], v[164:167], a[236:239], v[44:47]
  ds_read_b128 a[76:79], v21 offset:19456
  v_mfma_f32_16x16x32_bf16 v[44:47], v[160:163], a[204:207], v[44:47]
  s_add_u32 m0, s82, 155392
  ds_read_b128 a[80:83], v21 offset:20480
  v_mfma_f32_16x16x32_bf16 v[48:51], v[160:163], a[208:211], v[48:51]
  buffer_load_dwordx4 v6, s[20:23], s50 offen offset:256 lds
  buffer_load_dword v218, v222, s[24:27], s75 offen sc1
  v_mfma_f32_16x16x32_bf16 v[48:51], v[164:167], a[240:243], v[48:51]
  ds_read_b128 a[84:87], v21 offset:21504
  v_mfma_f32_16x16x32_bf16 v[48:51], v[168:171], v[240:243], v[48:51]
  ds_read_b128 a[88:91], v21 offset:22528
  v_mfma_f32_16x16x32_bf16 v[52:55], v[168:171], v[244:247], v[52:55]
  ds_read_b128 a[92:95], v21 offset:23552
  v_mfma_f32_16x16x32_bf16 v[52:55], v[164:167], a[244:247], v[52:55]
  ds_read_b128 a[96:99], v21 offset:24576
  v_mfma_f32_16x16x32_bf16 v[52:55], v[160:163], a[212:215], v[52:55]
  ds_read_b128 a[100:103], v21 offset:25600
  v_mfma_f32_16x16x32_bf16 v[56:59], v[160:163], a[216:219], v[56:59]
  s_add_u32 m0, s82, 89856
  ds_read_b128 a[104:107], v21 offset:26624
  v_mfma_f32_16x16x32_bf16 v[56:59], v[164:167], a[248:251], v[56:59]
  buffer_load_dwordx4 v6, s[20:23], s51 offen offset:256 lds
  ds_read_b128 a[108:111], v21 offset:27648
  v_mfma_f32_16x16x32_bf16 v[56:59], v[168:171], v[248:251], v[56:59]
  v_mfma_f32_16x16x32_bf16 v[60:63], v[168:171], v[252:255], v[60:63]
  v_mfma_f32_16x16x32_bf16 v[60:63], v[164:167], a[252:255], v[60:63]
  v_mfma_f32_16x16x32_bf16 v[60:63], v[160:163], a[220:223], v[60:63]
  s_waitcnt lgkmcnt(4)
  v_mfma_f32_16x16x32_bf16 v[96:99], v[172:175], a[0:3], v[96:99]
  s_barrier
  v_mfma_f32_16x16x32_bf16 v[96:99], v[176:179], a[32:35], v[96:99]
  ds_read_b64_tr_b16 v[160:161], v17 offset:20480
  ds_read_b64_tr_b16 v[162:163], v17 offset:22528
  ds_read_b128 a[112:115], v21 offset:28672
  v_mfma_f32_16x16x32_bf16 v[96:99], v[180:183], a[64:67], v[96:99]
  ds_read_b128 a[116:119], v21 offset:29696
  v_mfma_f32_16x16x32_bf16 v[100:103], v[180:183], a[68:71], v[100:103]
  ds_read_b64_tr_b16 v[164:165], v18 offset:16384
  ds_read_b64_tr_b16 v[166:167], v18 offset:18432
  ds_read_b128 a[120:123], v21 offset:30720
  v_mfma_f32_16x16x32_bf16 v[100:103], v[176:179], a[36:39], v[100:103]
  s_add_u32 m0, s82, 151296
  ds_read_b128 a[124:127], v21 offset:31744
  v_mfma_f32_16x16x32_bf16 v[100:103], v[172:175], a[4:7], v[100:103]
  buffer_load_dwordx4 v6, s[20:23], s52 offen offset:256 lds
  v_mfma_f32_16x16x32_bf16 v[104:107], v[172:175], a[8:11], v[104:107]
  ds_read_b64_tr_b16 v[168:169], v17 offset:45056
  ds_read_b64_tr_b16 v[170:171], v17 offset:47104
  v_mfma_f32_16x16x32_bf16 v[104:107], v[176:179], a[40:43], v[104:107]
  ds_read_b128 a[128:131], v21 offset:32768
  v_mfma_f32_16x16x32_bf16 v[104:107], v[180:183], a[72:75], v[104:107]
  ds_read_b128 a[132:135], v21 offset:33792
  v_mfma_f32_16x16x32_bf16 v[108:111], v[180:183], a[76:79], v[108:111]
  ds_read_b128 a[136:139], v21 offset:34816
  v_mfma_f32_16x16x32_bf16 v[108:111], v[176:179], a[44:47], v[108:111]
  ds_read_b128 a[140:143], v21 offset:35840
  v_mfma_f32_16x16x32_bf16 v[108:111], v[172:175], a[12:15], v[108:111]
  s_add_u32 m0, s82, 118528
  ds_read_b128 a[144:147], v21 offset:36864
  v_mfma_f32_16x16x32_bf16 v[112:115], v[172:175], a[16:19], v[112:115]
  buffer_load_dwordx4 v6, s[20:23], s53 offen offset:256 lds
  v_mfma_f32_16x16x32_bf16 v[112:115], v[176:179], a[48:51], v[112:115]
  ds_read_b128 a[148:151], v21 offset:37888
  v_mfma_f32_16x16x32_bf16 v[112:115], v[180:183], a[80:83], v[112:115]
  ds_read_b128 a[152:155], v21 offset:38912
  v_mfma_f32_16x16x32_bf16 v[116:119], v[180:183], a[84:87], v[116:119]
  ds_read_b128 a[156:159], v21 offset:39936
  v_mfma_f32_16x16x32_bf16 v[116:119], v[176:179], a[52:55], v[116:119]
  ds_read_b128 a[160:163], v21 offset:40960
  v_mfma_f32_16x16x32_bf16 v[116:119], v[172:175], a[20:23], v[116:119]
  ds_read_b128 a[164:167], v21 offset:41984
  v_mfma_f32_16x16x32_bf16 v[120:123], v[172:175], a[24:27], v[120:123]
  s_add_u32 m0, s82, 114432
  ds_read_b128 a[168:171], v21 offset:43008
  v_mfma_f32_16x16x32_bf16 v[120:123], v[176:179], a[56:59], v[120:123]
  buffer_load_dwordx4 v6, s[20:23], s54 offen offset:256 lds
  ds_read_b128 a[172:175], v21 offset:44032
  v_mfma_f32_16x16x32_bf16 v[120:123], v[180:183], a[88:91], v[120:123]
  v_mfma_f32_16x16x32_bf16 v[124:127], v[180:183], a[92:95], v[124:127]
  v_mfma_f32_16x16x32_bf16 v[124:127], v[176:179], a[60:63], v[124:127]
  v_mfma_f32_16x16x32_bf16 v[124:127], v[172:175], a[28:31], v[124:127]
  s_waitcnt vmcnt(7) lgkmcnt(12)
  v_mfma_f32_16x16x32_bf16 v[64:67], v[160:163], a[0:3], v[64:67]
  s_barrier
  v_mfma_f32_16x16x32_bf16 v[64:67], v[164:167], a[32:35], v[64:67]
  ds_read_b64_tr_b16 v[172:173], v17 offset:40960
  ds_read_b64_tr_b16 v[174:175], v17 offset:43008
  ds_read_b128 a[176:179], v21 offset:45056
  v_mfma_f32_16x16x32_bf16 v[64:67], v[168:171], a[64:67], v[64:67]
  ds_read_b128 a[180:183], v21 offset:46080
  v_mfma_f32_16x16x32_bf16 v[68:71], v[168:171], a[68:71], v[68:71]
  ds_read_b64_tr_b16 v[176:177], v17 offset:16384
  ds_read_b64_tr_b16 v[178:179], v17 offset:18432
  ds_read_b128 a[184:187], v21 offset:47104
  v_mfma_f32_16x16x32_bf16 v[68:71], v[164:167], a[36:39], v[68:71]
  s_add_u32 m0, s82, 147200
  ds_read_b128 a[188:191], v21 offset:48128
  v_mfma_f32_16x16x32_bf16 v[68:71], v[160:163], a[4:7], v[68:71]
  buffer_load_dwordx4 v6, s[20:23], s55 offen offset:256 lds
  v_mfma_f32_16x16x32_bf16 v[72:75], v[160:163], a[8:11], v[72:75]
  s_and_b32 s6, s80, 3
  ds_read_b64_tr_b16 v[180:181], v18 offset:12288
  ds_read_b64_tr_b16 v[182:183], v18 offset:14336
  v_mfma_f32_16x16x32_bf16 v[72:75], v[164:167], a[40:43], v[72:75]
  ds_read_b128 a[192:195], v21 offset:49152
  v_mfma_f32_16x16x32_bf16 v[72:75], v[168:171], a[72:75], v[72:75]
  ds_read_b128 a[196:199], v21 offset:50176
  v_mfma_f32_16x16x32_bf16 v[76:79], v[168:171], a[76:79], v[76:79]
  ds_read_b128 a[200:203], v21 offset:51200
  v_mfma_f32_16x16x32_bf16 v[76:79], v[164:167], a[44:47], v[76:79]
  ds_read_b128 a[204:207], v21 offset:52224
  v_mfma_f32_16x16x32_bf16 v[76:79], v[160:163], a[12:15], v[76:79]
  s_add_u32 m0, s82, 110336
  ds_read_b128 a[208:211], v21 offset:53248
  v_mfma_f32_16x16x32_bf16 v[80:83], v[160:163], a[16:19], v[80:83]
  buffer_load_dwordx4 v6, s[20:23], s56 offen offset:256 lds
  v_mfma_f32_16x16x32_bf16 v[80:83], v[164:167], a[48:51], v[80:83]
  ds_read_b128 a[212:215], v21 offset:54272
  s_lshl_b32 s6, s6, 2
  v_mfma_f32_16x16x32_bf16 v[80:83], v[168:171], a[80:83], v[80:83]
  ds_read_b128 a[216:219], v21 offset:55296
  v_mfma_f32_16x16x32_bf16 v[84:87], v[168:171], a[84:87], v[84:87]
  ds_read_b128 a[220:223], v21 offset:56320
  s_add_u32 s6, s6, s78
  v_mfma_f32_16x16x32_bf16 v[84:87], v[164:167], a[52:55], v[84:87]
  ds_read_b128 a[224:227], v21 offset:57344
  v_mfma_f32_16x16x32_bf16 v[84:87], v[160:163], a[20:23], v[84:87]
  ds_read_b128 a[228:231], v21 offset:58368
  s_lshl_b32 s7, s79, 4
  v_mfma_f32_16x16x32_bf16 v[88:91], v[160:163], a[24:27], v[88:91]
  s_add_u32 m0, s82, 85632
  v_mfma_f32_16x16x32_bf16 v[88:91], v[164:167], a[56:59], v[88:91]
  buffer_load_dwordx4 v6, s[20:23], s48 offen offset:384 lds
  v_mfma_f32_16x16x32_bf16 v[88:91], v[168:171], a[88:91], v[88:91]
  s_add_u32 s6, s6, s7
  v_mfma_f32_16x16x32_bf16 v[92:95], v[168:171], a[92:95], v[92:95]
  s_lshl_b32 s6, s6, 2
  v_mfma_f32_16x16x32_bf16 v[92:95], v[164:167], a[60:63], v[92:95]
  s_add_u32 s6, s6, s81
  v_mfma_f32_16x16x32_bf16 v[92:95], v[160:163], a[28:31], v[92:95]
  s_lshl_b32 s6, s6, 12
  s_waitcnt vmcnt(7)
  v_readfirstlane_b32 s91, v218
  s_nop 1
  s_cmp_ge_u32 s91, s77
  s_cbranch_scc0 L_sp8_gated_mix__spectral_gfnet__swiglu_ffn__prompt_kernel
L_bk8_gated_mix__spectral_gfnet__swiglu_ffn__prompt_kernel:
  s_waitcnt lgkmcnt(10)
  v_mfma_f32_16x16x32_bf16 v[96:99], v[172:175], a[96:99], v[96:99]
  s_barrier
  v_mfma_f32_16x16x32_bf16 v[96:99], v[176:179], a[128:131], v[96:99]
  ds_read_b64_tr_b16 v[160:161], v17 offset:36864
  ds_read_b64_tr_b16 v[162:163], v17 offset:38912
  ds_read_b128 a[232:235], v21 offset:59392
  v_mfma_f32_16x16x32_bf16 v[96:99], v[180:183], a[160:163], v[96:99]
  ds_read_b128 a[236:239], v21 offset:60416
  v_mfma_f32_16x16x32_bf16 v[100:103], v[180:183], a[164:167], v[100:103]
  s_add_u32 s6, s6, 29360128
  ds_read_b64_tr_b16 v[164:165], v17 offset:32768
  ds_read_b64_tr_b16 v[166:167], v17 offset:34816
  v_mfma_f32_16x16x32_bf16 v[100:103], v[176:179], a[132:135], v[100:103]
  s_add_u32 m0, s82, 142976
  ds_read_b128 a[240:243], v21 offset:61440
  v_mfma_f32_16x16x32_bf16 v[100:103], v[172:175], a[100:103], v[100:103]
  buffer_load_dwordx4 v6, s[20:23], s49 offen offset:384 lds
  v_mfma_f32_16x16x32_bf16 v[104:107], v[172:175], a[104:107], v[104:107]
  s_lshl_b32 s84, s79, 9
  ds_read_b64_tr_b16 v[168:169], v17 offset:12288
  ds_read_b64_tr_b16 v[170:171], v17 offset:14336
  v_mfma_f32_16x16x32_bf16 v[104:107], v[176:179], a[136:139], v[104:107]
  ds_read_b128 a[244:247], v21 offset:62464
  v_mfma_f32_16x16x32_bf16 v[104:107], v[180:183], a[168:171], v[104:107]
  ds_read_b128 a[248:251], v21 offset:63488
  v_mfma_f32_16x16x32_bf16 v[108:111], v[180:183], a[172:175], v[108:111]
  ds_read_b128 a[252:255], v21 offset:64512
  v_mfma_f32_16x16x32_bf16 v[108:111], v[176:179], a[140:143], v[108:111]
  ds_read_b128 v[224:227], v22 offset:0
  v_mfma_f32_16x16x32_bf16 v[108:111], v[172:175], a[108:111], v[108:111]
  s_add_u32 m0, s82, 106112
  ds_read_b128 v[228:231], v22 offset:1024
  v_mfma_f32_16x16x32_bf16 v[112:115], v[172:175], a[112:115], v[112:115]
  buffer_load_dwordx4 v6, s[20:23], s50 offen offset:384 lds
  v_mfma_f32_16x16x32_bf16 v[112:115], v[176:179], a[144:147], v[112:115]
  ds_read_b128 v[232:235], v22 offset:2048
  v_mfma_f32_16x16x32_bf16 v[112:115], v[180:183], a[176:179], v[112:115]
  ds_read_b128 v[236:239], v22 offset:3072
  v_mfma_f32_16x16x32_bf16 v[116:119], v[180:183], a[180:183], v[116:119]
  ds_read_b128 v[240:243], v22 offset:4096
  v_mfma_f32_16x16x32_bf16 v[116:119], v[176:179], a[148:151], v[116:119]
  ds_read_b128 v[244:247], v22 offset:5120
  v_mfma_f32_16x16x32_bf16 v[116:119], v[172:175], a[116:119], v[116:119]
  ds_read_b128 v[248:251], v22 offset:6144
  v_mfma_f32_16x16x32_bf16 v[120:123], v[172:175], a[120:123], v[120:123]
  s_add_u32 m0, s82, 81536
  ds_read_b128 v[252:255], v22 offset:7168
  v_mfma_f32_16x16x32_bf16 v[120:123], v[176:179], a[152:155], v[120:123]
  buffer_load_dwordx4 v6, s[20:23], s51 offen offset:384 lds
  v_mfma_f32_16x16x32_bf16 v[120:123], v[180:183], a[184:187], v[120:123]
  buffer_load_dwordx4 v[196:199], v21, s[24:27], s6 offen offset:0 sc1
  v_mfma_f32_16x16x32_bf16 v[124:127], v[180:183], a[188:191], v[124:127]
  s_lshl_b32 s85, s78, 7
  v_mfma_f32_16x16x32_bf16 v[124:127], v[176:179], a[156:159], v[124:127]
  s_add_u32 s84, s84, s85
  v_mfma_f32_16x16x32_bf16 v[124:127], v[172:175], a[124:127], v[124:127]
  s_waitcnt lgkmcnt(0)
  v_mfma_f32_16x16x32_bf16 v[96:99], v[160:163], a[192:195], v[96:99]
  s_barrier
  v_mfma_f32_16x16x32_bf16 v[96:99], v[164:167], a[224:227], v[96:99]
  s_add_u32 s84, s84, 6291456
  ds_read_b64_tr_b16 v[172:173], v18 offset:8192
  ds_read_b64_tr_b16 v[174:175], v18 offset:10240
  v_mfma_f32_16x16x32_bf16 v[96:99], v[168:171], v[224:227], v[96:99]
  s_add_u32 m0, s82, 102016
  v_mfma_f32_16x16x32_bf16 v[100:103], v[168:171], v[228:231], v[100:103]
  buffer_load_dwordx4 v6, s[20:23], s52 offen offset:384 lds
  v_mfma_f32_16x16x32_bf16 v[100:103], v[164:167], a[228:231], v[100:103]
  s_add_u32 s85, s84, 8192
  ds_read_b64_tr_b16 v[176:177], v18 offset:4096
  ds_read_b64_tr_b16 v[178:179], v18 offset:6144
  v_lshlrev_b32 v30, 2, v1
  v_mfma_f32_16x16x32_bf16 v[100:103], v[160:163], a[196:199], v[100:103]
  buffer_load_dwordx4 v[200:203], v21, s[24:27], s6 offen offset:1024 sc1
  v_mfma_f32_16x16x32_bf16 v[104:107], v[160:163], a[200:203], v[104:107]
  s_add_u32 m0, s82, 97920
  ds_read_b64_tr_b16 v[180:181], v18 offset:0
  ds_read_b64_tr_b16 v[182:183], v18 offset:2048
  v_mfma_f32_16x16x32_bf16 v[104:107], v[164:167], a[232:235], v[104:107]
  buffer_load_dwordx4 v6, s[20:23], s53 offen offset:384 lds
  v_mfma_f32_16x16x32_bf16 v[104:107], v[168:171], v[232:235], v[104:107]
  s_mov_b32 s90, 0x800000
  v_cvt_pk_bf16_f32 v96, v96, v97
  v_cvt_pk_bf16_f32 v97, v98, v99
  v_cvt_pk_bf16_f32 v98, v100, v101
  v_mfma_f32_16x16x32_bf16 v[108:111], v[168:171], v[236:239], v[108:111]
  s_add_u32 m0, s82, 77440
  v_cvt_pk_bf16_f32 v99, v102, v103
  v_mfma_f32_16x16x32_bf16 v[108:111], v[164:167], a[236:239], v[108:111]
  buffer_load_dwordx4 v6, s[20:23], s54 offen offset:384 lds
  v_mfma_f32_16x16x32_bf16 v[108:111], v[160:163], a[204:207], v[108:111]
  buffer_load_dwordx4 v[204:207], v21, s[24:27], s6 offen offset:2048 sc1
  v_mfma_f32_16x16x32_bf16 v[112:115], v[160:163], a[208:211], v[112:115]
  buffer_store_dwordx4 v[96:99], v23, s[24:27], s90 offen sc1
  v_mfma_f32_16x16x32_bf16 v[112:115], v[164:167], a[240:243], v[112:115]
  s_add_u32 m0, s82, 0
  v_mfma_f32_16x16x32_bf16 v[112:115], v[168:171], v[240:243], v[112:115]
  buffer_load_dwordx4 v5, s[24:27], m0 offen sc1 lds
  v_mfma_f32_16x16x32_bf16 v[116:119], v[168:171], v[244:247], v[116:119]
  buffer_load_dword v212, v30, s[24:27], s84 offen sc1
  v_mfma_f32_16x16x32_bf16 v[116:119], v[164:167], a[244:247], v[116:119]
  s_add_u32 m0, s82, 4096
  buffer_load_dwordx4 v[208:211], v21, s[24:27], s6 offen offset:3072 sc1
  v_mfma_f32_16x16x32_bf16 v[116:119], v[160:163], a[212:215], v[116:119]
  buffer_load_dwordx4 v5, s[24:27], m0 offen sc1 lds
  v_mfma_f32_16x16x32_bf16 v[120:123], v[160:163], a[216:219], v[120:123]
  s_mov_b32 s90, 0x802000
  v_cvt_pk_bf16_f32 v104, v104, v105
  v_cvt_pk_bf16_f32 v105, v106, v107
  v_cvt_pk_bf16_f32 v106, v108, v109
  v_cvt_pk_bf16_f32 v107, v110, v111
  v_mfma_f32_16x16x32_bf16 v[120:123], v[164:167], a[248:251], v[120:123]
  buffer_store_dwordx4 v[104:107], v23, s[24:27], s90 offen sc1
  v_mfma_f32_16x16x32_bf16 v[120:123], v[168:171], v[248:251], v[120:123]
  s_add_u32 m0, s82, 8192
  v_mfma_f32_16x16x32_bf16 v[124:127], v[168:171], v[252:255], v[124:127]
  buffer_load_dwordx4 v5, s[24:27], m0 offen sc1 lds
  v_mfma_f32_16x16x32_bf16 v[124:127], v[164:167], a[252:255], v[124:127]
  buffer_load_dword v213, v30, s[24:27], s84 offen offset:64 sc1
  v_mfma_f32_16x16x32_bf16 v[124:127], v[160:163], a[220:223], v[124:127]
  s_waitcnt lgkmcnt(0)
  v_mfma_f32_16x16x32_bf16 v[64:67], v[172:175], a[96:99], v[64:67]
  s_barrier
  v_mfma_f32_16x16x32_bf16 v[64:67], v[176:179], a[128:131], v[64:67]
  s_mov_b32 s90, 0x804000
  ds_read_b64_tr_b16 v[160:161], v17 offset:8192
  ds_read_b64_tr_b16 v[162:163], v17 offset:10240
  v_cvt_pk_bf16_f32 v112, v112, v113
  v_mfma_f32_16x16x32_bf16 v[64:67], v[180:183], a[160:163], v[64:67]
  buffer_load_dword v214, v30, s[24:27], s85 offen sc1
  v_mfma_f32_16x16x32_bf16 v[68:71], v[180:183], a[164:167], v[68:71]
  s_add_u32 m0, s82, 138880
  ds_read_b64_tr_b16 v[164:165], v17 offset:61440
  ds_read_b64_tr_b16 v[166:167], v17 offset:63488
  v_cvt_pk_bf16_f32 v113, v114, v115
  v_mfma_f32_16x16x32_bf16 v[68:71], v[176:179], a[132:135], v[68:71]
  buffer_load_dwordx4 v6, s[20:23], s55 offen offset:384 lds
  v_mfma_f32_16x16x32_bf16 v[68:71], v[172:175], a[100:103], v[68:71]
  buffer_load_dword v215, v30, s[24:27], s85 offen offset:64 sc1
  v_mfma_f32_16x16x32_bf16 v[72:75], v[172:175], a[104:107], v[72:75]
  ds_read_b64_tr_b16 v[168:169], v17 offset:57344
  ds_read_b64_tr_b16 v[170:171], v17 offset:59392
  v_cvt_pk_bf16_f32 v114, v116, v117
  v_mfma_f32_16x16x32_bf16 v[72:75], v[176:179], a[136:139], v[72:75]
  s_add_u32 m0, s82, 134784
  v_cvt_pk_bf16_f32 v115, v118, v119
  v_mfma_f32_16x16x32_bf16 v[72:75], v[180:183], a[168:171], v[72:75]
  buffer_load_dwordx4 v6, s[20:23], s56 offen offset:384 lds
  v_mfma_f32_16x16x32_bf16 v[76:79], v[180:183], a[172:175], v[76:79]
  buffer_store_dwordx4 v[112:115], v23, s[24:27], s90 offen sc1
  v_mfma_f32_16x16x32_bf16 v[76:79], v[176:179], a[140:143], v[76:79]
  s_mov_b32 s90, 0x806000
  v_cvt_pk_bf16_f32 v120, v120, v121
  v_cvt_pk_bf16_f32 v121, v122, v123
  v_cvt_pk_bf16_f32 v122, v124, v125
  v_cvt_pk_bf16_f32 v123, v126, v127
  v_mfma_f32_16x16x32_bf16 v[76:79], v[172:175], a[108:111], v[76:79]
  s_add_u32 m0, s82, 12288
  v_mfma_f32_16x16x32_bf16 v[80:83], v[172:175], a[112:115], v[80:83]
  buffer_load_dwordx4 v5, s[24:27], m0 offen sc1 lds
  v_mfma_f32_16x16x32_bf16 v[80:83], v[176:179], a[144:147], v[80:83]
  buffer_store_dwordx4 v[120:123], v23, s[24:27], s90 offen sc1
  v_mfma_f32_16x16x32_bf16 v[80:83], v[180:183], a[176:179], v[80:83]
  s_lshl_b32 s6, s79, 1
  v_add_f32 v96, 0x00000000, v13
  v_add_f32 v97, 0x3f800000, v13
  v_mfma_f32_16x16x32_bf16 v[84:87], v[180:183], a[180:183], v[84:87]
  s_add_u32 m0, s82, 16384
  v_add_f32 v98, 0x40000000, v13
  v_add_f32 v99, 0x40400000, v13
  v_mfma_f32_16x16x32_bf16 v[84:87], v[176:179], a[148:151], v[84:87]
  buffer_load_dwordx4 v5, s[24:27], m0 offen sc1 lds
  v_mfma_f32_16x16x32_bf16 v[84:87], v[172:175], a[116:119], v[84:87]
  s_and_b32 s7, s80, 1
  v_fma_f32 v100, v96, v10, s94
  v_mul_f32 v96, v96, v10
  v_mfma_f32_16x16x32_bf16 v[88:91], v[172:175], a[120:123], v[88:91]
  s_add_u32 s6, s6, s7
  v_fma_f32 v101, v97, v10, s94
  v_mul_f32 v97, v97, v10
  v_mfma_f32_16x16x32_bf16 v[88:91], v[176:179], a[152:155], v[88:91]
  s_add_u32 m0, s82, 20480
  v_fma_f32 v102, v98, v10, s94
  v_mul_f32 v98, v98, v10
  v_mfma_f32_16x16x32_bf16 v[88:91], v[180:183], a[184:187], v[88:91]
  buffer_load_dwordx4 v5, s[24:27], m0 offen sc1 lds
  v_mfma_f32_16x16x32_bf16 v[92:95], v[180:183], a[188:191], v[92:95]
  s_lshl_b32 s75, s6, 7
  v_fma_f32 v103, v99, v10, s94
  v_mul_f32 v99, v99, v10
  v_mfma_f32_16x16x32_bf16 v[92:95], v[176:179], a[156:159], v[92:95]
  s_add_u32 s75, s75, 6430976
  v_cos_f32 v96, v96
  v_mfma_f32_16x16x32_bf16 v[92:95], v[172:175], a[124:127], v[92:95]
  s_waitcnt lgkmcnt(0)
  v_cos_f32 v97, v97
  v_mfma_f32_16x16x32_bf16 v[64:67], v[160:163], a[192:195], v[64:67]
  s_barrier
  v_mfma_f32_16x16x32_bf16 v[64:67], v[164:167], a[224:227], v[64:67]
  s_lshr_b32 s77, s77, 1
  ds_read_b64_tr_b16 v[172:173], v17 offset:28672
  ds_read_b64_tr_b16 v[174:175], v17 offset:30720
  v_mfma_f32_16x16x32_bf16 v[64:67], v[168:171], v[224:227], v[64:67]
  s_lshl_b32 s83, s6, 2
  v_cos_f32 v98, v98
  v_mfma_f32_16x16x32_bf16 v[68:71], v[168:171], v[228:231], v[68:71]
  s_add_u32 s83, s83, s87
  ds_read_b64_tr_b16 v[176:177], v18 offset:28672
  ds_read_b64_tr_b16 v[178:179], v18 offset:30720
  v_mfma_f32_16x16x32_bf16 v[68:71], v[164:167], a[228:231], v[68:71]
  s_add_u32 m0, s82, 24576
  v_cos_f32 v99, v99
  v_mfma_f32_16x16x32_bf16 v[68:71], v[160:163], a[196:199], v[68:71]
  buffer_load_dwordx4 v5, s[24:27], m0 offen sc1 lds
  v_mfma_f32_16x16x32_bf16 v[72:75], v[160:163], a[200:203], v[72:75]
  s_lshl_b32 s83, s83, 2
  ds_read_b64_tr_b16 v[180:181], v18 offset:24576
  ds_read_b64_tr_b16 v[182:183], v18 offset:26624
  v_mfma_f32_16x16x32_bf16 v[72:75], v[164:167], a[232:235], v[72:75]
  s_and_b32 s7, s80, 2
  v_cos_f32 v100, v100
  v_mfma_f32_16x16x32_bf16 v[72:75], v[168:171], v[232:235], v[72:75]
  s_mov_b32 s90, 0x820000
  v_cvt_pk_bf16_f32 v64, v64, v65
  v_cvt_pk_bf16_f32 v65, v66, v67
  v_mfma_f32_16x16x32_bf16 v[76:79], v[168:171], v[236:239], v[76:79]
  v_cvt_pk_bf16_f32 v66, v68, v69
  v_cvt_pk_bf16_f32 v67, v70, v71
  v_mfma_f32_16x16x32_bf16 v[76:79], v[164:167], a[236:239], v[76:79]
  buffer_store_dwordx4 v[64:67], v23, s[24:27], s90 offen sc1
  v_mfma_f32_16x16x32_bf16 v[76:79], v[160:163], a[204:207], v[76:79]
  s_add_u32 m0, s82, 28672
  v_cos_f32 v101, v101
  v_mfma_f32_16x16x32_bf16 v[80:83], v[160:163], a[208:211], v[80:83]
  buffer_load_dwordx4 v5, s[24:27], m0 offen sc1 lds
  v_mfma_f32_16x16x32_bf16 v[80:83], v[164:167], a[240:243], v[80:83]
  s_add_u32 s83, s83, s7
  v_cos_f32 v102, v102
  v_mfma_f32_16x16x32_bf16 v[80:83], v[168:171], v[240:243], v[80:83]
  s_add_u32 s83, s83, s88
  v_cos_f32 v103, v103
  v_mfma_f32_16x16x32_bf16 v[84:87], v[168:171], v[244:247], v[84:87]
  s_lshl_b32 s83, s83, 2
  v_add_f32 v104, 0x41800000, v13
  v_add_f32 v105, 0x41880000, v13
  v_mfma_f32_16x16x32_bf16 v[84:87], v[164:167], a[244:247], v[84:87]
  s_mov_b32 s90, 0x822000
  v_cvt_pk_bf16_f32 v72, v72, v73
  v_cvt_pk_bf16_f32 v73, v74, v75
  v_mfma_f32_16x16x32_bf16 v[84:87], v[160:163], a[212:215], v[84:87]
  v_cvt_pk_bf16_f32 v74, v76, v77
  v_cvt_pk_bf16_f32 v75, v78, v79
  v_mfma_f32_16x16x32_bf16 v[88:91], v[160:163], a[216:219], v[88:91]
  s_add_u32 m0, s82, 32768
  v_add_f32 v106, 0x41900000, v13
  v_add_f32 v107, 0x41980000, v13
  v_mfma_f32_16x16x32_bf16 v[88:91], v[164:167], a[248:251], v[88:91]
  buffer_load_dwordx4 v5, s[24:27], m0 offen sc1 lds
  v_mfma_f32_16x16x32_bf16 v[88:91], v[168:171], v[248:251], v[88:91]
  buffer_store_dwordx4 v[72:75], v23, s[24:27], s90 offen sc1
  v_mfma_f32_16x16x32_bf16 v[92:95], v[168:171], v[252:255], v[92:95]
  s_add_u32 s83, s83, s78
  v_fma_f32 v108, v104, v10, s94
  v_mul_f32 v104, v104, v10
  v_mfma_f32_16x16x32_bf16 v[92:95], v[164:167], a[252:255], v[92:95]
  s_lshl_b32 s83, s83, 13
  v_fma_f32 v109, v105, v10, s94
  v_mul_f32 v105, v105, v10
  v_mfma_f32_16x16x32_bf16 v[92:95], v[160:163], a[220:223], v[92:95]
  s_waitcnt vmcnt(35) lgkmcnt(0)
  v_fma_f32 v110, v106, v10, s94
  v_mul_f32 v106, v106, v10
  v_mfma_f32_16x16x32_bf16 v[128:131], v[172:175], a[0:3], v[128:131]
  s_barrier
  v_mfma_f32_16x16x32_bf16 v[128:131], v[176:179], a[32:35], v[128:131]
  s_mov_b32 s90, 0x824000
  ds_read_b64_tr_b16 v[160:161], v17 offset:24576
  ds_read_b64_tr_b16 v[162:163], v17 offset:26624
  v_mfma_f32_16x16x32_bf16 v[128:131], v[180:183], a[64:67], v[128:131]
  v_cvt_pk_bf16_f32 v80, v80, v81
  v_cvt_pk_bf16_f32 v81, v82, v83
  v_mfma_f32_16x16x32_bf16 v[132:135], v[180:183], a[68:71], v[132:135]
  s_add_u32 s83, s83, 8388608
  ds_read_b64_tr_b16 v[164:165], v18 offset:20480
  ds_read_b64_tr_b16 v[166:167], v18 offset:22528
  v_mfma_f32_16x16x32_bf16 v[132:135], v[176:179], a[36:39], v[132:135]
  v_cvt_pk_bf16_f32 v82, v84, v85
  v_cvt_pk_bf16_f32 v83, v86, v87
  v_mfma_f32_16x16x32_bf16 v[132:135], v[172:175], a[4:7], v[132:135]
  ds_read_b64_tr_b16 v[168:169], v17 offset:53248
  ds_read_b64_tr_b16 v[170:171], v17 offset:55296
  v_mfma_f32_16x16x32_bf16 v[136:139], v[172:175], a[8:11], v[136:139]
  buffer_store_dwordx4 v[80:83], v23, s[24:27], s90 offen sc1
  v_mfma_f32_16x16x32_bf16 v[136:139], v[176:179], a[40:43], v[136:139]
  v_fma_f32 v111, v107, v10, s94
  v_mul_f32 v107, v107, v10
  v_mfma_f32_16x16x32_bf16 v[136:139], v[180:183], a[72:75], v[136:139]
  s_mov_b32 s90, 0x826000
  v_cvt_pk_bf16_f32 v88, v88, v89
  v_cvt_pk_bf16_f32 v89, v90, v91
  v_mfma_f32_16x16x32_bf16 v[140:143], v[180:183], a[76:79], v[140:143]
  v_cvt_pk_bf16_f32 v90, v92, v93
  v_cvt_pk_bf16_f32 v91, v94, v95
  v_mfma_f32_16x16x32_bf16 v[140:143], v[176:179], a[44:47], v[140:143]
  buffer_store_dwordx4 v[88:91], v23, s[24:27], s90 offen sc1
  v_mfma_f32_16x16x32_bf16 v[140:143], v[172:175], a[12:15], v[140:143]
  v_cos_f32 v104, v104
  v_mfma_f32_16x16x32_bf16 v[144:147], v[172:175], a[16:19], v[144:147]
  v_cos_f32 v105, v105
  v_mfma_f32_16x16x32_bf16 v[144:147], v[176:179], a[48:51], v[144:147]
  v_cos_f32 v106, v106
  v_mfma_f32_16x16x32_bf16 v[144:147], v[180:183], a[80:83], v[144:147]
  v_cos_f32 v107, v107
  v_mfma_f32_16x16x32_bf16 v[148:151], v[180:183], a[84:87], v[148:151]
  v_cos_f32 v108, v108
  v_mfma_f32_16x16x32_bf16 v[148:151], v[176:179], a[52:55], v[148:151]
  v_cos_f32 v109, v109
  v_mfma_f32_16x16x32_bf16 v[148:151], v[172:175], a[20:23], v[148:151]
  v_cos_f32 v110, v110
  v_mfma_f32_16x16x32_bf16 v[152:155], v[172:175], a[24:27], v[152:155]
  v_cos_f32 v111, v111
  v_mfma_f32_16x16x32_bf16 v[152:155], v[176:179], a[56:59], v[152:155]
  v_add_f32 v112, 0x00000000, v13
  v_add_f32 v113, 0x3f800000, v13
  v_mfma_f32_16x16x32_bf16 v[152:155], v[180:183], a[88:91], v[152:155]
  v_add_f32 v114, 0x40000000, v13
  v_add_f32 v115, 0x40400000, v13
  v_mfma_f32_16x16x32_bf16 v[156:159], v[180:183], a[92:95], v[156:159]
  v_fma_f32 v116, v112, v11, s94
  v_mul_f32 v112, v112, v11
  v_mfma_f32_16x16x32_bf16 v[156:159], v[176:179], a[60:63], v[156:159]
  v_fma_f32 v117, v113, v11, s94
  v_mul_f32 v113, v113, v11
  v_mfma_f32_16x16x32_bf16 v[156:159], v[172:175], a[28:31], v[156:159]
  s_waitcnt vmcnt(34) lgkmcnt(0)
  v_fma_f32 v118, v114, v11, s94
  v_mul_f32 v114, v114, v11
  v_mfma_f32_16x16x32_bf16 v[128:131], v[160:163], a[96:99], v[128:131]
  s_barrier
  v_mfma_f32_16x16x32_bf16 v[128:131], v[164:167], a[128:131], v[128:131]
  ds_read_b64_tr_b16 v[172:173], v17 offset:49152
  ds_read_b64_tr_b16 v[174:175], v17 offset:51200
  v_mfma_f32_16x16x32_bf16 v[128:131], v[168:171], a[160:163], v[128:131]
  v_fma_f32 v119, v115, v11, s94
  v_mul_f32 v115, v115, v11
  v_mfma_f32_16x16x32_bf16 v[132:135], v[168:171], a[164:167], v[132:135]
  ds_read_b64_tr_b16 v[176:177], v18 offset:16384
  ds_read_b64_tr_b16 v[178:179], v18 offset:18432
  v_mfma_f32_16x16x32_bf16 v[132:135], v[164:167], a[132:135], v[132:135]
  v_cos_f32 v112, v112
  v_mfma_f32_16x16x32_bf16 v[132:135], v[160:163], a[100:103], v[132:135]
  ds_read_b64_tr_b16 v[180:181], v17 offset:45056
  ds_read_b64_tr_b16 v[182:183], v17 offset:47104
  v_mfma_f32_16x16x32_bf16 v[136:139], v[160:163], a[104:107], v[136:139]
  v_cos_f32 v113, v113
  v_mfma_f32_16x16x32_bf16 v[136:139], v[164:167], a[136:139], v[136:139]
  v_cos_f32 v114, v114
  v_mfma_f32_16x16x32_bf16 v[136:139], v[168:171], a[168:171], v[136:139]
  v_cos_f32 v115, v115
  v_mfma_f32_16x16x32_bf16 v[140:143], v[168:171], a[172:175], v[140:143]
  v_cos_f32 v116, v116
  v_mfma_f32_16x16x32_bf16 v[140:143], v[164:167], a[140:143], v[140:143]
  v_cos_f32 v117, v117
  v_mfma_f32_16x16x32_bf16 v[140:143], v[160:163], a[108:111], v[140:143]
  v_cos_f32 v118, v118
  v_mfma_f32_16x16x32_bf16 v[144:147], v[160:163], a[112:115], v[144:147]
  v_cos_f32 v119, v119
  v_mfma_f32_16x16x32_bf16 v[144:147], v[164:167], a[144:147], v[144:147]
  v_add_f32 v120, 0x41800000, v13
  v_add_f32 v121, 0x41880000, v13
  v_mfma_f32_16x16x32_bf16 v[144:147], v[168:171], a[176:179], v[144:147]
  v_add_f32 v122, 0x41900000, v13
  v_add_f32 v123, 0x41980000, v13
  v_mfma_f32_16x16x32_bf16 v[148:151], v[168:171], a[180:183], v[148:151]
  v_fma_f32 v124, v120, v11, s94
  v_mul_f32 v120, v120, v11
  v_mfma_f32_16x16x32_bf16 v[148:151], v[164:167], a[148:151], v[148:151]
  v_fma_f32 v125, v121, v11, s94
  v_mul_f32 v121, v121, v11
  v_mfma_f32_16x16x32_bf16 v[148:151], v[160:163], a[116:119], v[148:151]
  v_fma_f32 v126, v122, v11, s94
  v_mul_f32 v122, v122, v11
  v_mfma_f32_16x16x32_bf16 v[152:155], v[160:163], a[120:123], v[152:155]
  v_fma_f32 v127, v123, v11, s94
  v_mul_f32 v123, v123, v11
  v_mfma_f32_16x16x32_bf16 v[152:155], v[164:167], a[152:155], v[152:155]
  v_cos_f32 v120, v120
  v_mfma_f32_16x16x32_bf16 v[152:155], v[168:171], a[184:187], v[152:155]
  v_cos_f32 v121, v121
  v_mfma_f32_16x16x32_bf16 v[156:159], v[168:171], a[188:191], v[156:159]
  v_cos_f32 v122, v122
  v_mfma_f32_16x16x32_bf16 v[156:159], v[164:167], a[156:159], v[156:159]
  v_cos_f32 v123, v123
  v_mfma_f32_16x16x32_bf16 v[156:159], v[160:163], a[124:127], v[156:159]
  s_waitcnt vmcnt(31) lgkmcnt(0)
  v_cos_f32 v124, v124
  v_mfma_f32_16x16x32_bf16 v[128:131], v[172:175], a[192:195], v[128:131]
  s_barrier
  v_mfma_f32_16x16x32_bf16 v[128:131], v[176:179], a[224:227], v[128:131]
  ds_read_b64_tr_b16 v[160:161], v17 offset:20480
  ds_read_b64_tr_b16 v[162:163], v17 offset:22528
  v_mfma_f32_16x16x32_bf16 v[128:131], v[180:183], v[224:227], v[128:131]
  v_cos_f32 v125, v125
  v_mfma_f32_16x16x32_bf16 v[132:135], v[180:183], v[228:231], v[132:135]
  ds_read_b64_tr_b16 v[164:165], v18 offset:12288
  ds_read_b64_tr_b16 v[166:167], v18 offset:14336
  v_mfma_f32_16x16x32_bf16 v[132:135], v[176:179], a[228:231], v[132:135]
  v_cos_f32 v126, v126
  v_mfma_f32_16x16x32_bf16 v[132:135], v[172:175], a[196:199], v[132:135]
  ds_read_b64_tr_b16 v[168:169], v17 offset:40960
  ds_read_b64_tr_b16 v[170:171], v17 offset:43008
  v_mfma_f32_16x16x32_bf16 v[136:139], v[172:175], a[200:203], v[136:139]
  v_cos_f32 v127, v127
  v_mfma_f32_16x16x32_bf16 v[136:139], v[176:179], a[232:235], v[136:139]
  v_add_f32 v64, 0x00000000, v14
  v_add_f32 v65, 0x3f800000, v14
  v_mfma_f32_16x16x32_bf16 v[136:139], v[180:183], v[232:235], v[136:139]
  s_mov_b32 s90, 0x840000
  v_cvt_pk_bf16_f32 v128, v128, v129
  v_cvt_pk_bf16_f32 v129, v130, v131
  v_mfma_f32_16x16x32_bf16 v[140:143], v[180:183], v[236:239], v[140:143]
  v_cvt_pk_bf16_f32 v130, v132, v133
  v_cvt_pk_bf16_f32 v131, v134, v135
  v_mfma_f32_16x16x32_bf16 v[140:143], v[176:179], a[236:239], v[140:143]
  buffer_store_dwordx4 v[128:131], v23, s[24:27], s90 offen sc1
  v_mfma_f32_16x16x32_bf16 v[140:143], v[172:175], a[204:207], v[140:143]
  v_add_f32 v66, 0x40000000, v14
  v_add_f32 v67, 0x40400000, v14
  v_mfma_f32_16x16x32_bf16 v[144:147], v[172:175], a[208:211], v[144:147]
  v_fma_f32 v68, v64, v12, s94
  v_mul_f32 v64, v64, v12
  v_mfma_f32_16x16x32_bf16 v[144:147], v[176:179], a[240:243], v[144:147]
  v_fma_f32 v69, v65, v12, s94
  v_mul_f32 v65, v65, v12
  v_mfma_f32_16x16x32_bf16 v[144:147], v[180:183], v[240:243], v[144:147]
  v_fma_f32 v70, v66, v12, s94
  v_mul_f32 v66, v66, v12
  v_mfma_f32_16x16x32_bf16 v[148:151], v[180:183], v[244:247], v[148:151]
  v_fma_f32 v71, v67, v12, s94
  v_mul_f32 v67, v67, v12
  v_mfma_f32_16x16x32_bf16 v[148:151], v[176:179], a[244:247], v[148:151]
  s_mov_b32 s90, 0x842000
  v_cvt_pk_bf16_f32 v136, v136, v137
  v_cvt_pk_bf16_f32 v137, v138, v139
  v_mfma_f32_16x16x32_bf16 v[148:151], v[172:175], a[212:215], v[148:151]
  v_cvt_pk_bf16_f32 v138, v140, v141
  v_cvt_pk_bf16_f32 v139, v142, v143
  v_mfma_f32_16x16x32_bf16 v[152:155], v[172:175], a[216:219], v[152:155]
  buffer_store_dwordx4 v[136:139], v23, s[24:27], s90 offen sc1
  v_mfma_f32_16x16x32_bf16 v[152:155], v[176:179], a[248:251], v[152:155]
  v_cos_f32 v64, v64
  v_mfma_f32_16x16x32_bf16 v[152:155], v[180:183], v[248:251], v[152:155]
  v_cos_f32 v65, v65
  v_mfma_f32_16x16x32_bf16 v[156:159], v[180:183], v[252:255], v[156:159]
  v_cos_f32 v66, v66
  v_mfma_f32_16x16x32_bf16 v[156:159], v[176:179], a[252:255], v[156:159]
  v_cos_f32 v67, v67
  v_mfma_f32_16x16x32_bf16 v[156:159], v[172:175], a[220:223], v[156:159]
  s_waitcnt vmcnt(28) lgkmcnt(0)
  v_cos_f32 v68, v68
  v_mfma_f32_16x16x32_bf16 v[32:35], v[160:163], a[0:3], v[32:35]
  s_barrier
  v_mfma_f32_16x16x32_bf16 v[32:35], v[164:167], a[32:35], v[32:35]
  s_mov_b32 s90, 0x844000
  ds_read_b64_tr_b16 v[172:173], v17 offset:16384
  ds_read_b64_tr_b16 v[174:175], v17 offset:18432
  v_mfma_f32_16x16x32_bf16 v[32:35], v[168:171], a[64:67], v[32:35]
  v_cvt_pk_bf16_f32 v144, v144, v145
  v_cvt_pk_bf16_f32 v145, v146, v147
  v_mfma_f32_16x16x32_bf16 v[36:39], v[168:171], a[68:71], v[36:39]
  ds_read_b64_tr_b16 v[176:177], v17 offset:36864
  ds_read_b64_tr_b16 v[178:179], v17 offset:38912
  v_mfma_f32_16x16x32_bf16 v[36:39], v[164:167], a[36:39], v[36:39]
  v_cvt_pk_bf16_f32 v146, v148, v149
  v_cvt_pk_bf16_f32 v147, v150, v151
  v_mfma_f32_16x16x32_bf16 v[36:39], v[160:163], a[4:7], v[36:39]
  ds_read_b64_tr_b16 v[180:181], v17 offset:32768
  ds_read_b64_tr_b16 v[182:183], v17 offset:34816
  v_mfma_f32_16x16x32_bf16 v[40:43], v[160:163], a[8:11], v[40:43]
  buffer_store_dwordx4 v[144:147], v23, s[24:27], s90 offen sc1
  v_mfma_f32_16x16x32_bf16 v[40:43], v[164:167], a[40:43], v[40:43]
  v_cos_f32 v69, v69
  v_mfma_f32_16x16x32_bf16 v[40:43], v[168:171], a[72:75], v[40:43]
  s_mov_b32 s90, 0x846000
  v_cvt_pk_bf16_f32 v152, v152, v153
  v_cvt_pk_bf16_f32 v153, v154, v155
  v_mfma_f32_16x16x32_bf16 v[44:47], v[168:171], a[76:79], v[44:47]
  v_cvt_pk_bf16_f32 v154, v156, v157
  v_cvt_pk_bf16_f32 v155, v158, v159
  v_mfma_f32_16x16x32_bf16 v[44:47], v[164:167], a[44:47], v[44:47]
  buffer_store_dwordx4 v[152:155], v23, s[24:27], s90 offen sc1
  v_mfma_f32_16x16x32_bf16 v[44:47], v[160:163], a[12:15], v[44:47]
  v_cos_f32 v70, v70
  v_mfma_f32_16x16x32_bf16 v[48:51], v[160:163], a[16:19], v[48:51]
  v_cos_f32 v71, v71
  v_mfma_f32_16x16x32_bf16 v[48:51], v[164:167], a[48:51], v[48:51]
  v_add_f32 v72, 0x41800000, v14
  v_add_f32 v73, 0x41880000, v14
  v_mfma_f32_16x16x32_bf16 v[48:51], v[168:171], a[80:83], v[48:51]
  v_add_f32 v74, 0x41900000, v14
  v_add_f32 v75, 0x41980000, v14
  v_mfma_f32_16x16x32_bf16 v[52:55], v[168:171], a[84:87], v[52:55]
  v_fma_f32 v76, v72, v12, s94
  v_mul_f32 v72, v72, v12
  v_mfma_f32_16x16x32_bf16 v[52:55], v[164:167], a[52:55], v[52:55]
  v_fma_f32 v77, v73, v12, s94
  v_mul_f32 v73, v73, v12
  v_mfma_f32_16x16x32_bf16 v[52:55], v[160:163], a[20:23], v[52:55]
  v_fma_f32 v78, v74, v12, s94
  v_mul_f32 v74, v74, v12
  v_mfma_f32_16x16x32_bf16 v[56:59], v[160:163], a[24:27], v[56:59]
  v_fma_f32 v79, v75, v12, s94
  v_mul_f32 v75, v75, v12
  v_mfma_f32_16x16x32_bf16 v[56:59], v[164:167], a[56:59], v[56:59]
  v_cos_f32 v72, v72
  v_mfma_f32_16x16x32_bf16 v[56:59], v[168:171], a[88:91], v[56:59]
  v_cos_f32 v73, v73
  v_mfma_f32_16x16x32_bf16 v[60:63], v[168:171], a[92:95], v[60:63]
  v_cos_f32 v74, v74
  v_mfma_f32_16x16x32_bf16 v[60:63], v[164:167], a[60:63], v[60:63]
  v_cos_f32 v75, v75
  v_mfma_f32_16x16x32_bf16 v[60:63], v[160:163], a[28:31], v[60:63]
  s_waitcnt vmcnt(4) lgkmcnt(0)
  v_cos_f32 v76, v76
  v_mfma_f32_16x16x32_bf16 v[32:35], v[172:175], a[96:99], v[32:35]
  s_barrier
  v_mfma_f32_16x16x32_bf16 v[32:35], v[176:179], a[128:131], v[32:35]
  ds_read_b64_tr_b16 v[160:161], v17 offset:12288
  ds_read_b64_tr_b16 v[162:163], v17 offset:14336
  v_mfma_f32_16x16x32_bf16 v[32:35], v[180:183], a[160:163], v[32:35]
  buffer_atomic_add v3, v222, s[24:27], s75 offen sc1
  v_mfma_f32_16x16x32_bf16 v[36:39], v[180:183], a[164:167], v[36:39]
  ds_read_b64_tr_b16 v[164:165], v18 offset:8192
  ds_read_b64_tr_b16 v[166:167], v18 offset:10240
  v_mfma_f32_16x16x32_bf16 v[36:39], v[176:179], a[132:135], v[36:39]
  v_cos_f32 v77, v77
  v_mfma_f32_16x16x32_bf16 v[36:39], v[172:175], a[100:103], v[36:39]
  ds_read_b64_tr_b16 v[168:169], v18 offset:4096
  ds_read_b64_tr_b16 v[170:171], v18 offset:6144
  v_mfma_f32_16x16x32_bf16 v[40:43], v[172:175], a[104:107], v[40:43]
  v_cos_f32 v78, v78
  v_mfma_f32_16x16x32_bf16 v[40:43], v[176:179], a[136:139], v[40:43]
  v_cos_f32 v79, v79
  v_mfma_f32_16x16x32_bf16 v[40:43], v[180:183], a[168:171], v[40:43]
  v_cmp_eq_f32 vcc, 0, v13
  v_cvt_pk_bf16_f32 v81, v98, v99
  v_mfma_f32_16x16x32_bf16 v[44:47], v[180:183], a[172:175], v[44:47]
  v_cvt_pk_bf16_f32 v83, v102, v103
  v_cndmask_b32 v80, v96, 0.5, vcc
  v_mfma_f32_16x16x32_bf16 v[44:47], v[176:179], a[140:143], v[44:47]
  v_cndmask_b32 v82, v100, v15, vcc
  v_cvt_pk_bf16_f32 v80, v80, v97
  v_mfma_f32_16x16x32_bf16 v[44:47], v[172:175], a[108:111], v[44:47]
  v_cvt_pk_bf16_f32 v82, v82, v101
  v_cvt_pk_bf16_f32 v84, v104, v105
  v_mfma_f32_16x16x32_bf16 v[48:51], v[172:175], a[112:115], v[48:51]
  v_cvt_pk_bf16_f32 v85, v106, v107
  v_cvt_pk_bf16_f32 v86, v108, v109
  v_mfma_f32_16x16x32_bf16 v[48:51], v[176:179], a[144:147], v[48:51]
  v_cvt_pk_bf16_f32 v87, v110, v111
  v_cmp_eq_f32 vcc, 0, v13
  v_mfma_f32_16x16x32_bf16 v[48:51], v[180:183], a[176:179], v[48:51]
  v_cvt_pk_bf16_f32 v89, v114, v115
  v_cvt_pk_bf16_f32 v91, v118, v119
  v_mfma_f32_16x16x32_bf16 v[52:55], v[180:183], a[180:183], v[52:55]
  v_cndmask_b32 v88, v112, 0.5, vcc
  v_cndmask_b32 v90, v116, v15, vcc
  v_mfma_f32_16x16x32_bf16 v[52:55], v[176:179], a[148:151], v[52:55]
  v_cvt_pk_bf16_f32 v88, v88, v113
  v_cvt_pk_bf16_f32 v90, v90, v117
  v_mfma_f32_16x16x32_bf16 v[52:55], v[172:175], a[116:119], v[52:55]
  v_cvt_pk_bf16_f32 v92, v120, v121
  v_cvt_pk_bf16_f32 v93, v122, v123
  v_mfma_f32_16x16x32_bf16 v[56:59], v[172:175], a[120:123], v[56:59]
  v_cvt_pk_bf16_f32 v94, v124, v125
  v_cvt_pk_bf16_f32 v95, v126, v127
  v_mfma_f32_16x16x32_bf16 v[56:59], v[176:179], a[152:155], v[56:59]
  v_cmp_eq_f32 vcc, 0, v14
  v_cvt_pk_bf16_f32 v185, v66, v67
  v_mfma_f32_16x16x32_bf16 v[56:59], v[180:183], a[184:187], v[56:59]
  v_cvt_pk_bf16_f32 v187, v70, v71
  v_cndmask_b32 v184, v64, 0.5, vcc
  v_mfma_f32_16x16x32_bf16 v[60:63], v[180:183], a[188:191], v[60:63]
  v_cndmask_b32 v186, v68, v15, vcc
  v_cvt_pk_bf16_f32 v184, v184, v65
  v_mfma_f32_16x16x32_bf16 v[60:63], v[176:179], a[156:159], v[60:63]
  v_cvt_pk_bf16_f32 v186, v186, v69
  v_cvt_pk_bf16_f32 v188, v72, v73
  v_mfma_f32_16x16x32_bf16 v[60:63], v[172:175], a[124:127], v[60:63]
  s_waitcnt lgkmcnt(0)
  v_cvt_pk_bf16_f32 v189, v74, v75
  v_cvt_pk_bf16_f32 v190, v76, v77
  v_mfma_f32_16x16x32_bf16 v[32:35], v[160:163], a[192:195], v[32:35]
  s_barrier
  v_mfma_f32_16x16x32_bf16 v[32:35], v[164:167], a[224:227], v[32:35]
  v_cvt_pk_bf16_f32 v191, v78, v79
  v_mul_f32 v212, 0x35e38e39, v212
  v_mfma_f32_16x16x32_bf16 v[32:35], v[168:171], v[224:227], v[32:35]
  v_mul_f32 v213, 0x35e38e39, v213
  v_and_b32 v30, 31, v0
  v_mfma_f32_16x16x32_bf16 v[36:39], v[168:171], v[228:231], v[36:39]
  v_mul_u32_u24 v30, 36864, v30
  v_lshrrev_b32 v31, 5, v0
  v_mfma_f32_16x16x32_bf16 v[36:39], v[164:167], a[228:231], v[36:39]
  v_lshl_add_u32 v30, v31, 4, v30
  s_and_b32 s84, s78, 1
  v_mfma_f32_16x16x32_bf16 v[36:39], v[160:163], a[196:199], v[36:39]
  s_lshl_b32 s84, s84, 10
  s_lshr_b32 s85, s78, 1
  s_add_u32 s84, s84, s85
  v_mfma_f32_16x16x32_bf16 v[40:43], v[160:163], a[200:203], v[40:43]
  s_lshl_b32 s85, s79, 1
  s_add_u32 s84, s84, s85
  s_mul_i32 s84, s84, 1152
  v_mfma_f32_16x16x32_bf16 v[40:43], v[164:167], a[232:235], v[40:43]
  s_lshl_b32 s92, s92, 1
  s_add_u32 s92, s92, s84
  s_lshl_b32 s93, s93, 1
  v_mfma_f32_16x16x32_bf16 v[40:43], v[168:171], v[232:235], v[40:43]
  s_add_u32 s93, s93, s84
  s_mul_i32 s84, s81, 10240
  v_add_u32 v31, s84, v21
  v_mfma_f32_16x16x32_bf16 v[44:47], v[168:171], v[236:239], v[44:47]
  s_cmp_eq_u32 s81, 0
  s_cselect_b32 s84, 0, 0x80000000
  v_or_b32 v19, s84, v30
  s_add_u32 s100, s83, 262144
  s_add_u32 s101, s83, 266240
  v_mfma_f32_16x16x32_bf16 v[44:47], v[164:167], a[236:239], v[44:47]
  s_mov_b32 s90, 0x860000
  v_cvt_pk_bf16_f32 v32, v32, v33
  v_cvt_pk_bf16_f32 v33, v34, v35
  v_cvt_pk_bf16_f32 v34, v36, v37
  v_cvt_pk_bf16_f32 v35, v38, v39
  v_mfma_f32_16x16x32_bf16 v[44:47], v[160:163], a[204:207], v[44:47]
  buffer_store_dwordx4 v[32:35], v23, s[24:27], s90 offen sc1
  v_mfma_f32_16x16x32_bf16 v[48:51], v[160:163], a[208:211], v[48:51]
  v_mfma_f32_16x16x32_bf16 v[48:51], v[164:167], a[240:243], v[48:51]
  v_mfma_f32_16x16x32_bf16 v[48:51], v[168:171], v[240:243], v[48:51]
  s_mov_b32 s90, 0x862000
  v_cvt_pk_bf16_f32 v40, v40, v41
  v_cvt_pk_bf16_f32 v41, v42, v43
  v_mfma_f32_16x16x32_bf16 v[52:55], v[168:171], v[244:247], v[52:55]
  v_cvt_pk_bf16_f32 v42, v44, v45
  v_cvt_pk_bf16_f32 v43, v46, v47
  v_mfma_f32_16x16x32_bf16 v[52:55], v[164:167], a[244:247], v[52:55]
  buffer_store_dwordx4 v[40:43], v23, s[24:27], s90 offen sc1
  v_mfma_f32_16x16x32_bf16 v[52:55], v[160:163], a[212:215], v[52:55]
  v_mfma_f32_16x16x32_bf16 v[56:59], v[160:163], a[216:219], v[56:59]
  v_mfma_f32_16x16x32_bf16 v[56:59], v[164:167], a[248:251], v[56:59]
  v_mfma_f32_16x16x32_bf16 v[56:59], v[168:171], v[248:251], v[56:59]
  s_mov_b32 s90, 0x864000
  v_cvt_pk_bf16_f32 v48, v48, v49
  v_cvt_pk_bf16_f32 v49, v50, v51
  s_nop 1
  v_cvt_pk_bf16_f32 v50, v52, v53
  v_cvt_pk_bf16_f32 v51, v54, v55
  v_mfma_f32_16x16x32_bf16 v[60:63], v[168:171], v[252:255], v[60:63]
  buffer_store_dwordx4 v[48:51], v23, s[24:27], s90 offen sc1
  v_mfma_f32_16x16x32_bf16 v[60:63], v[164:167], a[252:255], v[60:63]
  v_mfma_f32_16x16x32_bf16 v[60:63], v[160:163], a[220:223], v[60:63]
  ds_read_b128 v[224:227], v31 offset:0
  ds_read_b128 v[228:231], v31 offset:1024
  ds_read_b128 v[232:235], v31 offset:2048
  ds_read_b128 v[236:239], v31 offset:3072
  s_mov_b32 s90, 0x866000
  v_cvt_pk_bf16_f32 v56, v56, v57
  v_cvt_pk_bf16_f32 v57, v58, v59
  s_nop 0
  v_cvt_pk_bf16_f32 v58, v60, v61
  v_cvt_pk_bf16_f32 v59, v62, v63
  buffer_store_dwordx4 v[56:59], v23, s[24:27], s90 offen sc1
  buffer_load_dword v218, v222, s[24:27], s75 offen sc1
  v_mfma_f32_16x16x32_bf16 v[152:155], v[26:29], v[196:199], 0
  v_mfma_f32_16x16x32_bf16 v[156:159], v[24:27], v[196:199], 0
  v_mfma_f32_16x16x32_bf16 v[152:155], v[26:29], v[200:203], v[152:155]
  v_mfma_f32_16x16x32_bf16 v[156:159], v[24:27], v[200:203], v[156:159]
  v_mfma_f32_16x16x32_bf16 v[152:155], v[26:29], v[204:207], v[152:155]
  v_mfma_f32_16x16x32_bf16 v[156:159], v[24:27], v[204:207], v[156:159]
  v_mfma_f32_16x16x32_bf16 v[152:155], v[26:29], v[208:211], v[152:155]
  v_mfma_f32_16x16x32_bf16 v[156:159], v[24:27], v[208:211], v[156:159]
  s_waitcnt lgkmcnt(3)
  v_mfma_f32_16x16x32_bf16 v[128:131], v[184:187], v[224:227], 0
  s_waitcnt lgkmcnt(2)
  v_mfma_f32_16x16x32_bf16 v[132:135], v[184:187], v[228:231], 0
  ds_read_b128 v[224:227], v31 offset:4096
  ds_read_b128 v[228:231], v31 offset:5120
  v_fma_f32 v64, v9, v72, -v64
  v_fma_f32 v65, v9, v73, -v65
  v_fma_f32 v66, v9, v74, -v66
  v_fma_f32 v67, v9, v75, -v67
  v_fma_f32 v68, v9, v76, -v68
  v_fma_f32 v69, v9, v77, -v69
  v_fma_f32 v70, v9, v78, -v70
  v_fma_f32 v71, v9, v79, -v71
  v_cvt_pk_bf16_f32 v184, v64, v65
  v_cvt_pk_bf16_f32 v185, v66, v67
  v_cvt_pk_bf16_f32 v186, v68, v69
  v_cvt_pk_bf16_f32 v187, v70, v71
  s_waitcnt lgkmcnt(3)
  v_mfma_f32_16x16x32_bf16 v[128:131], v[188:191], v[232:235], v[128:131]
  s_waitcnt lgkmcnt(2)
  v_mfma_f32_16x16x32_bf16 v[132:135], v[188:191], v[236:239], v[132:135]
  s_waitcnt lgkmcnt(1)
  v_mfma_f32_16x16x32_bf16 v[128:131], v[184:187], v[224:227], v[128:131]
  s_waitcnt lgkmcnt(0)
  v_mfma_f32_16x16x32_bf16 v[132:135], v[184:187], v[228:231], v[132:135]
  s_cmp_eq_u32 s81, 3
  s_cbranch_scc1 L_q8_gated_mix__spectral_gfnet__swiglu_ffn__prompt_kernel
  ds_read_b128 v[232:235], v31 offset:6144
  ds_read_b128 v[236:239], v31 offset:7168
  ds_read_b128 v[224:227], v31 offset:8192
  ds_read_b128 v[228:231], v31 offset:9216
  v_fma_f32 v72, v9, v64, -v72
  v_fma_f32 v73, v9, v65, -v73
  v_fma_f32 v74, v9, v66, -v74
  v_fma_f32 v75, v9, v67, -v75
  v_fma_f32 v76, v9, v68, -v76
  v_fma_f32 v77, v9, v69, -v77
  v_fma_f32 v78, v9, v70, -v78
  v_fma_f32 v79, v9, v71, -v79
  v_cvt_pk_bf16_f32 v188, v72, v73
  v_cvt_pk_bf16_f32 v189, v74, v75
  v_cvt_pk_bf16_f32 v190, v76, v77
  v_cvt_pk_bf16_f32 v191, v78, v79
  s_waitcnt lgkmcnt(3)
  s_nop 0
  v_mfma_f32_16x16x32_bf16 v[128:131], v[188:191], v[232:235], v[128:131]
  s_waitcnt lgkmcnt(2)
  v_mfma_f32_16x16x32_bf16 v[132:135], v[188:191], v[236:239], v[132:135]
  v_fma_f32 v64, v9, v72, -v64
  v_fma_f32 v65, v9, v73, -v65
  v_fma_f32 v66, v9, v74, -v66
  v_fma_f32 v67, v9, v75, -v67
  v_fma_f32 v68, v9, v76, -v68
  v_fma_f32 v69, v9, v77, -v69
  v_fma_f32 v70, v9, v78, -v70
  v_fma_f32 v71, v9, v79, -v71
  v_cvt_pk_bf16_f32 v184, v64, v65
  v_cvt_pk_bf16_f32 v185, v66, v67
  v_cvt_pk_bf16_f32 v186, v68, v69
  v_cvt_pk_bf16_f32 v187, v70, v71
  s_waitcnt lgkmcnt(1)
  s_nop 0
  v_mfma_f32_16x16x32_bf16 v[128:131], v[184:187], v[224:227], v[128:131]
  s_waitcnt lgkmcnt(0)
  v_mfma_f32_16x16x32_bf16 v[132:135], v[184:187], v[228:231], v[132:135]
L_q8_gated_mix__spectral_gfnet__swiglu_ffn__prompt_kernel:
  ds_read_b128 v[224:227], v21 offset:0
  ds_read_b128 v[228:231], v21 offset:1024
  s_lshl_b32 s84, s81, 11
  v_add_u32 v31, s84, v21
  s_nop 3
  v_mul_f32 v128, v128, v212
  v_mul_f32 v129, v129, v212
  v_mul_f32 v130, v130, v212
  v_mul_f32 v131, v131, v212
  v_mul_f32 v132, v132, v213
  v_mul_f32 v133, v133, v213
  v_mul_f32 v134, v134, v213
  v_mul_f32 v135, v135, v213
  v_fma_f32 v128, v152, v214, v128
  v_fma_f32 v129, v153, v214, v129
  v_fma_f32 v130, v154, v214, v130
  v_fma_f32 v131, v155, v214, v131
  v_fma_f32 v132, v156, v215, v132
  v_fma_f32 v133, v157, v215, v133
  v_fma_f32 v134, v158, v215, v134
  v_fma_f32 v135, v159, v215, v135
  ds_write_b128 v31, v[128:131] offset:36864
  ds_write_b128 v31, v[132:135] offset:37888
  s_waitcnt lgkmcnt(3)
  v_mfma_f32_16x16x32_bf16 v[240:243], v[80:83], v[224:227], 0
  ds_read_b128 v[232:235], v21 offset:2048
  ds_read_b128 v[236:239], v21 offset:3072
  s_waitcnt lgkmcnt(4)
  v_mfma_f32_16x16x32_bf16 v[244:247], v[80:83], v[228:231], 0
  v_mfma_f32_16x16x32_bf16 v[248:251], v[88:91], v[224:227], 0
  v_mfma_f32_16x16x32_bf16 v[252:255], v[88:91], v[228:231], 0
  s_waitcnt lgkmcnt(1)
  v_mfma_f32_16x16x32_bf16 v[240:243], v[84:87], v[232:235], v[240:243]
  ds_read_b128 v[224:227], v21 offset:4096
  ds_read_b128 v[228:231], v21 offset:5120
  s_waitcnt lgkmcnt(2)
  v_mfma_f32_16x16x32_bf16 v[244:247], v[84:87], v[236:239], v[244:247]
  v_fma_f32 v96, v7, v104, -v96
  v_fma_f32 v97, v7, v105, -v97
  v_mfma_f32_16x16x32_bf16 v[248:251], v[92:95], v[232:235], v[248:251]
  v_fma_f32 v98, v7, v106, -v98
  v_fma_f32 v99, v7, v107, -v99
  v_mfma_f32_16x16x32_bf16 v[252:255], v[92:95], v[236:239], v[252:255]
  v_fma_f32 v100, v7, v108, -v100
  v_fma_f32 v101, v7, v109, -v101
  v_fma_f32 v102, v7, v110, -v102
  v_fma_f32 v103, v7, v111, -v103
  v_cvt_pk_bf16_f32 v80, v96, v97
  v_cvt_pk_bf16_f32 v81, v98, v99
  v_cvt_pk_bf16_f32 v82, v100, v101
  v_cvt_pk_bf16_f32 v83, v102, v103
  v_fma_f32 v112, v8, v120, -v112
  v_fma_f32 v113, v8, v121, -v113
  v_fma_f32 v114, v8, v122, -v114
  v_fma_f32 v115, v8, v123, -v115
  v_fma_f32 v116, v8, v124, -v116
  v_fma_f32 v117, v8, v125, -v117
  v_fma_f32 v118, v8, v126, -v118
  v_fma_f32 v119, v8, v127, -v119
  v_cvt_pk_bf16_f32 v88, v112, v113
  v_cvt_pk_bf16_f32 v89, v114, v115
  v_cvt_pk_bf16_f32 v90, v116, v117
  v_cvt_pk_bf16_f32 v91, v118, v119
  s_waitcnt lgkmcnt(1)
  v_mfma_f32_16x16x32_bf16 v[240:243], v[80:83], v[224:227], v[240:243]
  ds_read_b128 v[232:235], v21 offset:6144
  ds_read_b128 v[236:239], v21 offset:7168
  s_waitcnt lgkmcnt(2)
  v_mfma_f32_16x16x32_bf16 v[244:247], v[80:83], v[228:231], v[244:247]
  v_fma_f32 v104, v7, v96, -v104
  v_fma_f32 v105, v7, v97, -v105
  v_mfma_f32_16x16x32_bf16 v[248:251], v[88:91], v[224:227], v[248:251]
  v_fma_f32 v106, v7, v98, -v106
  v_fma_f32 v107, v7, v99, -v107
  v_mfma_f32_16x16x32_bf16 v[252:255], v[88:91], v[228:231], v[252:255]
  v_fma_f32 v108, v7, v100, -v108
  v_fma_f32 v109, v7, v101, -v109
  v_fma_f32 v110, v7, v102, -v110
  v_fma_f32 v111, v7, v103, -v111
  v_cvt_pk_bf16_f32 v84, v104, v105
  v_cvt_pk_bf16_f32 v85, v106, v107
  v_cvt_pk_bf16_f32 v86, v108, v109
  v_cvt_pk_bf16_f32 v87, v110, v111
  v_fma_f32 v120, v8, v112, -v120
  v_fma_f32 v121, v8, v113, -v121
  v_fma_f32 v122, v8, v114, -v122
  v_fma_f32 v123, v8, v115, -v123
  v_fma_f32 v124, v8, v116, -v124
  v_fma_f32 v125, v8, v117, -v125
  v_fma_f32 v126, v8, v118, -v126
  v_fma_f32 v127, v8, v119, -v127
  v_cvt_pk_bf16_f32 v92, v120, v121
  v_cvt_pk_bf16_f32 v93, v122, v123
  v_cvt_pk_bf16_f32 v94, v124, v125
  v_cvt_pk_bf16_f32 v95, v126, v127
  s_waitcnt lgkmcnt(1)
  v_mfma_f32_16x16x32_bf16 v[240:243], v[84:87], v[232:235], v[240:243]
  ds_read_b128 v[224:227], v21 offset:8192
  ds_read_b128 v[228:231], v21 offset:9216
  s_waitcnt lgkmcnt(2)
  v_mfma_f32_16x16x32_bf16 v[244:247], v[84:87], v[236:239], v[244:247]
  v_fma_f32 v96, v7, v104, -v96
  v_fma_f32 v97, v7, v105, -v97
  v_mfma_f32_16x16x32_bf16 v[248:251], v[92:95], v[232:235], v[248:251]
  v_fma_f32 v98, v7, v106, -v98
  v_fma_f32 v99, v7, v107, -v99
  v_mfma_f32_16x16x32_bf16 v[252:255], v[92:95], v[236:239], v[252:255]
  v_fma_f32 v100, v7, v108, -v100
  v_fma_f32 v101, v7, v109, -v101
  v_fma_f32 v102, v7, v110, -v102
  v_fma_f32 v103, v7, v111, -v103
  v_cvt_pk_bf16_f32 v80, v96, v97
  v_cvt_pk_bf16_f32 v81, v98, v99
  v_cvt_pk_bf16_f32 v82, v100, v101
  v_cvt_pk_bf16_f32 v83, v102, v103
  v_fma_f32 v112, v8, v120, -v112
  v_fma_f32 v113, v8, v121, -v113
  v_fma_f32 v114, v8, v122, -v114
  v_fma_f32 v115, v8, v123, -v115
  v_fma_f32 v116, v8, v124, -v116
  v_fma_f32 v117, v8, v125, -v117
  v_fma_f32 v118, v8, v126, -v118
  v_fma_f32 v119, v8, v127, -v119
  v_cvt_pk_bf16_f32 v88, v112, v113
  v_cvt_pk_bf16_f32 v89, v114, v115
  v_cvt_pk_bf16_f32 v90, v116, v117
  v_cvt_pk_bf16_f32 v91, v118, v119
  s_waitcnt vmcnt(0)
  v_readfirstlane_b32 s91, v218
  s_nop 1
  s_cmp_ge_u32 s91, s77
  s_cbranch_scc0 L_spA_gated_mix__spectral_gfnet__swiglu_ffn__prompt_kernel
L_bkA_gated_mix__spectral_gfnet__swiglu_ffn__prompt_kernel:
  s_barrier
  buffer_load_dwordx4 a[0:3], v21, s[24:27], s83 offen offset:0 sc1
  buffer_load_dwordx4 a[4:7], v21, s[24:27], s83 offen offset:1024 sc1
  s_waitcnt lgkmcnt(1)
  v_mfma_f32_16x16x32_bf16 v[240:243], v[80:83], v[224:227], v[240:243]
  ds_read_b128 v[232:235], v21 offset:10240
  ds_read_b128 v[236:239], v21 offset:11264
  s_waitcnt lgkmcnt(2)
  v_mfma_f32_16x16x32_bf16 v[244:247], v[80:83], v[228:231], v[244:247]
  v_fma_f32 v104, v7, v96, -v104
  v_fma_f32 v105, v7, v97, -v105
  v_mfma_f32_16x16x32_bf16 v[248:251], v[88:91], v[224:227], v[248:251]
  v_fma_f32 v106, v7, v98, -v106
  v_fma_f32 v107, v7, v99, -v107
  v_mfma_f32_16x16x32_bf16 v[252:255], v[88:91], v[228:231], v[252:255]
  v_fma_f32 v108, v7, v100, -v108
  v_fma_f32 v109, v7, v101, -v109
  v_fma_f32 v110, v7, v102, -v110
  v_fma_f32 v111, v7, v103, -v111
  v_cvt_pk_bf16_f32 v84, v104, v105
  v_cvt_pk_bf16_f32 v85, v106, v107
  v_cvt_pk_bf16_f32 v86, v108, v109
  v_cvt_pk_bf16_f32 v87, v110, v111
  v_fma_f32 v120, v8, v112, -v120
  v_fma_f32 v121, v8, v113, -v121
  v_fma_f32 v122, v8, v114, -v122
  v_fma_f32 v123, v8, v115, -v123
  v_fma_f32 v124, v8, v116, -v124
  v_fma_f32 v125, v8, v117, -v125
  v_fma_f32 v126, v8, v118, -v126
  v_fma_f32 v127, v8, v119, -v127
  v_cvt_pk_bf16_f32 v92, v120, v121
  v_cvt_pk_bf16_f32 v93, v122, v123
  v_cvt_pk_bf16_f32 v94, v124, v125
  v_cvt_pk_bf16_f32 v95, v126, v127
  s_barrier
  s_add_u32 s76, s75, 4
  buffer_atomic_add v3, v222, s[24:27], s76 offen sc1
  ds_read_b128 v[32:35], v21 offset:36864
  ds_read_b128 v[36:39], v21 offset:37888
  ds_read_b128 v[40:43], v21 offset:38912
  ds_read_b128 v[44:47], v21 offset:39936
  ds_read_b128 v[48:51], v21 offset:40960
  ds_read_b128 v[52:55], v21 offset:41984
  ds_read_b128 v[56:59], v21 offset:43008
  ds_read_b128 v[60:63], v21 offset:44032
  buffer_load_dwordx4 a[8:11], v21, s[24:27], s83 offen offset:2048 sc1
  buffer_load_dwordx4 a[12:15], v21, s[24:27], s83 offen offset:3072 sc1
  s_add_u32 s83, s83, 4096
  s_waitcnt lgkmcnt(9)
  v_mfma_f32_16x16x32_bf16 v[240:243], v[84:87], v[232:235], v[240:243]
  ds_read_b128 v[224:227], v21 offset:12288
  ds_read_b128 v[228:231], v21 offset:13312
  s_waitcnt lgkmcnt(10)
  v_mfma_f32_16x16x32_bf16 v[244:247], v[84:87], v[236:239], v[244:247]
  v_fma_f32 v96, v7, v104, -v96
  v_fma_f32 v97, v7, v105, -v97
  v_mfma_f32_16x16x32_bf16 v[248:251], v[92:95], v[232:235], v[248:251]
  v_fma_f32 v98, v7, v106, -v98
  v_fma_f32 v99, v7, v107, -v99
  v_mfma_f32_16x16x32_bf16 v[252:255], v[92:95], v[236:239], v[252:255]
  v_fma_f32 v100, v7, v108, -v100
  v_fma_f32 v101, v7, v109, -v101
  v_fma_f32 v102, v7, v110, -v102
  v_fma_f32 v103, v7, v111, -v103
  v_cvt_pk_bf16_f32 v80, v96, v97
  v_cvt_pk_bf16_f32 v81, v98, v99
  v_cvt_pk_bf16_f32 v82, v100, v101
  v_cvt_pk_bf16_f32 v83, v102, v103
  v_fma_f32 v112, v8, v120, -v112
  v_fma_f32 v113, v8, v121, -v113
  v_fma_f32 v114, v8, v122, -v114
  v_fma_f32 v115, v8, v123, -v115
  v_fma_f32 v116, v8, v124, -v116
  v_fma_f32 v117, v8, v125, -v117
  v_fma_f32 v118, v8, v126, -v118
  v_fma_f32 v119, v8, v127, -v119
  v_cvt_pk_bf16_f32 v88, v112, v113
  v_cvt_pk_bf16_f32 v89, v114, v115
  v_cvt_pk_bf16_f32 v90, v116, v117
  v_cvt_pk_bf16_f32 v91, v118, v119
  buffer_load_dwordx4 a[16:19], v21, s[24:27], s83 offen offset:0 sc1
  buffer_load_dwordx4 a[20:23], v21, s[24:27], s83 offen offset:1024 sc1
  s_waitcnt lgkmcnt(1)
  v_mfma_f32_16x16x32_bf16 v[240:243], v[80:83], v[224:227], v[240:243]
  ds_read_b128 v[232:235], v21 offset:14336
  ds_read_b128 v[236:239], v21 offset:15360
  s_waitcnt lgkmcnt(2)
  v_mfma_f32_16x16x32_bf16 v[244:247], v[80:83], v[228:231], v[244:247]
  v_fma_f32 v104, v7, v96, -v104
  v_fma_f32 v105, v7, v97, -v105
  v_mfma_f32_16x16x32_bf16 v[248:251], v[88:91], v[224:227], v[248:251]
  v_fma_f32 v106, v7, v98, -v106
  v_fma_f32 v107, v7, v99, -v107
  v_mfma_f32_16x16x32_bf16 v[252:255], v[88:91], v[228:231], v[252:255]
  v_fma_f32 v108, v7, v100, -v108
  v_fma_f32 v109, v7, v101, -v109
  v_fma_f32 v110, v7, v102, -v110
  v_fma_f32 v111, v7, v103, -v111
  v_cvt_pk_bf16_f32 v84, v104, v105
  v_cvt_pk_bf16_f32 v85, v106, v107
  v_cvt_pk_bf16_f32 v86, v108, v109
  v_cvt_pk_bf16_f32 v87, v110, v111
  v_fma_f32 v120, v8, v112, -v120
  v_fma_f32 v121, v8, v113, -v121
  v_fma_f32 v122, v8, v114, -v122
  v_fma_f32 v123, v8, v115, -v123
  v_fma_f32 v124, v8, v116, -v124
  v_fma_f32 v125, v8, v117, -v125
  v_fma_f32 v126, v8, v118, -v126
  v_fma_f32 v127, v8, v119, -v127
  v_cvt_pk_bf16_f32 v92, v120, v121
  v_cvt_pk_bf16_f32 v93, v122, v123
  v_cvt_pk_bf16_f32 v94, v124, v125
  v_cvt_pk_bf16_f32 v95, v126, v127
  buffer_load_dwordx4 a[24:27], v21, s[24:27], s83 offen offset:2048 sc1
  buffer_load_dwordx4 a[28:31], v21, s[24:27], s83 offen offset:3072 sc1
  s_add_u32 s83, s83, 4096
  s_waitcnt lgkmcnt(1)
  v_mfma_f32_16x16x32_bf16 v[240:243], v[84:87], v[232:235], v[240:243]
  ds_read_b128 v[224:227], v21 offset:16384
  ds_read_b128 v[228:231], v21 offset:17408
  s_waitcnt lgkmcnt(2)
  v_mfma_f32_16x16x32_bf16 v[244:247], v[84:87], v[236:239], v[244:247]
  v_fma_f32 v96, v7, v104, -v96
  v_fma_f32 v97, v7, v105, -v97
  v_mfma_f32_16x16x32_bf16 v[248:251], v[92:95], v[232:235], v[248:251]
  v_fma_f32 v98, v7, v106, -v98
  v_fma_f32 v99, v7, v107, -v99
  v_mfma_f32_16x16x32_bf16 v[252:255], v[92:95], v[236:239], v[252:255]
  v_fma_f32 v100, v7, v108, -v100
  v_fma_f32 v101, v7, v109, -v101
  v_fma_f32 v102, v7, v110, -v102
  v_fma_f32 v103, v7, v111, -v103
  v_cvt_pk_bf16_f32 v80, v96, v97
  v_cvt_pk_bf16_f32 v81, v98, v99
  v_cvt_pk_bf16_f32 v82, v100, v101
  v_cvt_pk_bf16_f32 v83, v102, v103
  v_fma_f32 v112, v8, v120, -v112
  v_fma_f32 v113, v8, v121, -v113
  v_fma_f32 v114, v8, v122, -v114
  v_fma_f32 v115, v8, v123, -v115
  v_fma_f32 v116, v8, v124, -v116
  v_fma_f32 v117, v8, v125, -v117
  v_fma_f32 v118, v8, v126, -v118
  v_fma_f32 v119, v8, v127, -v119
  v_cvt_pk_bf16_f32 v88, v112, v113
  v_cvt_pk_bf16_f32 v89, v114, v115
  v_cvt_pk_bf16_f32 v90, v116, v117
  v_cvt_pk_bf16_f32 v91, v118, v119
  s_waitcnt lgkmcnt(1)
  v_mfma_f32_16x16x32_bf16 v[240:243], v[80:83], v[224:227], v[240:243]
  ds_read_b128 v[232:235], v21 offset:18432
  ds_read_b128 v[236:239], v21 offset:19456
  s_waitcnt lgkmcnt(2)
  v_mfma_f32_16x16x32_bf16 v[244:247], v[80:83], v[228:231], v[244:247]
  v_fma_f32 v104, v7, v96, -v104
  v_fma_f32 v105, v7, v97, -v105
  v_mfma_f32_16x16x32_bf16 v[248:251], v[88:91], v[224:227], v[248:251]
  v_fma_f32 v106, v7, v98, -v106
  v_fma_f32 v107, v7, v99, -v107
  v_mfma_f32_16x16x32_bf16 v[252:255], v[88:91], v[228:231], v[252:255]
  v_fma_f32 v108, v7, v100, -v108
  v_fma_f32 v109, v7, v101, -v109
  v_fma_f32 v110, v7, v102, -v110
  v_fma_f32 v111, v7, v103, -v111
  v_cvt_pk_bf16_f32 v84, v104, v105
  v_cvt_pk_bf16_f32 v85, v106, v107
  v_cvt_pk_bf16_f32 v86, v108, v109
  v_cvt_pk_bf16_f32 v87, v110, v111
  v_fma_f32 v120, v8, v112, -v120
  v_fma_f32 v121, v8, v113, -v121
  v_fma_f32 v122, v8, v114, -v122
  v_fma_f32 v123, v8, v115, -v123
  v_fma_f32 v124, v8, v116, -v124
  v_fma_f32 v125, v8, v117, -v125
  v_fma_f32 v126, v8, v118, -v126
  v_fma_f32 v127, v8, v119, -v127
  v_cvt_pk_bf16_f32 v92, v120, v121
  v_cvt_pk_bf16_f32 v93, v122, v123
  v_cvt_pk_bf16_f32 v94, v124, v125
  v_cvt_pk_bf16_f32 v95, v126, v127
  s_waitcnt lgkmcnt(1)
  v_mfma_f32_16x16x32_bf16 v[240:243], v[84:87], v[232:235], v[240:243]
  ds_read_b128 v[224:227], v21 offset:20480
  ds_read_b128 v[228:231], v21 offset:21504
  s_waitcnt lgkmcnt(2)
  v_mfma_f32_16x16x32_bf16 v[244:247], v[84:87], v[236:239], v[244:247]
  v_fma_f32 v96, v7, v104, -v96
  v_fma_f32 v97, v7, v105, -v97
  v_mfma_f32_16x16x32_bf16 v[248:251], v[92:95], v[232:235], v[248:251]
  v_fma_f32 v98, v7, v106, -v98
  v_fma_f32 v99, v7, v107, -v99
  v_mfma_f32_16x16x32_bf16 v[252:255], v[92:95], v[236:239], v[252:255]
  v_fma_f32 v100, v7, v108, -v100
  v_fma_f32 v101, v7, v109, -v101
  v_fma_f32 v102, v7, v110, -v102
  v_fma_f32 v103, v7, v111, -v103
  v_cvt_pk_bf16_f32 v80, v96, v97
  v_cvt_pk_bf16_f32 v81, v98, v99
  v_cvt_pk_bf16_f32 v82, v100, v101
  v_cvt_pk_bf16_f32 v83, v102, v103
  v_fma_f32 v112, v8, v120, -v112
  v_fma_f32 v113, v8, v121, -v113
  v_fma_f32 v114, v8, v122, -v114
  v_fma_f32 v115, v8, v123, -v115
  v_fma_f32 v116, v8, v124, -v116
  v_fma_f32 v117, v8, v125, -v117
  v_fma_f32 v118, v8, v126, -v118
  v_fma_f32 v119, v8, v127, -v119
  v_cvt_pk_bf16_f32 v88, v112, v113
  v_cvt_pk_bf16_f32 v89, v114, v115
  v_cvt_pk_bf16_f32 v90, v116, v117
  v_cvt_pk_bf16_f32 v91, v118, v119
  s_waitcnt lgkmcnt(1)
  v_mfma_f32_16x16x32_bf16 v[240:243], v[80:83], v[224:227], v[240:243]
  ds_read_b128 v[232:235], v21 offset:22528
  ds_read_b128 v[236:239], v21 offset:23552
  s_waitcnt lgkmcnt(2)
  v_mfma_f32_16x16x32_bf16 v[244:247], v[80:83], v[228:231], v[244:247]
  v_fma_f32 v104, v7, v96, -v104
  v_fma_f32 v105, v7, v97, -v105
  v_mfma_f32_16x16x32_bf16 v[248:251], v[88:91], v[224:227], v[248:251]
  v_fma_f32 v106, v7, v98, -v106
  v_fma_f32 v107, v7, v99, -v107
  v_mfma_f32_16x16x32_bf16 v[252:255], v[88:91], v[228:231], v[252:255]
  v_fma_f32 v108, v7, v100, -v108
  v_fma_f32 v109, v7, v101, -v109
  v_fma_f32 v110, v7, v102, -v110
  v_fma_f32 v111, v7, v103, -v111
  v_cvt_pk_bf16_f32 v84, v104, v105
  v_cvt_pk_bf16_f32 v85, v106, v107
  v_cvt_pk_bf16_f32 v86, v108, v109
  v_cvt_pk_bf16_f32 v87, v110, v111
  v_fma_f32 v120, v8, v112, -v120
  v_fma_f32 v121, v8, v113, -v121
  v_fma_f32 v122, v8, v114, -v122
  v_fma_f32 v123, v8, v115, -v123
  v_fma_f32 v124, v8, v116, -v124
  v_fma_f32 v125, v8, v117, -v125
  v_fma_f32 v126, v8, v118, -v126
  v_fma_f32 v127, v8, v119, -v127
  v_cvt_pk_bf16_f32 v92, v120, v121
  v_cvt_pk_bf16_f32 v93, v122, v123
  v_cvt_pk_bf16_f32 v94, v124, v125
  v_cvt_pk_bf16_f32 v95, v126, v127
  buffer_load_dword v219, v222, s[24:27], s76 offen sc1
  s_waitcnt lgkmcnt(1)
  v_mfma_f32_16x16x32_bf16 v[240:243], v[84:87], v[232:235], v[240:243]
  ds_read_b128 v[224:227], v21 offset:24576
  ds_read_b128 v[228:231], v21 offset:25600
  s_waitcnt lgkmcnt(2)
  v_mfma_f32_16x16x32_bf16 v[244:247], v[84:87], v[236:239], v[244:247]
  v_fma_f32 v96, v7, v104, -v96
  v_fma_f32 v97, v7, v105, -v97
  v_mfma_f32_16x16x32_bf16 v[248:251], v[92:95], v[232:235], v[248:251]
  v_fma_f32 v98, v7, v106, -v98
  v_fma_f32 v99, v7, v107, -v99
  v_mfma_f32_16x16x32_bf16 v[252:255], v[92:95], v[236:239], v[252:255]
  v_fma_f32 v100, v7, v108, -v100
  v_fma_f32 v101, v7, v109, -v101
  v_fma_f32 v102, v7, v110, -v102
  v_fma_f32 v103, v7, v111, -v103
  v_cvt_pk_bf16_f32 v80, v96, v97
  v_cvt_pk_bf16_f32 v81, v98, v99
  v_cvt_pk_bf16_f32 v82, v100, v101
  v_cvt_pk_bf16_f32 v83, v102, v103
  v_fma_f32 v112, v8, v120, -v112
  v_fma_f32 v113, v8, v121, -v113
  v_fma_f32 v114, v8, v122, -v114
  v_fma_f32 v115, v8, v123, -v115
  v_fma_f32 v116, v8, v124, -v116
  v_fma_f32 v117, v8, v125, -v117
  v_fma_f32 v118, v8, v126, -v118
  v_fma_f32 v119, v8, v127, -v119
  v_cvt_pk_bf16_f32 v88, v112, v113
  v_cvt_pk_bf16_f32 v89, v114, v115
  v_cvt_pk_bf16_f32 v90, v116, v117
  v_cvt_pk_bf16_f32 v91, v118, v119
  s_waitcnt lgkmcnt(1)
  v_mfma_f32_16x16x32_bf16 v[240:243], v[80:83], v[224:227], v[240:243]
  ds_read_b128 v[232:235], v21 offset:26624
  ds_read_b128 v[236:239], v21 offset:27648
  s_waitcnt lgkmcnt(2)
  v_mfma_f32_16x16x32_bf16 v[244:247], v[80:83], v[228:231], v[244:247]
  v_fma_f32 v104, v7, v96, -v104
  v_fma_f32 v105, v7, v97, -v105
  v_mfma_f32_16x16x32_bf16 v[248:251], v[88:91], v[224:227], v[248:251]
  v_fma_f32 v106, v7, v98, -v106
  v_fma_f32 v107, v7, v99, -v107
  v_mfma_f32_16x16x32_bf16 v[252:255], v[88:91], v[228:231], v[252:255]
  v_fma_f32 v108, v7, v100, -v108
  v_fma_f32 v109, v7, v101, -v109
  v_fma_f32 v110, v7, v102, -v110
  v_fma_f32 v111, v7, v103, -v111
  v_cvt_pk_bf16_f32 v84, v104, v105
  v_cvt_pk_bf16_f32 v85, v106, v107
  v_cvt_pk_bf16_f32 v86, v108, v109
  v_cvt_pk_bf16_f32 v87, v110, v111
  v_fma_f32 v120, v8, v112, -v120
  v_fma_f32 v121, v8, v113, -v121
  v_fma_f32 v122, v8, v114, -v122
  v_fma_f32 v123, v8, v115, -v123
  v_fma_f32 v124, v8, v116, -v124
  v_fma_f32 v125, v8, v117, -v125
  v_fma_f32 v126, v8, v118, -v126
  v_fma_f32 v127, v8, v119, -v127
  v_cvt_pk_bf16_f32 v92, v120, v121
  v_cvt_pk_bf16_f32 v93, v122, v123
  v_cvt_pk_bf16_f32 v94, v124, v125
  v_cvt_pk_bf16_f32 v95, v126, v127
  s_waitcnt vmcnt(0)
  v_readfirstlane_b32 s91, v219
  s_nop 1
  s_cmp_ge_u32 s91, s77
  s_cbranch_scc0 L_spB_gated_mix__spectral_gfnet__swiglu_ffn__prompt_kernel
L_bkB_gated_mix__spectral_gfnet__swiglu_ffn__prompt_kernel:
  s_barrier
  buffer_load_dwordx4 v[160:163], v21, s[24:27], s100 offen offset:0 sc1
  buffer_load_dwordx4 v[164:167], v21, s[24:27], s100 offen offset:1024 sc1
  buffer_load_dwordx4 v[168:171], v21, s[24:27], s100 offen offset:2048 sc1
  buffer_load_dwordx4 v[172:175], v21, s[24:27], s100 offen offset:3072 sc1
  buffer_load_dwordx4 v[176:179], v21, s[24:27], s101 offen offset:0 sc1
  buffer_load_dwordx4 v[180:183], v21, s[24:27], s101 offen offset:1024 sc1
  buffer_load_dwordx4 v[196:199], v21, s[24:27], s101 offen offset:2048 sc1
  buffer_load_dwordx4 v[200:203], v21, s[24:27], s101 offen offset:3072 sc1
  s_waitcnt lgkmcnt(1)
  v_mfma_f32_16x16x32_bf16 v[240:243], v[84:87], v[232:235], v[240:243]
  ds_read_b128 v[224:227], v21 offset:28672
  ds_read_b128 v[228:231], v21 offset:29696
  s_waitcnt lgkmcnt(2)
  v_mfma_f32_16x16x32_bf16 v[244:247], v[84:87], v[236:239], v[244:247]
  v_fma_f32 v96, v7, v104, -v96
  v_fma_f32 v97, v7, v105, -v97
  v_mfma_f32_16x16x32_bf16 v[248:251], v[92:95], v[232:235], v[248:251]
  v_fma_f32 v98, v7, v106, -v98
  v_fma_f32 v99, v7, v107, -v99
  v_mfma_f32_16x16x32_bf16 v[252:255], v[92:95], v[236:239], v[252:255]
  v_fma_f32 v100, v7, v108, -v100
  v_fma_f32 v101, v7, v109, -v101
  v_fma_f32 v102, v7, v110, -v102
  v_fma_f32 v103, v7, v111, -v103
  v_cvt_pk_bf16_f32 v80, v96, v97
  v_cvt_pk_bf16_f32 v81, v98, v99
  v_cvt_pk_bf16_f32 v82, v100, v101
  v_cvt_pk_bf16_f32 v83, v102, v103
  v_fma_f32 v112, v8, v120, -v112
  v_fma_f32 v113, v8, v121, -v113
  v_fma_f32 v114, v8, v122, -v114
  v_fma_f32 v115, v8, v123, -v115
  v_fma_f32 v116, v8, v124, -v116
  v_fma_f32 v117, v8, v125, -v117
  v_fma_f32 v118, v8, v126, -v118
  v_fma_f32 v119, v8, v127, -v119
  v_cvt_pk_bf16_f32 v88, v112, v113
  v_cvt_pk_bf16_f32 v89, v114, v115
  v_cvt_pk_bf16_f32 v90, v116, v117
  v_cvt_pk_bf16_f32 v91, v118, v119
  s_waitcnt lgkmcnt(1)
  v_mfma_f32_16x16x32_bf16 v[240:243], v[80:83], v[224:227], v[240:243]
  ds_read_b128 v[232:235], v21 offset:30720
  ds_read_b128 v[236:239], v21 offset:31744
  s_waitcnt lgkmcnt(2)
  v_mfma_f32_16x16x32_bf16 v[244:247], v[80:83], v[228:231], v[244:247]
  v_fma_f32 v104, v7, v96, -v104
  v_fma_f32 v105, v7, v97, -v105
  v_mfma_f32_16x16x32_bf16 v[248:251], v[88:91], v[224:227], v[248:251]
  v_fma_f32 v106, v7, v98, -v106
  v_fma_f32 v107, v7, v99, -v107
  v_mfma_f32_16x16x32_bf16 v[252:255], v[88:91], v[228:231], v[252:255]
  v_fma_f32 v108, v7, v100, -v108
  v_fma_f32 v109, v7, v101, -v109
  v_mfma_f32_16x16x32_bf16 v[136:139], v[26:29], a[0:3], 0
  v_fma_f32 v110, v7, v102, -v110
  v_fma_f32 v111, v7, v103, -v111
  v_mfma_f32_16x16x32_bf16 v[140:143], v[24:27], a[0:3], 0
  v_cvt_pk_bf16_f32 v84, v104, v105
  v_cvt_pk_bf16_f32 v85, v106, v107
  v_mfma_f32_16x16x32_bf16 v[136:139], v[26:29], a[4:7], v[136:139]
  v_cvt_pk_bf16_f32 v86, v108, v109
  v_cvt_pk_bf16_f32 v87, v110, v111
  v_mfma_f32_16x16x32_bf16 v[140:143], v[24:27], a[4:7], v[140:143]
  v_fma_f32 v120, v8, v112, -v120
  v_fma_f32 v121, v8, v113, -v121
  v_fma_f32 v122, v8, v114, -v122
  v_fma_f32 v123, v8, v115, -v123
  v_fma_f32 v124, v8, v116, -v124
  v_fma_f32 v125, v8, v117, -v125
  v_fma_f32 v126, v8, v118, -v126
  v_fma_f32 v127, v8, v119, -v127
  v_cvt_pk_bf16_f32 v92, v120, v121
  v_cvt_pk_bf16_f32 v93, v122, v123
  v_cvt_pk_bf16_f32 v94, v124, v125
  v_cvt_pk_bf16_f32 v95, v126, v127
  s_waitcnt lgkmcnt(1)
  v_mfma_f32_16x16x32_bf16 v[240:243], v[84:87], v[232:235], v[240:243]
  ds_read_b128 v[224:227], v21 offset:32768
  ds_read_b128 v[228:231], v21 offset:33792
  s_waitcnt lgkmcnt(2)
  v_mfma_f32_16x16x32_bf16 v[244:247], v[84:87], v[236:239], v[244:247]
  v_fma_f32 v96, v7, v104, -v96
  v_fma_f32 v97, v7, v105, -v97
  v_mfma_f32_16x16x32_bf16 v[248:251], v[92:95], v[232:235], v[248:251]
  v_fma_f32 v98, v7, v106, -v98
  v_fma_f32 v99, v7, v107, -v99
  v_mfma_f32_16x16x32_bf16 v[252:255], v[92:95], v[236:239], v[252:255]
  v_fma_f32 v100, v7, v108, -v100
  v_fma_f32 v101, v7, v109, -v101
  v_mfma_f32_16x16x32_bf16 v[136:139], v[26:29], a[8:11], v[136:139]
  v_fma_f32 v102, v7, v110, -v102
  v_fma_f32 v103, v7, v111, -v103
  v_mfma_f32_16x16x32_bf16 v[140:143], v[24:27], a[8:11], v[140:143]
  v_cvt_pk_bf16_f32 v80, v96, v97
  v_cvt_pk_bf16_f32 v81, v98, v99
  v_mfma_f32_16x16x32_bf16 v[136:139], v[26:29], a[12:15], v[136:139]
  v_cvt_pk_bf16_f32 v82, v100, v101
  v_cvt_pk_bf16_f32 v83, v102, v103
  v_mfma_f32_16x16x32_bf16 v[140:143], v[24:27], a[12:15], v[140:143]
  v_fma_f32 v112, v8, v120, -v112
  v_fma_f32 v113, v8, v121, -v113
  v_fma_f32 v114, v8, v122, -v114
  v_fma_f32 v115, v8, v123, -v115
  v_fma_f32 v116, v8, v124, -v116
  v_fma_f32 v117, v8, v125, -v117
  v_fma_f32 v118, v8, v126, -v118
  v_fma_f32 v119, v8, v127, -v119
  v_cvt_pk_bf16_f32 v88, v112, v113
  v_cvt_pk_bf16_f32 v89, v114, v115
  v_cvt_pk_bf16_f32 v90, v116, v117
  v_cvt_pk_bf16_f32 v91, v118, v119
  s_waitcnt lgkmcnt(1)
  v_mfma_f32_16x16x32_bf16 v[240:243], v[80:83], v[224:227], v[240:243]
  ds_read_b128 v[232:235], v21 offset:34816
  ds_read_b128 v[236:239], v21 offset:35840
  s_waitcnt lgkmcnt(2)
  v_mfma_f32_16x16x32_bf16 v[244:247], v[80:83], v[228:231], v[244:247]
  v_fma_f32 v104, v7, v96, -v104
  v_fma_f32 v105, v7, v97, -v105
  v_mfma_f32_16x16x32_bf16 v[248:251], v[88:91], v[224:227], v[248:251]
  v_fma_f32 v106, v7, v98, -v106
  v_fma_f32 v107, v7, v99, -v107
  v_mfma_f32_16x16x32_bf16 v[252:255], v[88:91], v[228:231], v[252:255]
  v_fma_f32 v108, v7, v100, -v108
  v_fma_f32 v109, v7, v101, -v109
  v_mfma_f32_16x16x32_bf16 v[136:139], v[26:29], a[16:19], v[136:139]
  v_fma_f32 v110, v7, v102, -v110
  v_fma_f32 v111, v7, v103, -v111
  v_mfma_f32_16x16x32_bf16 v[140:143], v[24:27], a[16:19], v[140:143]
  v_cvt_pk_bf16_f32 v84, v104, v105
  v_cvt_pk_bf16_f32 v85, v106, v107
  v_mfma_f32_16x16x32_bf16 v[136:139], v[26:29], a[20:23], v[136:139]
  v_cvt_pk_bf16_f32 v86, v108, v109
  v_cvt_pk_bf16_f32 v87, v110, v111
  v_mfma_f32_16x16x32_bf16 v[140:143], v[24:27], a[20:23], v[140:143]
  v_fma_f32 v120, v8, v112, -v120
  v_fma_f32 v121, v8, v113, -v121
  v_fma_f32 v122, v8, v114, -v122
  v_fma_f32 v123, v8, v115, -v123
  v_fma_f32 v124, v8, v116, -v124
  v_fma_f32 v125, v8, v117, -v125
  v_fma_f32 v126, v8, v118, -v126
  v_fma_f32 v127, v8, v119, -v127
  v_cvt_pk_bf16_f32 v92, v120, v121
  v_cvt_pk_bf16_f32 v93, v122, v123
  v_cvt_pk_bf16_f32 v94, v124, v125
  v_cvt_pk_bf16_f32 v95, v126, v127
  s_waitcnt lgkmcnt(1)
  v_mfma_f32_16x16x32_bf16 v[240:243], v[84:87], v[232:235], v[240:243]
  s_waitcnt lgkmcnt(0)
  v_mfma_f32_16x16x32_bf16 v[244:247], v[84:87], v[236:239], v[244:247]
  v_mfma_f32_16x16x32_bf16 v[248:251], v[92:95], v[232:235], v[248:251]
  v_mfma_f32_16x16x32_bf16 v[252:255], v[92:95], v[236:239], v[252:255]
  v_mfma_f32_16x16x32_bf16 v[136:139], v[26:29], a[24:27], v[136:139]
  v_mfma_f32_16x16x32_bf16 v[140:143], v[24:27], a[24:27], v[140:143]
  v_mfma_f32_16x16x32_bf16 v[136:139], v[26:29], a[28:31], v[136:139]
  v_mfma_f32_16x16x32_bf16 v[140:143], v[24:27], a[28:31], v[140:143]
  v_add_f32 v32, v32, v40
  v_add_f32 v48, v48, v56
  v_add_f32 v32, v32, v48
  v_add_f32 v33, v33, v41
  v_add_f32 v49, v49, v57
  v_add_f32 v33, v33, v49
  v_add_f32 v34, v34, v42
  v_add_f32 v50, v50, v58
  v_add_f32 v34, v34, v50
  v_add_f32 v35, v35, v43
  v_add_f32 v51, v51, v59
  v_add_f32 v35, v35, v51
  v_add_f32 v36, v36, v44
  v_add_f32 v52, v52, v60
  v_add_f32 v36, v36, v52
  v_add_f32 v37, v37, v45
  v_add_f32 v53, v53, v61
  v_add_f32 v37, v37, v53
  v_add_f32 v38, v38, v46
  v_add_f32 v54, v54, v62
  v_add_f32 v38, v38, v54
  v_add_f32 v39, v39, v47
  v_add_f32 v55, v55, v63
  v_add_f32 v39, v39, v55
  v_cvt_pk_bf16_f32 v32, v32, v33
  v_cvt_pk_bf16_f32 v33, v34, v35
  v_cvt_pk_bf16_f32 v34, v36, v37
  v_cvt_pk_bf16_f32 v35, v38, v39
  s_nop 0
  v_permlane16_swap_b32 v32, v34
  v_permlane16_swap_b32 v33, v35
  buffer_store_dwordx4 v[32:35], v19, s[40:43], s92 offen offset:1024
  v_mul_f32 v240, v240, v212
  v_mul_f32 v241, v241, v212
  v_mul_f32 v242, v242, v212
  v_mul_f32 v243, v243, v212
  v_mul_f32 v244, v244, v213
  v_mul_f32 v245, v245, v213
  v_mul_f32 v246, v246, v213
  v_mul_f32 v247, v247, v213
  v_fma_f32 v240, v136, v214, v240
  v_fma_f32 v241, v137, v214, v241
  v_fma_f32 v242, v138, v214, v242
  v_fma_f32 v243, v139, v214, v243
  v_fma_f32 v244, v140, v215, v244
  v_fma_f32 v245, v141, v215, v245
  v_fma_f32 v246, v142, v215, v246
  v_fma_f32 v247, v143, v215, v247
  v_cvt_pk_bf16_f32 v240, v240, v241
  v_cvt_pk_bf16_f32 v241, v242, v243
  v_cvt_pk_bf16_f32 v242, v244, v245
  v_cvt_pk_bf16_f32 v243, v246, v247
  s_nop 0
  v_permlane16_swap_b32 v240, v242
  v_permlane16_swap_b32 v241, v243
  buffer_store_dwordx4 v[240:243], v30, s[40:43], s93 offen offset:0
  v_mul_f32 v248, v248, v212
  v_mul_f32 v249, v249, v212
  v_mul_f32 v250, v250, v212
  v_mul_f32 v251, v251, v212
  v_mul_f32 v252, v252, v213
  v_mul_f32 v253, v253, v213
  v_mul_f32 v254, v254, v213
  v_mul_f32 v255, v255, v213
  s_waitcnt vmcnt(9)
  v_mfma_f32_16x16x32_bf16 v[144:147], v[26:29], v[160:163], 0
  v_mfma_f32_16x16x32_bf16 v[148:151], v[24:27], v[160:163], 0
  s_waitcnt vmcnt(8)
  v_mfma_f32_16x16x32_bf16 v[144:147], v[26:29], v[164:167], v[144:147]
  v_mfma_f32_16x16x32_bf16 v[148:151], v[24:27], v[164:167], v[148:151]
  s_waitcnt vmcnt(7)
  v_mfma_f32_16x16x32_bf16 v[144:147], v[26:29], v[168:171], v[144:147]
  v_mfma_f32_16x16x32_bf16 v[148:151], v[24:27], v[168:171], v[148:151]
  s_waitcnt vmcnt(6)
  v_mfma_f32_16x16x32_bf16 v[144:147], v[26:29], v[172:175], v[144:147]
  v_mfma_f32_16x16x32_bf16 v[148:151], v[24:27], v[172:175], v[148:151]
  s_waitcnt vmcnt(5)
  v_mfma_f32_16x16x32_bf16 v[144:147], v[26:29], v[176:179], v[144:147]
  v_mfma_f32_16x16x32_bf16 v[148:151], v[24:27], v[176:179], v[148:151]
  s_waitcnt vmcnt(4)
  v_mfma_f32_16x16x32_bf16 v[144:147], v[26:29], v[180:183], v[144:147]
  v_mfma_f32_16x16x32_bf16 v[148:151], v[24:27], v[180:183], v[148:151]
  s_waitcnt vmcnt(3)
  v_mfma_f32_16x16x32_bf16 v[144:147], v[26:29], v[196:199], v[144:147]
  v_mfma_f32_16x16x32_bf16 v[148:151], v[24:27], v[196:199], v[148:151]
  s_waitcnt vmcnt(2)
  v_mfma_f32_16x16x32_bf16 v[144:147], v[26:29], v[200:203], v[144:147]
  v_mfma_f32_16x16x32_bf16 v[148:151], v[24:27], v[200:203], v[148:151]
  s_nop 6
  v_fma_f32 v248, v144, v214, v248
  v_fma_f32 v249, v145, v214, v249
  v_fma_f32 v250, v146, v214, v250
  v_fma_f32 v251, v147, v214, v251
  v_fma_f32 v252, v148, v215, v252
  v_fma_f32 v253, v149, v215, v253
  v_fma_f32 v254, v150, v215, v254
  v_fma_f32 v255, v151, v215, v255
  v_cvt_pk_bf16_f32 v248, v248, v249
  v_cvt_pk_bf16_f32 v249, v250, v251
  v_cvt_pk_bf16_f32 v250, v252, v253
  v_cvt_pk_bf16_f32 v251, v254, v255
  s_nop 0
  v_permlane16_swap_b32 v248, v250
  v_permlane16_swap_b32 v249, v251
  buffer_store_dwordx4 v[248:251], v30, s[40:43], s93 offen offset:256
L_end_gated_mix__spectral_gfnet__swiglu_ffn__prompt_kernel:
  s_endpgm
L_sp0_gated_mix__spectral_gfnet__swiglu_ffn__prompt_kernel:
  s_mov_b32 s5, 0
L_sq0_gated_mix__spectral_gfnet__swiglu_ffn__prompt_kernel:
  s_sleep 1
  buffer_load_dword v218, v222, s[28:31], 0 offen sc1
  s_add_u32 s5, s5, 1
  s_waitcnt vmcnt(0)
  v_readfirstlane_b32 s91, v218
  s_cmp_ge_u32 s5, 0x80000
  s_cbranch_scc1 L_bk0_gated_mix__spectral_gfnet__swiglu_ffn__prompt_kernel
  s_cmp_ge_u32 s91, s77
  s_cbranch_scc0 L_sq0_gated_mix__spectral_gfnet__swiglu_ffn__prompt_kernel
  s_branch L_bk0_gated_mix__spectral_gfnet__swiglu_ffn__prompt_kernel
L_sp1a_gated_mix__spectral_gfnet__swiglu_ffn__prompt_kernel:
  s_mov_b32 s5, 0
L_sq1a_gated_mix__spectral_gfnet__swiglu_ffn__prompt_kernel:
  s_sleep 1
  buffer_load_dword v218, v222, s[24:27], s75 offen sc1
  s_add_u32 s5, s5, 1
  s_waitcnt vmcnt(0)
  v_readfirstlane_b32 s91, v218
  s_cmp_ge_u32 s5, 0x80000
  s_cbranch_scc1 L_bk1a_gated_mix__spectral_gfnet__swiglu_ffn__prompt_kernel
  s_cmp_ge_u32 s91, s77
  s_cbranch_scc0 L_sq1a_gated_mix__spectral_gfnet__swiglu_ffn__prompt_kernel
  s_branch L_bk1a_gated_mix__spectral_gfnet__swiglu_ffn__prompt_kernel
L_sp1b_gated_mix__spectral_gfnet__swiglu_ffn__prompt_kernel:
  s_mov_b32 s5, 0
L_sq1b_gated_mix__spectral_gfnet__swiglu_ffn__prompt_kernel:
  s_sleep 1
  buffer_load_dword v219, v222, s[24:27], s76 offen sc1
  s_add_u32 s5, s5, 1
  s_waitcnt vmcnt(0)
  v_readfirstlane_b32 s91, v219
  s_cmp_ge_u32 s5, 0x80000
  s_cbranch_scc1 L_bk1b_gated_mix__spectral_gfnet__swiglu_ffn__prompt_kernel
  s_cmp_ge_u32 s91, s78
  s_cbranch_scc0 L_sq1b_gated_mix__spectral_gfnet__swiglu_ffn__prompt_kernel
  s_branch L_bk1b_gated_mix__spectral_gfnet__swiglu_ffn__prompt_kernel
L_sp2a_gated_mix__spectral_gfnet__swiglu_ffn__prompt_kernel:
  s_mov_b32 s5, 0
L_sq2a_gated_mix__spectral_gfnet__swiglu_ffn__prompt_kernel:
  s_sleep 1
  buffer_load_dword v218, v222, s[24:27], s75 offen sc1
  s_add_u32 s5, s5, 1
  s_waitcnt vmcnt(0)
  v_readfirstlane_b32 s91, v218
  s_cmp_ge_u32 s5, 0x80000
  s_cbranch_scc1 L_bk2a_gated_mix__spectral_gfnet__swiglu_ffn__prompt_kernel
  s_cmp_ge_u32 s91, s77
  s_cbranch_scc0 L_sq2a_gated_mix__spectral_gfnet__swiglu_ffn__prompt_kernel
  s_branch L_bk2a_gated_mix__spectral_gfnet__swiglu_ffn__prompt_kernel
L_sp2b_gated_mix__spectral_gfnet__swiglu_ffn__prompt_kernel:
  s_mov_b32 s5, 0
L_sq2b_gated_mix__spectral_gfnet__swiglu_ffn__prompt_kernel:
  s_sleep 1
  buffer_load_dword v219, v222, s[24:27], s76 offen sc1
  s_add_u32 s5, s5, 1
  s_waitcnt vmcnt(0)
  v_readfirstlane_b32 s91, v219
  s_cmp_ge_u32 s5, 0x80000
  s_cbranch_scc1 L_bk2b_gated_mix__spectral_gfnet__swiglu_ffn__prompt_kernel
  s_cmp_ge_u32 s91, s78
  s_cbranch_scc0 L_sq2b_gated_mix__spectral_gfnet__swiglu_ffn__prompt_kernel
  s_branch L_bk2b_gated_mix__spectral_gfnet__swiglu_ffn__prompt_kernel
L_spq1_gated_mix__spectral_gfnet__swiglu_ffn__prompt_kernel:
  s_mov_b32 s5, 0
L_sqq1_gated_mix__spectral_gfnet__swiglu_ffn__prompt_kernel:
  s_sleep 1
  buffer_load_dword v220, v222, s[24:27], s101 offen sc1
  s_add_u32 s5, s5, 1
  s_waitcnt vmcnt(0)
  v_readfirstlane_b32 s91, v220
  s_cmp_ge_u32 s5, 0x80000
  s_cbranch_scc1 L_bkq1_gated_mix__spectral_gfnet__swiglu_ffn__prompt_kernel
  s_cmp_ge_u32 s91, s45
  s_cbranch_scc0 L_sqq1_gated_mix__spectral_gfnet__swiglu_ffn__prompt_kernel
  s_branch L_bkq1_gated_mix__spectral_gfnet__swiglu_ffn__prompt_kernel
L_spq2_gated_mix__spectral_gfnet__swiglu_ffn__prompt_kernel:
  s_mov_b32 s5, 0
L_sqq2_gated_mix__spectral_gfnet__swiglu_ffn__prompt_kernel:
  s_sleep 1
  buffer_load_dword v220, v222, s[24:27], s101 offen sc1
  s_add_u32 s5, s5, 1
  s_waitcnt vmcnt(0)
  v_readfirstlane_b32 s91, v220
  s_cmp_ge_u32 s5, 0x80000
  s_cbranch_scc1 L_bkq2_gated_mix__spectral_gfnet__swiglu_ffn__prompt_kernel
  s_cmp_ge_u32 s91, s45
  s_cbranch_scc0 L_sqq2_gated_mix__spectral_gfnet__swiglu_ffn__prompt_kernel
  s_branch L_bkq2_gated_mix__spectral_gfnet__swiglu_ffn__prompt_kernel
L_sp8_gated_mix__spectral_gfnet__swiglu_ffn__prompt_kernel:
  s_mov_b32 s5, 0
L_sq8_gated_mix__spectral_gfnet__swiglu_ffn__prompt_kernel:
  s_sleep 1
  buffer_load_dword v218, v222, s[24:27], s75 offen sc1
  s_add_u32 s5, s5, 1
  s_waitcnt vmcnt(0)
  v_readfirstlane_b32 s91, v218
  s_cmp_ge_u32 s5, 0x80000
  s_cbranch_scc1 L_bk8_gated_mix__spectral_gfnet__swiglu_ffn__prompt_kernel
  s_cmp_ge_u32 s91, s77
  s_cbranch_scc0 L_sq8_gated_mix__spectral_gfnet__swiglu_ffn__prompt_kernel
  s_branch L_bk8_gated_mix__spectral_gfnet__swiglu_ffn__prompt_kernel
L_spA_gated_mix__spectral_gfnet__swiglu_ffn__prompt_kernel:
  s_mov_b32 s5, 0
L_sqA_gated_mix__spectral_gfnet__swiglu_ffn__prompt_kernel:
  s_sleep 1
  buffer_load_dword v218, v222, s[24:27], s75 offen sc1
  s_add_u32 s5, s5, 1
  s_waitcnt vmcnt(0)
  v_readfirstlane_b32 s91, v218
  s_cmp_ge_u32 s5, 0x80000
  s_cbranch_scc1 L_bkA_gated_mix__spectral_gfnet__swiglu_ffn__prompt_kernel
  s_cmp_ge_u32 s91, s77
  s_cbranch_scc0 L_sqA_gated_mix__spectral_gfnet__swiglu_ffn__prompt_kernel
  s_branch L_bkA_gated_mix__spectral_gfnet__swiglu_ffn__prompt_kernel
L_spB_gated_mix__spectral_gfnet__swiglu_ffn__prompt_kernel:
  s_mov_b32 s5, 0
L_sqB_gated_mix__spectral_gfnet__swiglu_ffn__prompt_kernel:
  s_sleep 1
  buffer_load_dword v219, v222, s[24:27], s76 offen sc1
  s_add_u32 s5, s5, 1
  s_waitcnt vmcnt(0)
  v_readfirstlane_b32 s91, v219
  s_cmp_ge_u32 s5, 0x80000
  s_cbranch_scc1 L_bkB_gated_mix__spectral_gfnet__swiglu_ffn__prompt_kernel
  s_cmp_ge_u32 s91, s77
  s_cbranch_scc0 L_sqB_gated_mix__spectral_gfnet__swiglu_ffn__prompt_kernel
  s_branch L_bkB_gated_mix__spectral_gfnet__swiglu_ffn__prompt_kernel
L_ozf_gated_mix__spectral_gfnet__swiglu_ffn__prompt_kernel:
  v_mov_b32 v31, 1
  buffer_store_dword v31, v222, s[28:31], 0 offen sc1
  s_branch L_zf_gated_mix__spectral_gfnet__swiglu_ffn__prompt_kernel
L_onw2_gated_mix__spectral_gfnet__swiglu_ffn__prompt_kernel:
  s_lshl_b32 s84, s87, 12
  s_lshl_b32 s85, s79, 8
  s_add_u32 s84, s84, s85
  s_lshl_b32 s85, s88, 7
  s_add_u32 s84, s84, s85
  s_add_u32 s84, s84, 6356992
  v_and_b32 v221, 14, v0
  v_and_b32 v31, 1, v0
  v_lshl_add_u32 v221, v31, 4, v221
  v_and_b32 v31, 1, v2
  v_lshl_add_u32 v221, v31, 6, v221
  v_lshrrev_b32 v31, 1, v2
  v_lshl_add_u32 v221, v31, 5, v221
  buffer_store_short v220, v221, s[24:27], s84 offen sc1
  s_branch L_nw2_gated_mix__spectral_gfnet__swiglu_ffn__prompt_kernel
L_ox1_gated_mix__spectral_gfnet__swiglu_ffn__prompt_kernel:
  v_lshrrev_b32 v24, 2, v1
  v_lshlrev_b32 v24, 1, v24
  v_and_b32 v30, 1, v1
  v_add_u32 v24, v24, v30
  v_lshlrev_b32 v29, 31, v30
  v_or_b32 v29, 1.0, v29
  s_lshl_b32 s84, s97, 4
  s_lshl_b32 s85, s88, 3
  s_add_u32 s84, s84, s85
  v_add_u32 v24, s84, v24
  v_bfe_u32 v25, v1, 1, 1
  v_cvt_f32_u32 v25, v25
  v_mul_f32 v25, 0x3e800000, v25
  v_add_u32 v30, s84, v1
  v_cmp_eq_u32 vcc, 2, v30
  v_mov_b32 v30, 0x120
  v_lshlrev_b32 v27, 3, v2
  v_cndmask_b32 v24, v24, v30, vcc
  v_cndmask_b32 v25, v25, 0, vcc
  v_mul_u32_u24 v30, s3, v24
  v_mul_u32_u24 v26, 7282, v30
  v_lshrrev_b32 v26, 16, v26
  v_mul_u32_u24 v26, 9, v26
  v_sub_u32 v30, v30, v26
  v_cvt_f32_u32 v30, v30
  v_fmac_f32 v25, 0x3de38e39, v30
  v_cvt_f32_u32 v24, v24
  v_mul_f32 v26, 0x3d638e39, v24
  v_mul_f32 v24, 0x3ae38e39, v24
  v_cos_f32 v26, v26
  v_add_u32 v30, s84, v2
  v_cmp_eq_u32 vcc, 0, v30
  v_cvt_f32_u32 v27, v27
  v_add_f32 v26, v26, v26
  v_cndmask_b32 v28, 1.0, 0, vcc
  s_mul_i32 s84, s87, 4352
  s_lshl_b32 s85, s88, 4
  s_add_u32 s84, s84, s85
  s_add_u32 s84, s84, 8704
  v_mul_u32_u24 v192, 272, v1
  v_lshl_add_u32 v192, v2, 2, v192
  v_add_u32 v192, s84, v192
  v_fma_f32 v96, v220, v114, v96
  v_add_f32 v97, v97, v115
  v_fma_f32 v112, v220, v98, -v112
  v_sub_f32 v113, v99, v113
  v_cvt_pk_bf16_f32 v184, v96, v97
  v_cvt_pk_bf16_f32 v185, v112, v113
  ds_write2_b32 v192, v184, v185 offset0:0 offset1:8
  v_fma_f32 v100, v220, v118, v100
  v_add_f32 v101, v101, v119
  v_fma_f32 v116, v220, v102, -v116
  v_sub_f32 v117, v103, v117
  v_cvt_pk_bf16_f32 v186, v100, v101
  v_cvt_pk_bf16_f32 v187, v116, v117
  ds_write2_b32 v192, v186, v187 offset0:16 offset1:24
  v_fma_f32 v104, v220, v122, v104
  v_add_f32 v105, v105, v123
  v_fma_f32 v120, v220, v106, -v120
  v_sub_f32 v121, v107, v121
  v_cvt_pk_bf16_f32 v188, v104, v105
  v_cvt_pk_bf16_f32 v189, v120, v121
  ds_write2_b32 v192, v188, v189 offset0:32 offset1:40
  v_fma_f32 v108, v220, v126, v108
  v_add_f32 v109, v109, v127
  v_fma_f32 v124, v220, v110, -v124
  v_sub_f32 v125, v111, v125
  v_cvt_pk_bf16_f32 v190, v108, v109
  v_cvt_pk_bf16_f32 v191, v124, v125
  ds_write2_b32 v192, v190, v191 offset0:48 offset1:56
  s_mul_i32 s84, s81, 2176
  s_add_u32 s84, s84, 8704
  v_lshl_add_u32 v192, v2, 4, v21
  v_add_u32 v192, s84, v192
  v_add_f32 v136, 0x00000000, v27
  v_add_f32 v137, 0x3f800000, v27
  v_add_f32 v138, 0x40000000, v27
  v_add_f32 v139, 0x40400000, v27
  v_add_f32 v140, 0x40800000, v27
  v_add_f32 v141, 0x40a00000, v27
  v_add_f32 v142, 0x40c00000, v27
  v_add_f32 v143, 0x40e00000, v27
  v_fma_f32 v136, v136, v24, v25
  v_fma_f32 v137, v137, v24, v25
  v_fma_f32 v138, v138, v24, v25
  v_fma_f32 v139, v139, v24, v25
  v_fma_f32 v140, v140, v24, v25
  v_fma_f32 v141, v141, v24, v25
  v_fma_f32 v142, v142, v24, v25
  v_fma_f32 v143, v143, v24, v25
  v_cos_f32 v136, v136
  v_cos_f32 v137, v137
  v_cos_f32 v138, v138
  v_cos_f32 v139, v139
  v_cos_f32 v140, v140
  v_cos_f32 v141, v141
  v_cos_f32 v142, v142
  v_cos_f32 v143, v143
  v_cvt_pk_bf16_f32 v152, v136, v137
  v_cvt_pk_bf16_f32 v153, v138, v139
  v_cvt_pk_bf16_f32 v154, v140, v141
  v_cvt_pk_bf16_f32 v155, v142, v143
  s_nop 1
  v_mfma_f32_16x16x32_bf16 v[96:99], a[0:3], v[152:155], 0
  v_add_f32 v144, 0x42000000, v27
  v_add_f32 v145, 0x42040000, v27
  v_mfma_f32_16x16x32_bf16 v[100:103], a[4:7], v[152:155], 0
  v_add_f32 v146, 0x42080000, v27
  v_add_f32 v147, 0x420c0000, v27
  v_mfma_f32_16x16x32_bf16 v[104:107], a[8:11], v[152:155], 0
  v_add_f32 v148, 0x42100000, v27
  v_add_f32 v149, 0x42140000, v27
  v_mfma_f32_16x16x32_bf16 v[108:111], a[12:15], v[152:155], 0
  v_add_f32 v150, 0x42180000, v27
  v_add_f32 v151, 0x421c0000, v27
  v_mfma_f32_16x16x32_bf16 v[112:115], a[144:147], v[152:155], 0
  v_fma_f32 v144, v144, v24, v25
  v_fma_f32 v145, v145, v24, v25
  v_mfma_f32_16x16x32_bf16 v[116:119], a[148:151], v[152:155], 0
  v_fma_f32 v146, v146, v24, v25
  v_fma_f32 v147, v147, v24, v25
  v_mfma_f32_16x16x32_bf16 v[120:123], a[152:155], v[152:155], 0
  v_fma_f32 v148, v148, v24, v25
  v_fma_f32 v149, v149, v24, v25
  v_fma_f32 v150, v150, v24, v25
  v_fma_f32 v151, v151, v24, v25
  v_cos_f32 v144, v144
  v_cos_f32 v145, v145
  v_cos_f32 v146, v146
  v_cos_f32 v147, v147
  v_cos_f32 v148, v148
  v_cos_f32 v149, v149
  v_cos_f32 v150, v150
  v_cos_f32 v151, v151
  v_cvt_pk_bf16_f32 v156, v144, v145
  v_cvt_pk_bf16_f32 v157, v146, v147
  v_cvt_pk_bf16_f32 v158, v148, v149
  v_cvt_pk_bf16_f32 v159, v150, v151
  v_mfma_f32_16x16x32_bf16 v[124:127], a[156:159], v[152:155], 0
  s_nop 0
  v_mfma_f32_16x16x32_bf16 v[96:99], a[16:19], v[156:159], v[96:99]
  v_fma_f32 v136, v26, v144, -v136
  v_fma_f32 v137, v26, v145, -v137
  v_mfma_f32_16x16x32_bf16 v[100:103], a[20:23], v[156:159], v[100:103]
  v_fma_f32 v138, v26, v146, -v138
  v_fma_f32 v139, v26, v147, -v139
  v_mfma_f32_16x16x32_bf16 v[104:107], a[24:27], v[156:159], v[104:107]
  v_fma_f32 v140, v26, v148, -v140
  v_fma_f32 v141, v26, v149, -v141
  v_mfma_f32_16x16x32_bf16 v[108:111], a[28:31], v[156:159], v[108:111]
  v_fma_f32 v142, v26, v150, -v142
  v_fma_f32 v143, v26, v151, -v143
  v_mfma_f32_16x16x32_bf16 v[112:115], a[160:163], v[156:159], v[112:115]
  v_cvt_pk_bf16_f32 v152, v136, v137
  v_cvt_pk_bf16_f32 v153, v138, v139
  v_mfma_f32_16x16x32_bf16 v[116:119], a[164:167], v[156:159], v[116:119]
  v_cvt_pk_bf16_f32 v154, v140, v141
  v_cvt_pk_bf16_f32 v155, v142, v143
  v_mfma_f32_16x16x32_bf16 v[120:123], a[168:171], v[156:159], v[120:123]
  v_mfma_f32_16x16x32_bf16 v[124:127], a[172:175], v[156:159], v[124:127]
  v_mfma_f32_16x16x32_bf16 v[96:99], a[32:35], v[152:155], v[96:99]
  v_fma_f32 v144, v26, v136, -v144
  v_fma_f32 v145, v26, v137, -v145
  v_mfma_f32_16x16x32_bf16 v[100:103], a[36:39], v[152:155], v[100:103]
  v_fma_f32 v146, v26, v138, -v146
  v_fma_f32 v147, v26, v139, -v147
  v_mfma_f32_16x16x32_bf16 v[104:107], a[40:43], v[152:155], v[104:107]
  v_fma_f32 v148, v26, v140, -v148
  v_fma_f32 v149, v26, v141, -v149
  v_mfma_f32_16x16x32_bf16 v[108:111], a[44:47], v[152:155], v[108:111]
  v_fma_f32 v150, v26, v142, -v150
  v_fma_f32 v151, v26, v143, -v151
  v_mfma_f32_16x16x32_bf16 v[112:115], a[176:179], v[152:155], v[112:115]
  v_cvt_pk_bf16_f32 v156, v144, v145
  v_cvt_pk_bf16_f32 v157, v146, v147
  v_mfma_f32_16x16x32_bf16 v[116:119], a[180:183], v[152:155], v[116:119]
  v_cvt_pk_bf16_f32 v158, v148, v149
  v_cvt_pk_bf16_f32 v159, v150, v151
  v_mfma_f32_16x16x32_bf16 v[120:123], a[184:187], v[152:155], v[120:123]
  v_mfma_f32_16x16x32_bf16 v[124:127], a[188:191], v[152:155], v[124:127]
  s_waitcnt lgkmcnt(0)
  s_barrier
  v_mfma_f32_16x16x32_bf16 v[96:99], a[48:51], v[156:159], v[96:99]
  v_fma_f32 v136, v26, v144, -v136
  v_fma_f32 v137, v26, v145, -v137
  v_mfma_f32_16x16x32_bf16 v[100:103], a[52:55], v[156:159], v[100:103]
  v_fma_f32 v138, v26, v146, -v138
  v_fma_f32 v139, v26, v147, -v139
  v_mfma_f32_16x16x32_bf16 v[104:107], a[56:59], v[156:159], v[104:107]
  v_fma_f32 v140, v26, v148, -v140
  v_fma_f32 v141, v26, v149, -v141
  v_mfma_f32_16x16x32_bf16 v[108:111], a[60:63], v[156:159], v[108:111]
  v_fma_f32 v142, v26, v150, -v142
  v_fma_f32 v143, v26, v151, -v143
  v_mfma_f32_16x16x32_bf16 v[112:115], a[192:195], v[156:159], v[112:115]
  v_cvt_pk_bf16_f32 v152, v136, v137
  v_cvt_pk_bf16_f32 v153, v138, v139
  v_mfma_f32_16x16x32_bf16 v[116:119], a[196:199], v[156:159], v[116:119]
  v_cvt_pk_bf16_f32 v154, v140, v141
  v_cvt_pk_bf16_f32 v155, v142, v143
  v_mfma_f32_16x16x32_bf16 v[120:123], a[200:203], v[156:159], v[120:123]
  v_mfma_f32_16x16x32_bf16 v[124:127], a[204:207], v[156:159], v[124:127]
  ds_read_b128 v[184:187], v192
  ds_read_b128 v[188:191], v192 offset:1088
  v_mfma_f32_16x16x32_bf16 v[96:99], a[64:67], v[152:155], v[96:99]
  v_fma_f32 v144, v26, v136, -v144
  v_fma_f32 v145, v26, v137, -v145
  v_mfma_f32_16x16x32_bf16 v[100:103], a[68:71], v[152:155], v[100:103]
  v_fma_f32 v146, v26, v138, -v146
  v_fma_f32 v147, v26, v139, -v147
  v_mfma_f32_16x16x32_bf16 v[104:107], a[72:75], v[152:155], v[104:107]
  v_fma_f32 v148, v26, v140, -v148
  v_fma_f32 v149, v26, v141, -v149
  v_mfma_f32_16x16x32_bf16 v[108:111], a[76:79], v[152:155], v[108:111]
  v_fma_f32 v150, v26, v142, -v150
  v_fma_f32 v151, v26, v143, -v151
  v_mfma_f32_16x16x32_bf16 v[112:115], a[208:211], v[152:155], v[112:115]
  v_cvt_pk_bf16_f32 v156, v144, v145
  v_cvt_pk_bf16_f32 v157, v146, v147
  v_mfma_f32_16x16x32_bf16 v[116:119], a[212:215], v[152:155], v[116:119]
  v_cvt_pk_bf16_f32 v158, v148, v149
  v_cvt_pk_bf16_f32 v159, v150, v151
  v_mfma_f32_16x16x32_bf16 v[120:123], a[216:219], v[152:155], v[120:123]
  v_mfma_f32_16x16x32_bf16 v[124:127], a[220:223], v[152:155], v[124:127]
  v_mfma_f32_16x16x32_bf16 v[96:99], a[80:83], v[156:159], v[96:99]
  v_fma_f32 v136, v26, v144, -v136
  v_fma_f32 v137, v26, v145, -v137
  v_mfma_f32_16x16x32_bf16 v[100:103], a[84:87], v[156:159], v[100:103]
  v_fma_f32 v138, v26, v146, -v138
  v_fma_f32 v139, v26, v147, -v139
  v_mfma_f32_16x16x32_bf16 v[104:107], a[88:91], v[156:159], v[104:107]
  v_fma_f32 v140, v26, v148, -v140
  v_fma_f32 v141, v26, v149, -v141
  v_mfma_f32_16x16x32_bf16 v[108:111], a[92:95], v[156:159], v[108:111]
  v_fma_f32 v142, v26, v150, -v142
  v_fma_f32 v143, v26, v151, -v143
  v_mfma_f32_16x16x32_bf16 v[112:115], a[224:227], v[156:159], v[112:115]
  v_cvt_pk_bf16_f32 v152, v136, v137
  v_cvt_pk_bf16_f32 v153, v138, v139
  v_mfma_f32_16x16x32_bf16 v[116:119], a[228:231], v[156:159], v[116:119]
  v_cvt_pk_bf16_f32 v154, v140, v141
  v_cvt_pk_bf16_f32 v155, v142, v143
  v_mfma_f32_16x16x32_bf16 v[120:123], a[232:235], v[156:159], v[120:123]
  v_mfma_f32_16x16x32_bf16 v[124:127], a[236:239], v[156:159], v[124:127]
  v_mfma_f32_16x16x32_bf16 v[96:99], a[96:99], v[152:155], v[96:99]
  v_fma_f32 v144, v26, v136, -v144
  v_fma_f32 v145, v26, v137, -v145
  v_mfma_f32_16x16x32_bf16 v[100:103], a[100:103], v[152:155], v[100:103]
  v_fma_f32 v146, v26, v138, -v146
  v_fma_f32 v147, v26, v139, -v147
  v_mfma_f32_16x16x32_bf16 v[104:107], a[104:107], v[152:155], v[104:107]
  v_fma_f32 v148, v26, v140, -v148
  v_fma_f32 v149, v26, v141, -v149
  v_mfma_f32_16x16x32_bf16 v[108:111], a[108:111], v[152:155], v[108:111]
  v_fma_f32 v150, v26, v142, -v150
  v_fma_f32 v151, v26, v143, -v151
  v_mfma_f32_16x16x32_bf16 v[112:115], a[240:243], v[152:155], v[112:115]
  v_cvt_pk_bf16_f32 v156, v144, v145
  v_cvt_pk_bf16_f32 v157, v146, v147
  v_mfma_f32_16x16x32_bf16 v[116:119], a[244:247], v[152:155], v[116:119]
  v_cvt_pk_bf16_f32 v158, v148, v149
  v_cvt_pk_bf16_f32 v159, v150, v151
  v_mfma_f32_16x16x32_bf16 v[120:123], a[248:251], v[152:155], v[120:123]
  v_mfma_f32_16x16x32_bf16 v[124:127], a[252:255], v[152:155], v[124:127]
  v_mfma_f32_16x16x32_bf16 v[96:99], a[112:115], v[156:159], v[96:99]
  v_fma_f32 v136, v26, v144, -v136
  v_fma_f32 v137, v26, v145, -v137
  v_mfma_f32_16x16x32_bf16 v[100:103], a[116:119], v[156:159], v[100:103]
  v_fma_f32 v138, v26, v146, -v138
  v_fma_f32 v139, v26, v147, -v139
  v_mfma_f32_16x16x32_bf16 v[104:107], a[120:123], v[156:159], v[104:107]
  v_fma_f32 v140, v26, v148, -v140
  v_fma_f32 v141, v26, v149, -v141
  v_mfma_f32_16x16x32_bf16 v[108:111], a[124:127], v[156:159], v[108:111]
  v_fma_f32 v142, v26, v150, -v142
  v_fma_f32 v143, v26, v151, -v143
  v_mfma_f32_16x16x32_bf16 v[112:115], v[224:227], v[156:159], v[112:115]
  v_cvt_pk_bf16_f32 v152, v136, v137
  v_cvt_pk_bf16_f32 v153, v138, v139
  v_mfma_f32_16x16x32_bf16 v[116:119], v[228:231], v[156:159], v[116:119]
  v_cvt_pk_bf16_f32 v154, v140, v141
  v_cvt_pk_bf16_f32 v155, v142, v143
  v_mfma_f32_16x16x32_bf16 v[120:123], v[232:235], v[156:159], v[120:123]
  v_mfma_f32_16x16x32_bf16 v[124:127], v[236:239], v[156:159], v[124:127]
  v_mfma_f32_16x16x32_bf16 v[96:99], a[128:131], v[152:155], v[96:99]
  s_waitcnt lgkmcnt(1)
  buffer_store_dwordx4 v[184:187], v21, s[24:27], s39 offen sc1
  v_mfma_f32_16x16x32_bf16 v[100:103], a[132:135], v[152:155], v[100:103]
  s_waitcnt lgkmcnt(0)
  buffer_store_dwordx4 v[188:191], v21, s[24:27], s39 offen offset:1024 sc1
  v_mfma_f32_16x16x32_bf16 v[104:107], a[136:139], v[152:155], v[104:107]
  s_lshl_b32 s39, s97, 4
  s_add_u32 s39, s39, s79
  s_lshl_b32 s39, s39, 2
  v_mfma_f32_16x16x32_bf16 v[108:111], a[140:143], v[152:155], v[108:111]
  s_add_u32 s39, s39, s81
  v_mfma_f32_16x16x32_bf16 v[112:115], v[240:243], v[152:155], v[112:115]
  s_lshl_b32 s39, s39, 11
  v_mfma_f32_16x16x32_bf16 v[116:119], v[244:247], v[152:155], v[116:119]
  v_mfma_f32_16x16x32_bf16 v[120:123], v[248:251], v[152:155], v[120:123]
  v_mfma_f32_16x16x32_bf16 v[124:127], v[252:255], v[152:155], v[124:127]
  s_nop 3
  v_fma_f32 v96, v29, v112, v96
  v_fma_f32 v97, v29, v113, v97
  v_fma_f32 v98, v29, v114, v98
  v_fma_f32 v99, v29, v115, v99
  v_fma_f32 v100, v29, v116, v100
  v_fma_f32 v101, v29, v117, v101
  v_fma_f32 v102, v29, v118, v102
  v_fma_f32 v103, v29, v119, v103
  v_fma_f32 v104, v29, v120, v104
  v_fma_f32 v105, v29, v121, v105
  v_fma_f32 v106, v29, v122, v106
  v_fma_f32 v107, v29, v123, v107
  v_fma_f32 v108, v29, v124, v108
  v_fma_f32 v109, v29, v125, v109
  v_fma_f32 v110, v29, v126, v110
  v_fma_f32 v111, v29, v127, v111
  v_add_f32 v112, v96, v104
  v_sub_f32 v120, v96, v104
  v_add_f32 v113, v97, v105
  v_sub_f32 v121, v97, v105
  v_add_f32 v114, v98, v106
  v_sub_f32 v122, v98, v106
  v_add_f32 v115, v99, v107
  v_sub_f32 v123, v99, v107
  v_add_f32 v116, v100, v108
  v_sub_f32 v124, v100, v108
  v_add_f32 v117, v101, v109
  v_sub_f32 v125, v101, v109
  v_add_f32 v118, v102, v110
  v_sub_f32 v126, v102, v110
  v_add_f32 v119, v103, v111
  v_sub_f32 v127, v103, v111
  v_cvt_pk_bf16_f32 v136, v112, v113
  v_cvt_pk_bf16_f32 v137, v114, v115
  v_cvt_pk_bf16_f32 v138, v116, v117
  v_cvt_pk_bf16_f32 v139, v118, v119
  v_cvt_pk_bf16_f32 v140, v120, v121
  v_cvt_pk_bf16_f32 v141, v122, v123
  v_cvt_pk_bf16_f32 v142, v124, v125
  v_cvt_pk_bf16_f32 v143, v126, v127
  v_mfma_f32_16x16x32_bf16 v[96:99], v[136:139], v[196:199], 0
  v_mfma_f32_16x16x32_bf16 v[112:115], v[136:139], v[200:203], 0
  v_mfma_f32_16x16x32_bf16 v[100:103], v[140:143], v[204:207], 0
  v_mfma_f32_16x16x32_bf16 v[116:119], v[140:143], v[208:211], 0
  v_mfma_f32_16x16x32_bf16 v[104:107], v[136:139], v[212:215], 0
  v_mfma_f32_16x16x32_bf16 v[120:123], v[136:139], v[216:219], 0
  v_mfma_f32_16x16x32_bf16 v[108:111], v[140:143], v[128:131], 0
  v_mfma_f32_16x16x32_bf16 v[124:127], v[140:143], v[132:135], 0
  s_branch L_x1_gated_mix__spectral_gfnet__swiglu_ffn__prompt_kernel
L_ony_gated_mix__spectral_gfnet__swiglu_ffn__prompt_kernel:
  s_lshl_b32 s84, s89, 12
  s_add_u32 s84, s84, 2359296
  v_bfe_u32 v210, v1, 2, 1
  v_lshlrev_b32 v210, 6, v210
  v_lshrrev_b32 v211, 3, v1
  v_lshl_add_u32 v210, v211, 17, v210
  v_and_b32 v211, 3, v1
  v_lshl_add_u32 v210, v211, 2, v210
  v_lshl_add_u32 v210, v2, 28, v210
  v_cvt_pk_bf16_f32 v206, v98, v106
  v_cvt_pk_bf16_f32 v208, -v114, -v122
  v_cvt_pk_bf16_f32 v207, v102, v110
  v_cvt_pk_bf16_f32 v209, -v118, -v126
  buffer_store_dword v206, v210, s[24:27], s84 offen offset:0 sc1
  buffer_store_dword v208, v210, s[24:27], s84 offen offset:32 sc1
  buffer_store_dword v207, v210, s[24:27], s84 offen offset:16 sc1
  buffer_store_dword v209, v210, s[24:27], s84 offen offset:48 sc1
  s_branch L_ny_gated_mix__spectral_gfnet__swiglu_ffn__prompt_kernel
L_os2n_gated_mix__spectral_gfnet__swiglu_ffn__prompt_kernel:
  s_lshl_b32 s84, s87, 12
  s_lshl_b32 s85, s88, 6
  s_add_u32 s84, s84, s85
  s_add_u32 s84, s84, 6356992
  v_lshrrev_b32 v212, 2, v0
  v_lshlrev_b32 v212, 7, v212
  v_and_b32 v213, 3, v0
  v_lshl_add_u32 v212, v213, 4, v212
  buffer_load_dwordx4 v[204:207], v212, s[24:27], s84 offen sc1
  buffer_load_dwordx4 v[208:211], v212, s[24:27], s84 offen offset:2048 sc1
  s_branch L_s2n_gated_mix__spectral_gfnet__swiglu_ffn__prompt_kernel
L_oex1_gated_mix__spectral_gfnet__swiglu_ffn__prompt_kernel:
  ds_write_b128 v152, v[196:199] offset:8192
  ds_write_b128 v152, v[200:203] offset:9216
  s_add_u32 s84, s100, 3145728
  s_add_u32 s85, s84, 131072
  v_cvt_f32_u32 v96, v1
  v_lshlrev_b32 v97, 2, v2
  v_mul_f32 v96, 0x3d000000, v96
  v_cvt_f32_u32 v97, v97
  v_add_f32 v98, 0x00000000, v97
  v_add_f32 v99, 0x3f800000, v97
  v_mul_f32 v98, v98, v96
  v_mul_f32 v99, v99, v96
  v_cos_f32 v100, v98
  v_cos_f32 v101, v99
  v_sin_f32 v98, v98
  v_sin_f32 v99, v99
  v_cvt_pk_bf16_f32 v128, v100, v101
  v_cvt_pk_bf16_f32 v132, v98, v99
  v_add_f32 v98, 0x40000000, v97
  v_add_f32 v99, 0x40400000, v97
  v_mul_f32 v98, v98, v96
  v_mul_f32 v99, v99, v96
  v_cos_f32 v100, v98
  v_cos_f32 v101, v99
  v_sin_f32 v98, v98
  v_sin_f32 v99, v99
  v_cvt_pk_bf16_f32 v129, v100, v101
  v_cvt_pk_bf16_f32 v133, v98, v99
  s_waitcnt lgkmcnt(0)
  s_barrier
  ds_read_b64_tr_b16 v[112:113], v153 offset:0
  ds_read_b64_tr_b16 v[114:115], v153 offset:2048
  ds_read_b64_tr_b16 v[116:117], v153 offset:32
  ds_read_b64_tr_b16 v[118:119], v153 offset:2080
  ds_read_b64_tr_b16 v[196:197], v154 offset:0
  ds_read_b64_tr_b16 v[198:199], v154 offset:1024
  ds_read_b64_tr_b16 v[200:201], v154 offset:4096
  ds_read_b64_tr_b16 v[202:203], v154 offset:5120
  v_and_b32 v96, 1, v1
  v_mul_u32_u24 v96, 0x8000, v96
  v_lshl_add_u32 v96, v96, 16, v96
  v_xor_b32 v130, v96, v128
  v_xor_b32 v131, v96, v129
  v_xor_b32 v134, v96, v132
  v_xor_b32 v135, v96, v133
  v_xor_b32 v136, 0x80008000, v132
  v_xor_b32 v140, 0x80000000, v128
  v_xor_b32 v144, 0x80000000, v132
  v_xor_b32 v148, 0x8000, v132
  v_xor_b32 v137, 0x80008000, v133
  v_xor_b32 v141, 0x80000000, v129
  v_xor_b32 v145, 0x80000000, v133
  v_xor_b32 v149, 0x8000, v133
  v_xor_b32 v138, 0x80008000, v134
  v_xor_b32 v142, 0x80000000, v130
  v_xor_b32 v146, 0x80000000, v134
  v_xor_b32 v150, 0x8000, v134
  v_xor_b32 v139, 0x80008000, v135
  v_xor_b32 v143, 0x80000000, v131
  v_xor_b32 v147, 0x80000000, v135
  v_xor_b32 v151, 0x8000, v135
  s_waitcnt lgkmcnt(6)
  v_mfma_f32_16x16x32_bf16 v[96:99], v[128:131], v[112:115], 0
  s_waitcnt lgkmcnt(4)
  v_mfma_f32_16x16x32_bf16 v[96:99], v[132:135], v[116:119], v[96:99]
  v_mfma_f32_16x16x32_bf16 v[104:107], v[128:131], v[116:119], 0
  v_mfma_f32_16x16x32_bf16 v[104:107], v[136:139], v[112:115], v[104:107]
  v_mfma_f32_16x16x32_bf16 v[100:103], v[140:143], v[112:115], 0
  v_mfma_f32_16x16x32_bf16 v[100:103], v[144:147], v[116:119], v[100:103]
  v_mfma_f32_16x16x32_bf16 v[108:111], v[140:143], v[116:119], 0
  v_mfma_f32_16x16x32_bf16 v[108:111], v[148:151], v[112:115], v[108:111]
  s_waitcnt lgkmcnt(0)
  s_barrier
  v_lshlrev_b32 v215, 16, v200
  v_and_b32 v200, 0xffff0000, v200
  v_lshlrev_b32 v214, 16, v196
  v_and_b32 v196, 0xffff0000, v196
  v_mul_f32 v212, v104, v215
  v_mul_f32 v213, v105, v200
  v_mul_f32 v215, v96, v215
  v_mul_f32 v200, v97, v200
  v_fma_f32 v96, v96, v214, -v212
  v_fma_f32 v97, v97, v196, -v213
  v_fma_f32 v104, v104, v214, v215
  v_fma_f32 v105, v105, v196, v200
  v_lshlrev_b32 v215, 16, v201
  v_and_b32 v201, 0xffff0000, v201
  v_lshlrev_b32 v214, 16, v197
  v_and_b32 v197, 0xffff0000, v197
  v_mul_f32 v212, v106, v215
  v_mul_f32 v213, v107, v201
  v_mul_f32 v215, v98, v215
  v_mul_f32 v201, v99, v201
  v_fma_f32 v98, v98, v214, -v212
  v_fma_f32 v99, v99, v197, -v213
  v_fma_f32 v106, v106, v214, v215
  v_fma_f32 v107, v107, v197, v201
  v_lshlrev_b32 v215, 16, v202
  v_and_b32 v202, 0xffff0000, v202
  v_lshlrev_b32 v214, 16, v198
  v_and_b32 v198, 0xffff0000, v198
  v_mul_f32 v212, v108, v215
  v_mul_f32 v213, v109, v202
  v_mul_f32 v215, v100, v215
  v_mul_f32 v202, v101, v202
  v_fma_f32 v100, v100, v214, -v212
  v_fma_f32 v101, v101, v198, -v213
  v_fma_f32 v108, v108, v214, v215
  v_fma_f32 v109, v109, v198, v202
  v_lshlrev_b32 v215, 16, v203
  v_and_b32 v203, 0xffff0000, v203
  v_lshlrev_b32 v214, 16, v199
  v_and_b32 v199, 0xffff0000, v199
  v_mul_f32 v212, v110, v215
  v_mul_f32 v213, v111, v203
  v_mul_f32 v215, v102, v215
  v_mul_f32 v203, v103, v203
  v_fma_f32 v102, v102, v214, -v212
  v_fma_f32 v103, v103, v199, -v213
  v_fma_f32 v110, v110, v214, v215
  v_fma_f32 v111, v111, v199, v203
  v_cvt_pk_bf16_f32 v112, v96, v97
  v_cvt_pk_bf16_f32 v113, v98, v99
  v_cvt_pk_bf16_f32 v114, v100, v101
  v_cvt_pk_bf16_f32 v115, v102, v103
  v_cvt_pk_bf16_f32 v116, v104, v105
  v_cvt_pk_bf16_f32 v117, v106, v107
  v_cvt_pk_bf16_f32 v118, v108, v109
  v_cvt_pk_bf16_f32 v119, v110, v111
  v_mfma_f32_16x16x32_bf16 v[96:99], v[112:115], v[128:131], 0
  s_nop 0
  v_mfma_f32_16x16x32_bf16 v[96:99], v[116:119], v[136:139], v[96:99]
  v_mfma_f32_16x16x32_bf16 v[100:103], v[112:115], v[140:143], 0
  v_mfma_f32_16x16x32_bf16 v[100:103], v[116:119], v[148:151], v[100:103]
  v_mfma_f32_16x16x32_bf16 v[104:107], v[116:119], v[128:131], 0
  v_mfma_f32_16x16x32_bf16 v[104:107], v[112:115], v[132:135], v[104:107]
  v_mfma_f32_16x16x32_bf16 v[108:111], v[116:119], v[140:143], 0
  v_mfma_f32_16x16x32_bf16 v[108:111], v[112:115], v[144:147], v[108:111]
  s_nop 1
  v_cvt_pk_bf16_f32 v196, v96, v97
  v_cvt_pk_bf16_f32 v197, v98, v99
  ds_write_b64 v155, v[196:197] offset:0
  v_cvt_pk_bf16_f32 v198, v100, v101
  v_cvt_pk_bf16_f32 v199, v102, v103
  ds_write_b64 v155, v[198:199] offset:2048
  v_cvt_pk_bf16_f32 v200, v104, v105
  v_cvt_pk_bf16_f32 v201, v106, v107
  ds_write_b64 v156, v[200:201] offset:0
  v_cvt_pk_bf16_f32 v202, v108, v109
  v_cvt_pk_bf16_f32 v203, v110, v111
  ds_write_b64 v156, v[202:203] offset:2048
  s_waitcnt lgkmcnt(0)
  s_barrier
  ds_read_b128 v[112:115], v157 offset:0
  ds_read_b128 v[116:119], v157 offset:4096
  s_waitcnt lgkmcnt(1)
  buffer_store_dwordx4 v[112:115], v220, s[24:27], s84 offen sc1
  s_waitcnt lgkmcnt(0)
  buffer_store_dwordx4 v[116:119], v220, s[24:27], s85 offen sc1
  s_branch L_s2e_gated_mix__spectral_gfnet__swiglu_ffn__prompt_kernel
L_onyl_gated_mix__spectral_gfnet__swiglu_ffn__prompt_kernel:
  s_add_u32 s84, s84, 2359296
  v_and_b32 v192, 1, v2
  v_lshlrev_b32 v192, 6, v192
  v_lshrrev_b32 v144, 1, v2
  v_lshl_add_u32 v192, v144, 17, v192
  buffer_load_dwordx4 v[144:147], v192, s[24:27], s84 offen offset:0 sc1
  buffer_load_dwordx4 v[148:151], v192, s[24:27], s84 offen offset:32 sc1
  buffer_load_dwordx4 v[152:155], v192, s[24:27], s84 offen offset:16 sc1
  buffer_load_dwordx4 v[156:159], v192, s[24:27], s84 offen offset:48 sc1
  s_branch L_nyl_gated_mix__spectral_gfnet__swiglu_ffn__prompt_kernel
L_od2l_gated_mix__spectral_gfnet__swiglu_ffn__prompt_kernel:
  s_lshl_b32 s84, s89, 12
  s_add_u32 s84, s84, 3145728
  s_lshl_b32 s85, s95, 17
  s_add_u32 s85, s85, s84
  s_waitcnt vmcnt(0)
  buffer_load_dwordx4 v[144:147], v21, s[24:27], s85 offen offset:0 sc1
  s_waitcnt vmcnt(1)
  buffer_load_dwordx4 v[148:151], v21, s[24:27], s85 offen offset:1024 sc1
  s_waitcnt vmcnt(2)
  buffer_load_dwordx4 v[152:155], v21, s[24:27], s85 offen offset:2048 sc1
  s_waitcnt vmcnt(3)
  buffer_load_dwordx4 v[156:159], v21, s[24:27], s85 offen offset:3072 sc1
  s_branch L_d2l_gated_mix__spectral_gfnet__swiglu_ffn__prompt_kernel
L_onyd_gated_mix__spectral_gfnet__swiglu_ffn__prompt_kernel:
  v_cmp_eq_u32 vcc, 0, v1
  v_xor_b32 v148, 0x80008000, v148
  s_nop 0
  v_cndmask_b32 v200, v200, v144, vcc
  v_cndmask_b32 v196, v196, v148, vcc
  v_xor_b32 v149, 0x80008000, v149
  v_cndmask_b32 v201, v201, v145, vcc
  v_cndmask_b32 v197, v197, v149, vcc
  v_xor_b32 v150, 0x80008000, v150
  v_cndmask_b32 v202, v202, v146, vcc
  v_cndmask_b32 v198, v198, v150, vcc
  v_xor_b32 v151, 0x80008000, v151
  v_cndmask_b32 v203, v203, v147, vcc
  v_cndmask_b32 v199, v199, v151, vcc
  v_xor_b32 v156, 0x80008000, v156
  v_cndmask_b32 v208, v208, v152, vcc
  v_cndmask_b32 v204, v204, v156, vcc
  v_xor_b32 v157, 0x80008000, v157
  v_cndmask_b32 v209, v209, v153, vcc
  v_cndmask_b32 v205, v205, v157, vcc
  v_xor_b32 v158, 0x80008000, v158
  v_cndmask_b32 v210, v210, v154, vcc
  v_cndmask_b32 v206, v206, v158, vcc
  v_xor_b32 v159, 0x80008000, v159
  v_cndmask_b32 v211, v211, v155, vcc
  v_cndmask_b32 v207, v207, v159, vcc
  s_branch L_nyd_gated_mix__spectral_gfnet__swiglu_ffn__prompt_kernel
L_od2_gated_mix__spectral_gfnet__swiglu_ffn__prompt_kernel:
  s_lshl_b32 s100, s81, 12
  s_add_u32 s100, s100, 73728
  v_add_u32 v192, s100, v21
  v_lshrrev_b32 v193, 2, v1
  v_lshl_add_u32 v193, v2, 3, v193
  v_lshlrev_b32 v193, 7, v193
  v_and_b32 v194, 3, v1
  v_lshl_add_u32 v193, v194, 3, v193
  v_add_u32 v193, s100, v193
  ds_write_b128 v192, v[144:147] offset:0
  ds_write_b128 v192, v[148:151] offset:1024
  ds_write_b128 v192, v[152:155] offset:2048
  ds_write_b128 v192, v[156:159] offset:3072
  ds_read_b64_tr_b16 v[144:145], v193 offset:0
  ds_read_b64_tr_b16 v[146:147], v193 offset:512
  ds_read_b64_tr_b16 v[148:149], v193 offset:32
  ds_read_b64_tr_b16 v[150:151], v193 offset:544
  ds_read_b64_tr_b16 v[152:153], v193 offset:64
  ds_read_b64_tr_b16 v[154:155], v193 offset:576
  ds_read_b64_tr_b16 v[156:157], v193 offset:96
  ds_read_b64_tr_b16 v[158:159], v193 offset:608
  s_lshl_b32 s100, s89, 1
  s_mul_i32 s100, s100, 18
  s_add_u32 s100, s100, s95
  s_lshl_b32 s100, s100, 1
  s_add_u32 s100, s100, s88
  s_lshl_b32 s100, s100, 10
  s_add_u32 s100, s100, 50331648
  s_waitcnt lgkmcnt(5)
  v_xor_b32 v184, 0x80008000, v148
  v_xor_b32 v185, 0x80008000, v149
  s_waitcnt lgkmcnt(4)
  v_xor_b32 v186, 0x80008000, v150
  v_xor_b32 v187, 0x80008000, v151
  s_waitcnt lgkmcnt(1)
  v_xor_b32 v188, 0x80008000, v156
  v_xor_b32 v189, 0x80008000, v157
  s_waitcnt lgkmcnt(0)
  v_xor_b32 v190, 0x80008000, v158
  v_xor_b32 v191, 0x80008000, v159
  v_mfma_f32_16x16x32_bf16 v[48:51], v[144:147], v[32:35], 0
  v_mfma_f32_16x16x32_bf16 v[48:51], v[184:187], v[36:39], v[48:51]
  v_mfma_f32_16x16x32_bf16 v[56:59], v[152:155], v[40:43], 0
  v_mfma_f32_16x16x32_bf16 v[56:59], v[188:191], v[44:47], v[56:59]
  v_mfma_f32_16x16x32_bf16 v[52:55], v[148:151], v[32:35], 0
  v_mfma_f32_16x16x32_bf16 v[52:55], v[144:147], v[36:39], v[52:55]
  v_mfma_f32_16x16x32_bf16 v[60:63], v[156:159], v[40:43], 0
  v_mfma_f32_16x16x32_bf16 v[60:63], v[152:155], v[44:47], v[60:63]
  s_nop 3
  v_add_f32 v144, v48, v56
  v_sub_f32 v152, v48, v56
  v_add_f32 v145, v49, v57
  v_sub_f32 v153, v49, v57
  v_add_f32 v146, v50, v58
  v_sub_f32 v154, v50, v58
  v_add_f32 v147, v51, v59
  v_sub_f32 v155, v51, v59
  v_add_f32 v148, v52, v60
  v_sub_f32 v156, v52, v60
  v_add_f32 v149, v53, v61
  v_sub_f32 v157, v53, v61
  v_add_f32 v150, v54, v62
  v_sub_f32 v158, v54, v62
  v_add_f32 v151, v55, v63
  v_sub_f32 v159, v55, v63
  v_cvt_pk_bf16_f32 v144, v144, v145
  v_cvt_pk_bf16_f32 v145, v146, v147
  v_cvt_pk_bf16_f32 v146, v148, v149
  v_cvt_pk_bf16_f32 v147, v150, v151
  buffer_store_dwordx4 v[144:147], v21, s[24:27], s100 offen sc1
  s_add_u32 s100, s100, 36864
  v_cvt_pk_bf16_f32 v152, v152, v153
  v_cvt_pk_bf16_f32 v153, v154, v155
  v_cvt_pk_bf16_f32 v154, v156, v157
  v_cvt_pk_bf16_f32 v155, v158, v159
  buffer_store_dwordx4 v[152:155], v21, s[24:27], s100 offen sc1
  s_branch L_d2_gated_mix__spectral_gfnet__swiglu_ffn__prompt_kernel
L_last_gated_mix__spectral_gfnet__swiglu_ffn__prompt_kernel:
  s_endpgm
.section .rodata,"a"
.p2align 6
.amdhsa_kernel gated_mix__spectral_gfnet__swiglu_ffn__prompt_kernel
  .amdhsa_next_free_vgpr 512
  .amdhsa_next_free_sgpr 102
  .amdhsa_accum_offset 256
  .amdhsa_group_segment_fixed_size 0
  .amdhsa_kernarg_size 88
  .amdhsa_user_sgpr_count 2
  .amdhsa_user_sgpr_kernarg_segment_ptr 1
  .amdhsa_system_sgpr_workgroup_id_x 1
.end_amdhsa_kernel
```
